```python
import torch

def _softmax(x, axis=-1):
    return torch.softmax(x, dim=axis)
def _gelu(x):
    return torch.nn.functional.gelu(x, approximate="tanh")
def _silu(x):
    return torch.nn.functional.silu(x)
def _sigmoid(x):
    return torch.sigmoid(x)
def _layernorm(x, axis=-1, eps=1e-5):
    m = x.mean(dim=axis, keepdim=True)
    v = x.var(dim=axis, keepdim=True, unbiased=False)
    return (x - m) / torch.sqrt(v + eps)
def _scatter_add(tgt, idx, src, axis=0):
    return tgt.clone().index_add_(axis, idx, src)
def _segment_sum(src, seg, n):
    out = torch.zeros((n,) + src.shape[1:], dtype=src.dtype)
    return out.index_add_(0, seg, src)
def _pad(x, pw):
    flat = tuple(v for pair in reversed(pw) for v in pair)
    return torch.nn.functional.pad(x, flat)

kernel_name = 'parallel_sum__sliding_block__glu_gated_geglu__prompt'

def setup_inputs():

    _w = (lambda a: (lambda t: t.to(torch.bfloat16) if t.is_floating_point() else t)(torch.as_tensor(a)))
    def _A_setup():
        B, S, D = 1, 2048, 1024
        return {
            "x": _w((lambda *s: torch.randn(*s, dtype=torch.bfloat16) * 0.05)(B, S, D)),
            "wqkv": _w((lambda *s: torch.randn(*s, dtype=torch.bfloat16) * 0.05)(D, 3 * D)),
            "wo": _w((lambda *s: torch.randn(*s, dtype=torch.bfloat16) * 0.05)(D, D)),
        }
    _A_in = _A_setup()

    def _B_setup():
        B, S, Dm, Df = 1, 2048, 1024, 3584
        return {
            "x": _w((lambda *s: torch.randn(*s, dtype=torch.bfloat16) * 0.05)(B, S, Dm)),
            "w_gate": _w((lambda *s: torch.randn(*s, dtype=torch.bfloat16) * 0.8)(Dm, Df) * (Dm ** -0.5)),
            "w_up": _w((lambda *s: torch.randn(*s, dtype=torch.bfloat16) * 0.8)(Dm, Df) * (Dm ** -0.5)),
            "w_down": _w((lambda *s: torch.randn(*s, dtype=torch.bfloat16) * 0.8)(Df, Dm) * (Df ** -0.5)),
        }
    _B_in = _B_setup()

    return {
        "A_x": _A_in["x"],
        "A_wqkv": _A_in["wqkv"],
        "A_wo": _A_in["wo"],
        "B_x": _B_in["x"],
        "B_w_gate": _B_in["w_gate"],
        "B_w_up": _B_in["w_up"],
        "B_w_down": _B_in["w_down"],
    }

def reference(A_x, A_wqkv, A_wo, B_x, B_w_gate, B_w_up, B_w_down):
    def _A_ref(x, wqkv, wo):
        B, S, D = x.shape
        H = 32; Dh = D // H; W = 256
        qkv = (lambda x, *d: x.permute(*d))((x @ wqkv).reshape(B, S, 3, H, Dh), 2, 0, 3, 1, 4)
        q, k, v = qkv[0], qkv[1], qkv[2]
        scores = torch.einsum("bhqd,bhkd->bhqk", q, k) * (Dh ** -0.5)
        idx = torch.arange(S)
        mask = (idx[:, None] - idx[None, :] >= 0) & (idx[:, None] - idx[None, :] < W)
        scores = torch.where(mask[None, None], scores, -1e9)
        p = _softmax(scores, axis=-1)
        o = torch.einsum("bhqk,bhkd->bhqd", p, v)
        return (lambda x, *d: x.permute(*d))(o, 0, 2, 1, 3).reshape(B, S, D) @ wo

    def _B_ref(x, w_gate, w_up, w_down):
        g = torch.einsum("bsd,df->bsf", x, w_gate)
        u = torch.einsum("bsd,df->bsf", x, w_up)
        h = _gelu(g) * u
        return torch.einsum("bsf,fd->bsd", h, w_down)

    x = A_x
    xn = _layernorm(x, axis=-1)
    return x + _A_ref(xn, A_wqkv, A_wo) + _B_ref(xn, B_w_gate, B_w_up, B_w_down)
```

```asm
; @launch grid=(256,1,1) block=(512,1,1) lds=163840
.amdgcn_target "amdgcn-amd-amdhsa--gfx950"
.text
.globl parallel_sum__sliding_block__glu_gated_geglu__prompt_kernel
.p2align 8
.type parallel_sum__sliding_block__glu_gated_geglu__prompt_kernel,@function
parallel_sum__sliding_block__glu_gated_geglu__prompt_kernel:
L_pf0:
s_cmp_ge_u32 s2, 256
s_cbranch_scc1 L_end
s_load_dwordx4 s[4:7], s[0:1], 0
s_load_dwordx8 s[48:55], s[0:1], 32
s_load_dwordx4 s[56:59], s[0:1], 64
s_load_dwordx2 s[84:85], s[0:1], 16
s_memrealtime s[86:87]
s_getpc_b64 s[88:89]
L_pc0:
s_lshr_b32 s90, s2, 3
s_and_b32 s90, s90, 15
s_mul_i32 s90, s90, 4096
v_lshlrev_b32 v16, 6, v0
v_add_u32 v16, s90, v16
v_min_u32 v16, L_end-L_pc0, v16
v_cmp_gt_u32 vcc, 64, v0
s_nop 0
s_and_saveexec_b64 s[90:91], vcc
s_cbranch_execz L_nocode
global_load_dword v16, v16, s[88:89]
L_nocode:
s_mov_b64 exec, s[90:91]
v_lshrrev_b32 v9, 6, v0
v_and_b32 v0, 63, v0
v_readfirstlane_b32 s43, v9
s_and_b32 s45, s2, 7
s_lshl_b32 s45, s45, 2
s_bfe_u32 s41, s2, 0x20003
s_add_u32 s45, s45, s41
s_lshr_b32 s44, s2, 5
s_and_b32 s41, s45, 1
s_lshl_b32 s41, s41, 2
s_xor_b32 s88, s43, s41
s_and_b32 s41, s44, 1
s_lshl_b32 s41, s41, 2
s_xor_b32 s89, s43, s41
s_and_b32 s41, s43, 1
s_lshl_b32 s41, s41, 2
v_lshrrev_b32 v11, 4, v0
v_add_u32 v11, s41, v11
v_and_b32 v12, 7, v0
v_xor_b32 v11, v11, v12
v_lshlrev_b32 v11, 4, v11
v_lshrrev_b32 v12, 3, v0
v_lshl_add_u32 v6, v12, 11, v11
s_lshl_b32 s28, s44, 19
s_lshl_b32 s41, s88, 14
s_add_u32 s28, s28, s41
s_lshl_b32 s40, s88, 10
s_mov_b32 s10, 0x400000
s_mov_b32 s11, 0x20000
s_waitcnt lgkmcnt(0)
s_mov_b32 s8, s4
s_mov_b32 s9, s5
s_add_u32 m0, s40, 0
s_nop 0
buffer_load_dwordx4 v6, s[8:11], s28 offen lds
s_add_u32 s41, s28, 262144
s_add_u32 m0, s40, 16384
s_nop 0
buffer_load_dwordx4 v6, s[8:11], s41 offen lds
s_add_u32 s41, s28, 131072
s_add_u32 m0, s40, 8192
s_nop 0
buffer_load_dwordx4 v6, s[8:11], s41 offen lds
s_add_u32 s41, s28, 393216
s_add_u32 m0, s40, 24576
s_nop 0
buffer_load_dwordx4 v6, s[8:11], s41 offen lds
s_lshl_b32 s91, s45, 6
s_mul_i32 s90, s45, 224
s_lshl_b32 s41, s89, 6
v_add_u32 v11, s41, v0
v_mul_u32_u24 v12, 4682, v11
v_lshrrev_b32 v12, 16, v12
v_mul_u32_u24 v13, 14, v12
v_sub_u32 v13, v11, v13
v_lshrrev_b32 v14, 1, v12
v_xor_b32 v14, v14, v12
v_and_b32 v14, 4, v14
v_mul_u32_u24 v14, 3, v14
v_xor_b32 v7, v12, v14
v_mul_u32_u24 v7, 7168, v7
v_lshl_add_u32 v7, v13, 4, v7
v_add_u32 v7, s90, v7
v_mul_u32_u24 v12, 5462, v0
v_lshrrev_b32 v12, 16, v12
v_mul_u32_u24 v13, 12, v12
v_sub_u32 v13, v0, v13
v_lshrrev_b32 v14, 1, v12
v_and_b32 v14, 2, v14
v_xor_b32 v13, v13, v14
v_lshrrev_b32 v14, 1, v12
v_xor_b32 v14, v14, v12
v_and_b32 v14, 4, v14
v_mul_u32_u24 v14, 3, v14
v_xor_b32 v15, v12, v14
v_mul_u32_u24 v15, 6144, v15
v_lshrrev_b32 v14, 2, v13
v_lshl_add_u32 v15, v14, 11, v15
v_and_b32 v13, 3, v13
v_lshl_add_u32 v15, v13, 4, v15
v_add_u32 v15, s91, v15
s_lshl_b32 s41, s89, 10
s_add_u32 s41, s41, 65536
s_cmp_eq_u32 s89, 7
s_cselect_b64 vcc, -1, 0
s_mov_b32 s14, 7340032
s_cmov_b32 s14, 6291456
s_mov_b32 s18, s14
s_mov_b32 s15, 0x20000
s_mov_b32 s19, 0x20000
v_cndmask_b32 v7, v7, v15, vcc
s_mov_b32 s31, 458752
s_cmov_b32 s31, 393216
s_mov_b32 s32, 229376
s_cmov_b32 s32, 98304
s_cselect_b32 s33, 196608, 0
s_mov_b32 s34, 229376
s_cmov_b32 s34, 294912
s_cselect_b32 s35, 94208, s41
s_mov_b32 s36, 7168
s_cmov_b32 s36, 3072
s_mov_b32 s37, 14336
s_cmov_b32 s37, 6144
s_mov_b32 s38, 21504
s_cmov_b32 s38, 9216
s_mov_b32 s29, 0
s_mov_b32 s30, 0
s_waitcnt lgkmcnt(0)
s_cselect_b32 s12, s6, s48
s_cselect_b32 s13, s7, s49
s_cselect_b32 s16, s6, s50
s_cselect_b32 s17, s7, s51
s_mov_b32 s8, s4
s_mov_b32 s9, s5
s_add_u32 s36, s35, s36
s_add_u32 s37, s35, s37
s_add_u32 s38, s35, s38
s_mov_b32 m0, s35
s_nop 0
buffer_load_dwordx4 v7, s[12:15], s29 offen lds
s_add_u32 s41, s29, s32
s_mov_b32 m0, s36
s_nop 0
buffer_load_dwordx4 v7, s[12:15], s41 offen lds
s_add_u32 s41, s29, s33
s_mov_b32 m0, s37
s_nop 0
buffer_load_dwordx4 v7, s[16:19], s41 offen lds
s_add_u32 s41, s29, s34
s_mov_b32 m0, s38
s_nop 0
buffer_load_dwordx4 v7, s[16:19], s41 offen lds
s_lshl_b32 s41, s89, 2
s_lshr_b32 s41, 0x1ba87542, s41
s_and_b32 s41, s41, 15
s_lshl_b32 s39, s41, 10
s_add_u32 s39, s39, 94208
s_lshl_b32 s41, s41, 6
v_add_u32 v11, s41, v0
s_mov_b32 s20, s6
s_mov_b32 s21, s7
s_mov_b32 s22, 0x600000
s_mov_b32 s23, 0x20000
v_mul_u32_u24 v12, 5462, v11
v_lshrrev_b32 v12, 16, v12
v_mul_u32_u24 v13, 12, v12
v_sub_u32 v13, v11, v13
v_lshrrev_b32 v14, 1, v12
v_and_b32 v14, 2, v14
v_xor_b32 v13, v13, v14
v_lshrrev_b32 v14, 1, v12
v_xor_b32 v14, v14, v12
v_and_b32 v14, 4, v14
v_mul_u32_u24 v14, 3, v14
v_xor_b32 v8, v12, v14
v_mul_u32_u24 v8, 6144, v8
v_lshrrev_b32 v14, 2, v13
v_lshl_add_u32 v8, v14, 11, v8
v_and_b32 v13, 3, v13
v_lshl_add_u32 v8, v13, 4, v8
v_add_u32 v8, s91, v8
s_mov_b32 m0, s39
s_nop 0
buffer_load_dwordx4 v8, s[20:23], s30 offen lds
s_add_u32 s28, s28, 128
s_add_u32 s29, s29, s31
s_add_u32 s30, s30, 393216
s_add_u32 m0, s40, 32768
s_nop 0
buffer_load_dwordx4 v6, s[8:11], s28 offen lds
s_add_u32 s41, s28, 262144
s_add_u32 m0, s40, 49152
s_nop 0
buffer_load_dwordx4 v6, s[8:11], s41 offen lds
s_add_u32 s41, s28, 131072
s_add_u32 m0, s40, 40960
s_nop 0
buffer_load_dwordx4 v6, s[8:11], s41 offen lds
s_add_u32 s41, s28, 393216
s_add_u32 m0, s40, 57344
s_nop 0
buffer_load_dwordx4 v6, s[8:11], s41 offen lds
s_lshr_b32 s93, s2, 3
s_and_b32 s94, s2, 7
s_mov_b32 s99, 0x20000
s_cmp_lg_u32 s43, 5
s_cbranch_scc1 L_pfn_2
s_mul_i32 s93, s2, 28672
s_add_u32 s96, s52, s93
s_addc_u32 s97, s53, 0
s_mov_b32 s98, 0
s_mov_b32 s100, 0
s_mov_b32 s101, 0
s_mov_b32 s0, 256
s_mov_b32 s1, 1024
s_mov_b32 s3, 7
s_branch L_pfd_1
L_pfn_2:
s_mov_b32 s96, s52
s_mov_b32 s97, s53
s_mov_b32 s98, 0
s_mov_b32 s100, 0
s_mov_b32 s101, 0
s_mov_b32 s0, 0
s_mov_b32 s1, 0
s_mov_b32 s3, 0
L_pfd_1:
s_mov_b32 s24, s58
s_mov_b32 s25, s59
s_mov_b32 s26, 0x10000000
s_mov_b32 s27, 0x20000
s_lshr_b32 s46, s43, 2
s_and_b32 s47, s43, 3
v_mov_b32 v5, 0
s_or_b32 s41, s2, s43
s_cmp_lg_u32 s41, 0
s_cbranch_scc1 L_nn_3
s_or_b32 s41, s86, 1
v_mov_b32 v11, s41
global_store_dword v5, v11, s[56:57] offset:128 sc1
L_nn_3:
v_and_b32 v11, 15, v0
v_lshrrev_b32 v12, 4, v0
v_lshrrev_b32 v13, 1, v11
v_xor_b32 v13, v13, v12
v_lshlrev_b32 v13, 4, v13
v_lshl_add_u32 v1, v11, 7, v13
s_lshl_b32 s41, s46, 14
v_add_u32 v1, s41, v1
v_xor_b32 v2, 64, v1
v_lshrrev_b32 v13, 1, v12
v_lshlrev_b32 v13, 4, v13
v_and_b32 v14, 1, v12
v_lshl_add_u32 v13, v14, 2, v13
v_bfe_u32 v15, v0, 2, 2
v_add_u32 v13, v13, v15
v_and_b32 v15, 3, v0
v_lshlrev_b32 v15, 3, v15
v_mul_u32_u24 v3, 224, v13
v_add_u32 v3, v3, v15
v_mul_u32_u24 v4, 192, v13
v_add_u32 v4, v4, v15
v_add_u32 v4, 94208, v4
v_lshlrev_b32 v14, 5, v14
s_mov_b32 s92, 0x3f803f80
s_mov_b32 s42, 1
s_lshl_b32 s87, s44, 1
s_add_u32 s89, s87, 2
s_add_u32 s50, s87, 1
s_mov_b32 s51, 13
s_cmp_ge_u32 s44, 6
s_cmov_b32 s50, 99
s_cmov_b32 s89, 13
s_cmp_eq_u32 s44, 7
s_cmov_b32 s87, 99
s_cmov_b32 s89, 99
s_cmp_lg_u32 s46, 0
s_cmov_b32 s87, 99
s_cmov_b32 s50, 99
s_cmov_b32 s51, 99
s_mov_b32 s88, 3
s_lshl_b32 s48, s44, 1
s_cmp_ge_u32 s44, 4
s_cmov_b32 s48, 0
s_add_u32 s88, s48, 5
s_add_u32 s48, s48, 2
s_add_u32 s48, s48, s46
s_add_u32 s49, s48, 1
s_cmp_lg_u32 s43, 0
s_cmov_b32 s88, 99
s_cmov_b32 s89, 99
s_and_b32 s41, s45, 1
s_cmp_eq_u32 s47, 3
s_cbranch_scc1 L_v1_4
s_lshl_b32 s93, s47, 1
s_add_u32 s93, s93, s41
s_add_u32 s94, s47, 3
s_cmp_eq_u32 s47, 0
s_cmov_b32 s94, 1
s_lshl_b32 s91, s94, 6
s_lshl_b32 s94, s94, 5
v_xor_b32 v14, s94, v14
v_add_u32 v4, v4, v14
s_add_u32 s90, s93, 6
s_lshl_b32 s90, s90, 6
s_lshl_b32 s93, s93, 5
s_add_u32 s93, s93, 65536
v_add_u32 v3, s93, v3
s_waitcnt vmcnt(4)
s_barrier
ds_read_b128 v[24:27], v1 offset:0
ds_read_b128 v[28:31], v2 offset:0
ds_read_b128 v[36:39], v2 offset:2048
ds_read_b128 v[32:35], v1 offset:2048
ds_read_b64_tr_b16 v[60:61], v3 offset:7168
ds_read_b64_tr_b16 v[62:63], v3 offset:8960
ds_read_b64_tr_b16 v[56:57], v3 offset:0
ds_read_b64_tr_b16 v[58:59], v3 offset:1792
ds_read_b64_tr_b16 v[68:69], v3 offset:21504
ds_read_b64_tr_b16 v[70:71], v3 offset:23296
ds_read_b64_tr_b16 v[64:65], v3 offset:14336
ds_read_b64_tr_b16 v[66:67], v3 offset:16128
ds_read_b64_tr_b16 v[76:77], v3 offset:7200
ds_read_b64_tr_b16 v[78:79], v3 offset:8992
ds_read_b64_tr_b16 v[72:73], v3 offset:32
ds_read_b64_tr_b16 v[74:75], v3 offset:1824
ds_read_b64_tr_b16 v[84:85], v3 offset:21536
ds_read_b64_tr_b16 v[86:87], v3 offset:23328
ds_read_b64_tr_b16 v[80:81], v3 offset:14368
ds_read_b64_tr_b16 v[82:83], v3 offset:16160
ds_read_b64_tr_b16 v[92:93], v4 offset:6144
s_waitcnt lgkmcnt(13)
v_mfma_f32_16x16x32_bf16 v[96:99], v[56:59], v[24:27], 0
ds_read_b64_tr_b16 v[94:95], v4 offset:7680
v_mfma_f32_16x16x32_bf16 v[96:99], v[60:63], v[28:31], v[96:99]
ds_read_b64_tr_b16 v[88:89], v4 offset:0
s_add_u32 m0, s35, 40960
v_mfma_f32_16x16x32_bf16 v[116:119], v[60:63], v[36:39], 0
ds_read_b64_tr_b16 v[90:91], v4 offset:1536
buffer_load_dwordx4 v7, s[12:15], s29 offen lds
v_mfma_f32_16x16x32_bf16 v[116:119], v[56:59], v[32:35], v[116:119]
ds_read_b128 v[40:43], v1 offset:4096
s_waitcnt lgkmcnt(13)
v_mfma_f32_16x16x32_bf16 v[120:123], v[64:67], v[32:35], 0
ds_read_b128 v[44:47], v2 offset:4096
s_add_u32 s41, s29, s32
v_mfma_f32_16x16x32_bf16 v[120:123], v[68:71], v[36:39], v[120:123]
ds_read_b128 v[52:55], v2 offset:6144
s_add_u32 m0, s36, 40960
v_mfma_f32_16x16x32_bf16 v[100:103], v[68:71], v[28:31], 0
ds_read_b128 v[48:51], v1 offset:6144
buffer_load_dwordx4 v7, s[12:15], s41 offen lds
v_mfma_f32_16x16x32_bf16 v[100:103], v[64:67], v[24:27], v[100:103]
s_waitcnt lgkmcnt(12)
v_mfma_f32_16x16x32_bf16 v[104:107], v[72:75], v[24:27], 0
s_add_u32 s41, s29, s33
v_mfma_f32_16x16x32_bf16 v[104:107], v[76:79], v[28:31], v[104:107]
s_add_u32 m0, s37, 40960
v_mfma_f32_16x16x32_bf16 v[124:127], v[76:79], v[36:39], 0
buffer_load_dwordx4 v7, s[16:19], s41 offen lds
v_mfma_f32_16x16x32_bf16 v[124:127], v[72:75], v[32:35], v[124:127]
s_waitcnt lgkmcnt(8)
v_mfma_f32_16x16x32_bf16 v[128:131], v[80:83], v[32:35], 0
s_add_u32 s41, s29, s34
v_mfma_f32_16x16x32_bf16 v[128:131], v[84:87], v[36:39], v[128:131]
s_add_u32 m0, s38, 40960
v_mfma_f32_16x16x32_bf16 v[108:111], v[84:87], v[28:31], 0
buffer_load_dwordx4 v7, s[16:19], s41 offen lds
v_mfma_f32_16x16x32_bf16 v[108:111], v[80:83], v[24:27], v[108:111]
s_waitcnt lgkmcnt(4)
v_mfma_f32_16x16x32_bf16 v[112:115], v[88:91], v[24:27], 0
v_mfma_f32_16x16x32_bf16 v[112:115], v[92:95], v[28:31], v[112:115]
v_mfma_f32_16x16x32_bf16 v[132:135], v[92:95], v[36:39], 0
s_add_u32 m0, s39, 40960
v_mfma_f32_16x16x32_bf16 v[132:135], v[88:91], v[32:35], v[132:135]
buffer_load_dwordx4 v8, s[20:23], s30 offen lds
s_waitcnt lgkmcnt(0)
s_barrier
v_mfma_f32_16x16x32_bf16 v[136:139], v[56:59], v[40:43], 0
ds_read_b128 v[24:27], v1 offset:8192
v_mfma_f32_16x16x32_bf16 v[136:139], v[60:63], v[44:47], v[136:139]
ds_read_b128 v[28:31], v2 offset:8192
v_mfma_f32_16x16x32_bf16 v[156:159], v[60:63], v[52:55], 0
ds_read_b128 v[36:39], v2 offset:10240
v_mfma_f32_16x16x32_bf16 v[156:159], v[56:59], v[48:51], v[156:159]
ds_read_b128 v[32:35], v1 offset:10240
v_mfma_f32_16x16x32_bf16 v[160:163], v[64:67], v[48:51], 0
s_cmp_eq_u32 s43, 0
s_cbranch_scc1 L_nl_6
L_nlb_7:
v_mfma_f32_16x16x32_bf16 v[160:163], v[68:71], v[52:55], v[160:163]
v_mfma_f32_16x16x32_bf16 v[140:143], v[68:71], v[44:47], 0
v_mfma_f32_16x16x32_bf16 v[140:143], v[64:67], v[40:43], v[140:143]
v_mfma_f32_16x16x32_bf16 v[144:147], v[72:75], v[40:43], 0
v_mfma_f32_16x16x32_bf16 v[144:147], v[76:79], v[44:47], v[144:147]
s_add_u32 s28, s28, 128
s_add_u32 s29, s29, s31
s_add_u32 s30, s30, 393216
v_mfma_f32_16x16x32_bf16 v[164:167], v[76:79], v[52:55], 0
v_mfma_f32_16x16x32_bf16 v[164:167], v[72:75], v[48:51], v[164:167]
v_mfma_f32_16x16x32_bf16 v[168:171], v[80:83], v[48:51], 0
v_mfma_f32_16x16x32_bf16 v[168:171], v[84:87], v[52:55], v[168:171]
v_mfma_f32_16x16x32_bf16 v[148:151], v[84:87], v[44:47], 0
s_add_u32 m0, s40, 0
v_mfma_f32_16x16x32_bf16 v[148:151], v[80:83], v[40:43], v[148:151]
buffer_load_dwordx4 v6, s[8:11], s28 offen lds
v_mfma_f32_16x16x32_bf16 v[152:155], v[88:91], v[40:43], 0
v_mfma_f32_16x16x32_bf16 v[152:155], v[92:95], v[44:47], v[152:155]
v_mfma_f32_16x16x32_bf16 v[172:175], v[92:95], v[52:55], 0
v_mfma_f32_16x16x32_bf16 v[172:175], v[88:91], v[48:51], v[172:175]
s_waitcnt lgkmcnt(3)
v_mfma_f32_16x16x32_bf16 v[176:179], v[56:59], v[24:27], 0
ds_read_b128 v[40:43], v1 offset:12288
s_add_u32 s41, s28, 262144
s_waitcnt lgkmcnt(3)
v_mfma_f32_16x16x32_bf16 v[176:179], v[60:63], v[28:31], v[176:179]
ds_read_b128 v[44:47], v2 offset:12288
s_add_u32 m0, s40, 16384
s_waitcnt lgkmcnt(3)
v_mfma_f32_16x16x32_bf16 v[196:199], v[60:63], v[36:39], 0
ds_read_b128 v[52:55], v2 offset:14336
buffer_load_dwordx4 v6, s[8:11], s41 offen lds
s_waitcnt lgkmcnt(3)
v_mfma_f32_16x16x32_bf16 v[196:199], v[56:59], v[32:35], v[196:199]
ds_read_b128 v[48:51], v1 offset:14336
v_mfma_f32_16x16x32_bf16 v[200:203], v[64:67], v[32:35], 0
v_mfma_f32_16x16x32_bf16 v[200:203], v[68:71], v[36:39], v[200:203]
s_mov_b32 m0, s35
v_mfma_f32_16x16x32_bf16 v[180:183], v[68:71], v[28:31], 0
buffer_load_dwordx4 v7, s[12:15], s29 offen lds
v_mfma_f32_16x16x32_bf16 v[180:183], v[64:67], v[24:27], v[180:183]
v_mfma_f32_16x16x32_bf16 v[184:187], v[72:75], v[24:27], 0
v_mfma_f32_16x16x32_bf16 v[184:187], v[76:79], v[28:31], v[184:187]
v_mfma_f32_16x16x32_bf16 v[204:207], v[76:79], v[36:39], 0
s_add_u32 s41, s29, s32
v_mfma_f32_16x16x32_bf16 v[204:207], v[72:75], v[32:35], v[204:207]
s_mov_b32 m0, s36
v_mfma_f32_16x16x32_bf16 v[208:211], v[80:83], v[32:35], 0
buffer_load_dwordx4 v7, s[12:15], s41 offen lds
v_mfma_f32_16x16x32_bf16 v[208:211], v[84:87], v[36:39], v[208:211]
v_mfma_f32_16x16x32_bf16 v[188:191], v[84:87], v[28:31], 0
v_mfma_f32_16x16x32_bf16 v[188:191], v[80:83], v[24:27], v[188:191]
v_mfma_f32_16x16x32_bf16 v[192:195], v[88:91], v[24:27], 0
s_add_u32 s41, s29, s33
v_mfma_f32_16x16x32_bf16 v[192:195], v[92:95], v[28:31], v[192:195]
s_mov_b32 m0, s37
v_mfma_f32_16x16x32_bf16 v[212:215], v[92:95], v[36:39], 0
buffer_load_dwordx4 v7, s[16:19], s41 offen lds
v_mfma_f32_16x16x32_bf16 v[212:215], v[88:91], v[32:35], v[212:215]
s_cmp_eq_u32 s87, 0
s_cbranch_scc1 L_cs_8
L_csb_9:
s_waitcnt vmcnt(5) lgkmcnt(0)
s_barrier
v_mfma_f32_16x16x32_bf16 v[216:219], v[56:59], v[40:43], 0
ds_read_b128 v[24:27], v1 offset:32768
v_mfma_f32_16x16x32_bf16 v[216:219], v[60:63], v[44:47], v[216:219]
ds_read_b128 v[28:31], v2 offset:32768
v_mfma_f32_16x16x32_bf16 v[236:239], v[60:63], v[52:55], 0
ds_read_b128 v[36:39], v2 offset:34816
v_mfma_f32_16x16x32_bf16 v[236:239], v[56:59], v[48:51], v[236:239]
ds_read_b128 v[32:35], v1 offset:34816
ds_read_b64_tr_b16 v[60:61], v3 offset:48128
v_mfma_f32_16x16x32_bf16 v[240:243], v[64:67], v[48:51], 0
ds_read_b64_tr_b16 v[62:63], v3 offset:49920
s_add_u32 s41, s29, s34
v_mfma_f32_16x16x32_bf16 v[240:243], v[68:71], v[52:55], v[240:243]
ds_read_b64_tr_b16 v[56:57], v3 offset:40960
s_mov_b32 m0, s38
v_mfma_f32_16x16x32_bf16 v[220:223], v[68:71], v[44:47], 0
ds_read_b64_tr_b16 v[58:59], v3 offset:42752
buffer_load_dwordx4 v7, s[16:19], s41 offen lds
v_mfma_f32_16x16x32_bf16 v[220:223], v[64:67], v[40:43], v[220:223]
ds_read_b64_tr_b16 v[68:69], v3 offset:62464
v_mfma_f32_16x16x32_bf16 v[224:227], v[72:75], v[40:43], 0
ds_read_b64_tr_b16 v[70:71], v3 offset:64256
v_mfma_f32_16x16x32_bf16 v[224:227], v[76:79], v[44:47], v[224:227]
ds_read_b64_tr_b16 v[64:65], v3 offset:55296
v_mfma_f32_16x16x32_bf16 v[244:247], v[76:79], v[52:55], 0
ds_read_b64_tr_b16 v[66:67], v3 offset:57088
v_mfma_f32_16x16x32_bf16 v[244:247], v[72:75], v[48:51], v[244:247]
ds_read_b64_tr_b16 v[76:77], v3 offset:48160
v_mfma_f32_16x16x32_bf16 v[248:251], v[80:83], v[48:51], 0
ds_read_b64_tr_b16 v[78:79], v3 offset:49952
v_mfma_f32_16x16x32_bf16 v[248:251], v[84:87], v[52:55], v[248:251]
ds_read_b64_tr_b16 v[72:73], v3 offset:40992
v_mfma_f32_16x16x32_bf16 v[228:231], v[84:87], v[44:47], 0
ds_read_b64_tr_b16 v[74:75], v3 offset:42784
v_mfma_f32_16x16x32_bf16 v[228:231], v[80:83], v[40:43], v[228:231]
ds_read_b64_tr_b16 v[84:85], v3 offset:62496
v_mfma_f32_16x16x32_bf16 v[232:235], v[88:91], v[40:43], 0
ds_read_b64_tr_b16 v[86:87], v3 offset:64288
v_mfma_f32_16x16x32_bf16 v[232:235], v[92:95], v[44:47], v[232:235]
ds_read_b64_tr_b16 v[80:81], v3 offset:55328
v_mfma_f32_16x16x32_bf16 v[252:255], v[92:95], v[52:55], 0
ds_read_b64_tr_b16 v[82:83], v3 offset:57120
v_mfma_f32_16x16x32_bf16 v[252:255], v[88:91], v[48:51], v[252:255]
ds_read_b64_tr_b16 v[92:93], v4 offset:47104
s_waitcnt lgkmcnt(13)
v_mfma_f32_16x16x32_bf16 v[96:99], v[56:59], v[24:27], v[96:99]
ds_read_b64_tr_b16 v[94:95], v4 offset:48640
v_mfma_f32_16x16x32_bf16 v[96:99], v[60:63], v[28:31], v[96:99]
ds_read_b64_tr_b16 v[88:89], v4 offset:40960
v_mfma_f32_16x16x32_bf16 v[116:119], v[60:63], v[36:39], v[116:119]
ds_read_b64_tr_b16 v[90:91], v4 offset:42496
v_mfma_f32_16x16x32_bf16 v[116:119], v[56:59], v[32:35], v[116:119]
ds_read_b128 v[40:43], v1 offset:36864
s_mov_b32 m0, s39
s_waitcnt lgkmcnt(13)
v_mfma_f32_16x16x32_bf16 v[120:123], v[64:67], v[32:35], v[120:123]
ds_read_b128 v[44:47], v2 offset:36864
buffer_load_dwordx4 v8, s[20:23], s30 offen lds
v_mfma_f32_16x16x32_bf16 v[120:123], v[68:71], v[36:39], v[120:123]
ds_read_b128 v[52:55], v2 offset:38912
v_mfma_f32_16x16x32_bf16 v[100:103], v[68:71], v[28:31], v[100:103]
ds_read_b128 v[48:51], v1 offset:38912
v_mfma_f32_16x16x32_bf16 v[100:103], v[64:67], v[24:27], v[100:103]
s_add_u32 s41, s28, 131072
s_waitcnt lgkmcnt(12)
v_mfma_f32_16x16x32_bf16 v[104:107], v[72:75], v[24:27], v[104:107]
s_add_u32 m0, s40, 8192
v_mfma_f32_16x16x32_bf16 v[104:107], v[76:79], v[28:31], v[104:107]
buffer_load_dwordx4 v6, s[8:11], s41 offen lds
v_mfma_f32_16x16x32_bf16 v[124:127], v[76:79], v[36:39], v[124:127]
v_mfma_f32_16x16x32_bf16 v[124:127], v[72:75], v[32:35], v[124:127]
s_waitcnt lgkmcnt(8)
v_mfma_f32_16x16x32_bf16 v[128:131], v[80:83], v[32:35], v[128:131]
s_add_u32 s41, s28, 393216
v_mfma_f32_16x16x32_bf16 v[128:131], v[84:87], v[36:39], v[128:131]
s_add_u32 m0, s40, 24576
v_mfma_f32_16x16x32_bf16 v[108:111], v[84:87], v[28:31], v[108:111]
buffer_load_dwordx4 v6, s[8:11], s41 offen lds
v_mfma_f32_16x16x32_bf16 v[108:111], v[80:83], v[24:27], v[108:111]
s_waitcnt lgkmcnt(4)
v_mfma_f32_16x16x32_bf16 v[112:115], v[88:91], v[24:27], v[112:115]
v_mfma_f32_16x16x32_bf16 v[112:115], v[92:95], v[28:31], v[112:115]
v_mfma_f32_16x16x32_bf16 v[132:135], v[92:95], v[36:39], v[132:135]
v_mfma_f32_16x16x32_bf16 v[132:135], v[88:91], v[32:35], v[132:135]
s_waitcnt lgkmcnt(0)
s_barrier
v_mfma_f32_16x16x32_bf16 v[136:139], v[56:59], v[40:43], v[136:139]
ds_read_b128 v[24:27], v1 offset:40960
s_add_u32 s28, s28, 128
v_mfma_f32_16x16x32_bf16 v[136:139], v[60:63], v[44:47], v[136:139]
ds_read_b128 v[28:31], v2 offset:40960
s_add_u32 s29, s29, s31
v_mfma_f32_16x16x32_bf16 v[156:159], v[60:63], v[52:55], v[156:159]
ds_read_b128 v[36:39], v2 offset:43008
s_add_u32 s30, s30, 393216
v_mfma_f32_16x16x32_bf16 v[156:159], v[56:59], v[48:51], v[156:159]
ds_read_b128 v[32:35], v1 offset:43008
v_mfma_f32_16x16x32_bf16 v[160:163], v[64:67], v[48:51], v[160:163]
s_add_u32 m0, s40, 32768
v_mfma_f32_16x16x32_bf16 v[160:163], v[68:71], v[52:55], v[160:163]
buffer_load_dwordx4 v6, s[8:11], s28 offen lds
v_mfma_f32_16x16x32_bf16 v[140:143], v[68:71], v[44:47], v[140:143]
v_mfma_f32_16x16x32_bf16 v[140:143], v[64:67], v[40:43], v[140:143]
v_mfma_f32_16x16x32_bf16 v[144:147], v[72:75], v[40:43], v[144:147]
s_cmp_eq_u32 s43, 5
s_cmov_b32 s98, 28672
s_cmov_b32 s101, 8192
v_mfma_f32_16x16x32_bf16 v[144:147], v[76:79], v[44:47], v[144:147]
s_add_u32 s41, s28, 262144
v_mfma_f32_16x16x32_bf16 v[164:167], v[76:79], v[52:55], v[164:167]
s_add_u32 m0, s40, 49152
v_mfma_f32_16x16x32_bf16 v[164:167], v[72:75], v[48:51], v[164:167]
buffer_load_dwordx4 v6, s[8:11], s41 offen lds
v_mfma_f32_16x16x32_bf16 v[168:171], v[80:83], v[48:51], v[168:171]
v_mfma_f32_16x16x32_bf16 v[168:171], v[84:87], v[52:55], v[168:171]
v_mfma_f32_16x16x32_bf16 v[148:151], v[84:87], v[44:47], v[148:151]
v_mfma_f32_16x16x32_bf16 v[148:151], v[80:83], v[40:43], v[148:151]
v_mfma_f32_16x16x32_bf16 v[152:155], v[88:91], v[40:43], v[152:155]
s_add_u32 m0, s35, 40960
v_mfma_f32_16x16x32_bf16 v[152:155], v[92:95], v[44:47], v[152:155]
buffer_load_dwordx4 v7, s[12:15], s29 offen lds
v_mfma_f32_16x16x32_bf16 v[172:175], v[92:95], v[52:55], v[172:175]
v_mfma_f32_16x16x32_bf16 v[172:175], v[88:91], v[48:51], v[172:175]
s_waitcnt lgkmcnt(3)
v_mfma_f32_16x16x32_bf16 v[176:179], v[56:59], v[24:27], v[176:179]
ds_read_b128 v[40:43], v1 offset:45056
s_waitcnt lgkmcnt(3)
v_mfma_f32_16x16x32_bf16 v[176:179], v[60:63], v[28:31], v[176:179]
ds_read_b128 v[44:47], v2 offset:45056
s_waitcnt lgkmcnt(3)
v_mfma_f32_16x16x32_bf16 v[196:199], v[60:63], v[36:39], v[196:199]
ds_read_b128 v[52:55], v2 offset:47104
s_waitcnt lgkmcnt(3)
v_mfma_f32_16x16x32_bf16 v[196:199], v[56:59], v[32:35], v[196:199]
ds_read_b128 v[48:51], v1 offset:47104
v_mfma_f32_16x16x32_bf16 v[200:203], v[64:67], v[32:35], v[200:203]
s_add_u32 s41, s29, s32
v_mfma_f32_16x16x32_bf16 v[200:203], v[68:71], v[36:39], v[200:203]
s_add_u32 m0, s36, 40960
v_mfma_f32_16x16x32_bf16 v[180:183], v[68:71], v[28:31], v[180:183]
buffer_load_dwordx4 v7, s[12:15], s41 offen lds
v_mfma_f32_16x16x32_bf16 v[180:183], v[64:67], v[24:27], v[180:183]
s_add_u32 s41, s29, s33
v_mfma_f32_16x16x32_bf16 v[184:187], v[72:75], v[24:27], v[184:187]
s_add_u32 m0, s37, 40960
v_mfma_f32_16x16x32_bf16 v[184:187], v[76:79], v[28:31], v[184:187]
buffer_load_dwordx4 v7, s[16:19], s41 offen lds
v_mfma_f32_16x16x32_bf16 v[204:207], v[76:79], v[36:39], v[204:207]
v_mfma_f32_16x16x32_bf16 v[204:207], v[72:75], v[32:35], v[204:207]
v_mfma_f32_16x16x32_bf16 v[208:211], v[80:83], v[32:35], v[208:211]
v_mfma_f32_16x16x32_bf16 v[208:211], v[84:87], v[36:39], v[208:211]
v_mfma_f32_16x16x32_bf16 v[188:191], v[84:87], v[28:31], v[188:191]
v_mfma_f32_16x16x32_bf16 v[188:191], v[80:83], v[24:27], v[188:191]
v_mfma_f32_16x16x32_bf16 v[192:195], v[88:91], v[24:27], v[192:195]
v_mfma_f32_16x16x32_bf16 v[192:195], v[92:95], v[28:31], v[192:195]
v_mfma_f32_16x16x32_bf16 v[212:215], v[92:95], v[36:39], v[212:215]
v_mfma_f32_16x16x32_bf16 v[212:215], v[88:91], v[32:35], v[212:215]
s_cmp_lt_u32 s100, s98
s_cbranch_scc1 L_pf_11
L_pfb_12:
s_cmp_eq_u32 s50, 1
s_cbranch_scc1 L_cs_13
L_csb_14:
s_waitcnt vmcnt(7) lgkmcnt(0)
s_barrier
v_mfma_f32_16x16x32_bf16 v[216:219], v[56:59], v[40:43], v[216:219]
ds_read_b128 v[24:27], v1 offset:0
v_mfma_f32_16x16x32_bf16 v[216:219], v[60:63], v[44:47], v[216:219]
ds_read_b128 v[28:31], v2 offset:0
s_cmp_eq_u32 s43, 0
s_cbranch_scc1 L_nc_16
L_ncb_17:
v_mfma_f32_16x16x32_bf16 v[236:239], v[60:63], v[52:55], v[236:239]
ds_read_b128 v[36:39], v2 offset:2048
s_add_u32 s42, s42, 1
v_mfma_f32_16x16x32_bf16 v[236:239], v[56:59], v[48:51], v[236:239]
ds_read_b128 v[32:35], v1 offset:2048
ds_read_b64_tr_b16 v[60:61], v3 offset:7168
v_mfma_f32_16x16x32_bf16 v[240:243], v[64:67], v[48:51], v[240:243]
ds_read_b64_tr_b16 v[62:63], v3 offset:8960
s_add_u32 s41, s29, s34
v_mfma_f32_16x16x32_bf16 v[240:243], v[68:71], v[52:55], v[240:243]
ds_read_b64_tr_b16 v[56:57], v3 offset:0
s_add_u32 m0, s38, 40960
v_mfma_f32_16x16x32_bf16 v[220:223], v[68:71], v[44:47], v[220:223]
ds_read_b64_tr_b16 v[58:59], v3 offset:1792
buffer_load_dwordx4 v7, s[16:19], s41 offen lds
v_mfma_f32_16x16x32_bf16 v[220:223], v[64:67], v[40:43], v[220:223]
ds_read_b64_tr_b16 v[68:69], v3 offset:21504
v_mfma_f32_16x16x32_bf16 v[224:227], v[72:75], v[40:43], v[224:227]
ds_read_b64_tr_b16 v[70:71], v3 offset:23296
v_mfma_f32_16x16x32_bf16 v[224:227], v[76:79], v[44:47], v[224:227]
ds_read_b64_tr_b16 v[64:65], v3 offset:14336
v_mfma_f32_16x16x32_bf16 v[244:247], v[76:79], v[52:55], v[244:247]
ds_read_b64_tr_b16 v[66:67], v3 offset:16128
v_mfma_f32_16x16x32_bf16 v[244:247], v[72:75], v[48:51], v[244:247]
ds_read_b64_tr_b16 v[76:77], v3 offset:7200
v_mfma_f32_16x16x32_bf16 v[248:251], v[80:83], v[48:51], v[248:251]
ds_read_b64_tr_b16 v[78:79], v3 offset:8992
v_mfma_f32_16x16x32_bf16 v[248:251], v[84:87], v[52:55], v[248:251]
ds_read_b64_tr_b16 v[72:73], v3 offset:32
v_mfma_f32_16x16x32_bf16 v[228:231], v[84:87], v[44:47], v[228:231]
ds_read_b64_tr_b16 v[74:75], v3 offset:1824
v_mfma_f32_16x16x32_bf16 v[228:231], v[80:83], v[40:43], v[228:231]
ds_read_b64_tr_b16 v[84:85], v3 offset:21536
v_mfma_f32_16x16x32_bf16 v[232:235], v[88:91], v[40:43], v[232:235]
ds_read_b64_tr_b16 v[86:87], v3 offset:23328
v_mfma_f32_16x16x32_bf16 v[232:235], v[92:95], v[44:47], v[232:235]
ds_read_b64_tr_b16 v[80:81], v3 offset:14368
v_mfma_f32_16x16x32_bf16 v[252:255], v[92:95], v[52:55], v[252:255]
ds_read_b64_tr_b16 v[82:83], v3 offset:16160
v_mfma_f32_16x16x32_bf16 v[252:255], v[88:91], v[48:51], v[252:255]
ds_read_b64_tr_b16 v[92:93], v4 offset:6144
.p2align 6
L_loop_20:
s_waitcnt lgkmcnt(13)
v_mfma_f32_16x16x32_bf16 v[96:99], v[56:59], v[24:27], v[96:99]
ds_read_b64_tr_b16 v[94:95], v4 offset:7680
v_mfma_f32_16x16x32_bf16 v[96:99], v[60:63], v[28:31], v[96:99]
ds_read_b64_tr_b16 v[88:89], v4 offset:0
v_mfma_f32_16x16x32_bf16 v[116:119], v[60:63], v[36:39], v[116:119]
ds_read_b64_tr_b16 v[90:91], v4 offset:1536
v_mfma_f32_16x16x32_bf16 v[116:119], v[56:59], v[32:35], v[116:119]
ds_read_b128 v[40:43], v1 offset:4096
s_add_u32 m0, s39, 40960
s_waitcnt lgkmcnt(13)
v_mfma_f32_16x16x32_bf16 v[120:123], v[64:67], v[32:35], v[120:123]
ds_read_b128 v[44:47], v2 offset:4096
buffer_load_dwordx4 v8, s[20:23], s30 offen lds
v_mfma_f32_16x16x32_bf16 v[120:123], v[68:71], v[36:39], v[120:123]
ds_read_b128 v[52:55], v2 offset:6144
v_mfma_f32_16x16x32_bf16 v[100:103], v[68:71], v[28:31], v[100:103]
ds_read_b128 v[48:51], v1 offset:6144
v_mfma_f32_16x16x32_bf16 v[100:103], v[64:67], v[24:27], v[100:103]
s_add_u32 s41, s28, 131072
s_waitcnt lgkmcnt(12)
v_mfma_f32_16x16x32_bf16 v[104:107], v[72:75], v[24:27], v[104:107]
s_add_u32 m0, s40, 40960
v_mfma_f32_16x16x32_bf16 v[104:107], v[76:79], v[28:31], v[104:107]
buffer_load_dwordx4 v6, s[8:11], s41 offen lds
v_mfma_f32_16x16x32_bf16 v[124:127], v[76:79], v[36:39], v[124:127]
v_mfma_f32_16x16x32_bf16 v[124:127], v[72:75], v[32:35], v[124:127]
s_waitcnt lgkmcnt(8)
v_mfma_f32_16x16x32_bf16 v[128:131], v[80:83], v[32:35], v[128:131]
s_add_u32 s41, s28, 393216
v_mfma_f32_16x16x32_bf16 v[128:131], v[84:87], v[36:39], v[128:131]
s_add_u32 m0, s40, 57344
v_mfma_f32_16x16x32_bf16 v[108:111], v[84:87], v[28:31], v[108:111]
buffer_load_dwordx4 v6, s[8:11], s41 offen lds
v_mfma_f32_16x16x32_bf16 v[108:111], v[80:83], v[24:27], v[108:111]
s_waitcnt lgkmcnt(4)
v_mfma_f32_16x16x32_bf16 v[112:115], v[88:91], v[24:27], v[112:115]
v_mfma_f32_16x16x32_bf16 v[112:115], v[92:95], v[28:31], v[112:115]
v_mfma_f32_16x16x32_bf16 v[132:135], v[92:95], v[36:39], v[132:135]
v_mfma_f32_16x16x32_bf16 v[132:135], v[88:91], v[32:35], v[132:135]
s_waitcnt vmcnt(9) lgkmcnt(0)
s_barrier
v_mfma_f32_16x16x32_bf16 v[136:139], v[56:59], v[40:43], v[136:139]
ds_read_b128 v[24:27], v1 offset:8192
s_add_u32 s28, s28, 128
v_mfma_f32_16x16x32_bf16 v[136:139], v[60:63], v[44:47], v[136:139]
ds_read_b128 v[28:31], v2 offset:8192
s_add_u32 s29, s29, s31
v_mfma_f32_16x16x32_bf16 v[156:159], v[60:63], v[52:55], v[156:159]
ds_read_b128 v[36:39], v2 offset:10240
s_add_u32 s30, s30, 393216
s_cmp_eq_u32 s49, s42
s_cbranch_scc1 L_rs_21
L_rsb_22:
s_cmp_eq_u32 s48, s42
s_cbranch_scc1 L_rw_23
L_rwb_24:
v_mfma_f32_16x16x32_bf16 v[156:159], v[56:59], v[48:51], v[156:159]
ds_read_b128 v[32:35], v1 offset:10240
v_mfma_f32_16x16x32_bf16 v[160:163], v[64:67], v[48:51], v[160:163]
s_add_u32 m0, s40, 0
v_mfma_f32_16x16x32_bf16 v[160:163], v[68:71], v[52:55], v[160:163]
buffer_load_dwordx4 v6, s[8:11], s28 offen lds
v_mfma_f32_16x16x32_bf16 v[140:143], v[68:71], v[44:47], v[140:143]
v_mfma_f32_16x16x32_bf16 v[140:143], v[64:67], v[40:43], v[140:143]
v_mfma_f32_16x16x32_bf16 v[144:147], v[72:75], v[40:43], v[144:147]
v_mfma_f32_16x16x32_bf16 v[144:147], v[76:79], v[44:47], v[144:147]
s_add_u32 s41, s28, 262144
v_mfma_f32_16x16x32_bf16 v[164:167], v[76:79], v[52:55], v[164:167]
s_add_u32 m0, s40, 16384
v_mfma_f32_16x16x32_bf16 v[164:167], v[72:75], v[48:51], v[164:167]
buffer_load_dwordx4 v6, s[8:11], s41 offen lds
v_mfma_f32_16x16x32_bf16 v[168:171], v[80:83], v[48:51], v[168:171]
v_mfma_f32_16x16x32_bf16 v[168:171], v[84:87], v[52:55], v[168:171]
v_mfma_f32_16x16x32_bf16 v[148:151], v[84:87], v[44:47], v[148:151]
v_mfma_f32_16x16x32_bf16 v[148:151], v[80:83], v[40:43], v[148:151]
v_mfma_f32_16x16x32_bf16 v[152:155], v[88:91], v[40:43], v[152:155]
s_mov_b32 m0, s35
v_mfma_f32_16x16x32_bf16 v[152:155], v[92:95], v[44:47], v[152:155]
buffer_load_dwordx4 v7, s[12:15], s29 offen lds
v_mfma_f32_16x16x32_bf16 v[172:175], v[92:95], v[52:55], v[172:175]
v_mfma_f32_16x16x32_bf16 v[172:175], v[88:91], v[48:51], v[172:175]
s_waitcnt lgkmcnt(3)
v_mfma_f32_16x16x32_bf16 v[176:179], v[56:59], v[24:27], v[176:179]
ds_read_b128 v[40:43], v1 offset:12288
s_waitcnt lgkmcnt(3)
v_mfma_f32_16x16x32_bf16 v[176:179], v[60:63], v[28:31], v[176:179]
ds_read_b128 v[44:47], v2 offset:12288
s_waitcnt lgkmcnt(3)
v_mfma_f32_16x16x32_bf16 v[196:199], v[60:63], v[36:39], v[196:199]
ds_read_b128 v[52:55], v2 offset:14336
s_waitcnt lgkmcnt(3)
v_mfma_f32_16x16x32_bf16 v[196:199], v[56:59], v[32:35], v[196:199]
ds_read_b128 v[48:51], v1 offset:14336
v_mfma_f32_16x16x32_bf16 v[200:203], v[64:67], v[32:35], v[200:203]
s_add_u32 s41, s29, s32
v_mfma_f32_16x16x32_bf16 v[200:203], v[68:71], v[36:39], v[200:203]
s_mov_b32 m0, s36
v_mfma_f32_16x16x32_bf16 v[180:183], v[68:71], v[28:31], v[180:183]
buffer_load_dwordx4 v7, s[12:15], s41 offen lds
v_mfma_f32_16x16x32_bf16 v[180:183], v[64:67], v[24:27], v[180:183]
s_add_u32 s41, s29, s33
v_mfma_f32_16x16x32_bf16 v[184:187], v[72:75], v[24:27], v[184:187]
s_mov_b32 m0, s37
v_mfma_f32_16x16x32_bf16 v[184:187], v[76:79], v[28:31], v[184:187]
buffer_load_dwordx4 v7, s[16:19], s41 offen lds
v_mfma_f32_16x16x32_bf16 v[204:207], v[76:79], v[36:39], v[204:207]
v_mfma_f32_16x16x32_bf16 v[204:207], v[72:75], v[32:35], v[204:207]
v_mfma_f32_16x16x32_bf16 v[208:211], v[80:83], v[32:35], v[208:211]
v_mfma_f32_16x16x32_bf16 v[208:211], v[84:87], v[36:39], v[208:211]
v_mfma_f32_16x16x32_bf16 v[188:191], v[84:87], v[28:31], v[188:191]
v_mfma_f32_16x16x32_bf16 v[188:191], v[80:83], v[24:27], v[188:191]
v_mfma_f32_16x16x32_bf16 v[192:195], v[88:91], v[24:27], v[192:195]
v_mfma_f32_16x16x32_bf16 v[192:195], v[92:95], v[28:31], v[192:195]
v_mfma_f32_16x16x32_bf16 v[212:215], v[92:95], v[36:39], v[212:215]
v_mfma_f32_16x16x32_bf16 v[212:215], v[88:91], v[32:35], v[212:215]
s_cmp_lt_u32 s100, s98
s_cbranch_scc1 L_pf_25
L_pfb_26:
s_cmp_eq_u32 s87, s42
s_cbranch_scc1 L_cs_27
L_csb_28:
s_waitcnt vmcnt(7) lgkmcnt(0)
s_barrier
v_mfma_f32_16x16x32_bf16 v[216:219], v[56:59], v[40:43], v[216:219]
ds_read_b128 v[24:27], v1 offset:32768
v_mfma_f32_16x16x32_bf16 v[216:219], v[60:63], v[44:47], v[216:219]
ds_read_b128 v[28:31], v2 offset:32768
s_cmp_eq_u32 s89, s42
s_cbranch_scc1 L_fl_30
L_flb_31:
v_mfma_f32_16x16x32_bf16 v[236:239], v[60:63], v[52:55], v[236:239]
ds_read_b128 v[36:39], v2 offset:34816
s_add_u32 s42, s42, 1
v_mfma_f32_16x16x32_bf16 v[236:239], v[56:59], v[48:51], v[236:239]
ds_read_b128 v[32:35], v1 offset:34816
ds_read_b64_tr_b16 v[60:61], v3 offset:48128
v_mfma_f32_16x16x32_bf16 v[240:243], v[64:67], v[48:51], v[240:243]
ds_read_b64_tr_b16 v[62:63], v3 offset:49920
s_add_u32 s41, s29, s34
v_mfma_f32_16x16x32_bf16 v[240:243], v[68:71], v[52:55], v[240:243]
ds_read_b64_tr_b16 v[56:57], v3 offset:40960
s_mov_b32 m0, s38
v_mfma_f32_16x16x32_bf16 v[220:223], v[68:71], v[44:47], v[220:223]
ds_read_b64_tr_b16 v[58:59], v3 offset:42752
buffer_load_dwordx4 v7, s[16:19], s41 offen lds
v_mfma_f32_16x16x32_bf16 v[220:223], v[64:67], v[40:43], v[220:223]
ds_read_b64_tr_b16 v[68:69], v3 offset:62464
v_mfma_f32_16x16x32_bf16 v[224:227], v[72:75], v[40:43], v[224:227]
ds_read_b64_tr_b16 v[70:71], v3 offset:64256
v_mfma_f32_16x16x32_bf16 v[224:227], v[76:79], v[44:47], v[224:227]
ds_read_b64_tr_b16 v[64:65], v3 offset:55296
v_mfma_f32_16x16x32_bf16 v[244:247], v[76:79], v[52:55], v[244:247]
ds_read_b64_tr_b16 v[66:67], v3 offset:57088
v_mfma_f32_16x16x32_bf16 v[244:247], v[72:75], v[48:51], v[244:247]
ds_read_b64_tr_b16 v[76:77], v3 offset:48160
v_mfma_f32_16x16x32_bf16 v[248:251], v[80:83], v[48:51], v[248:251]
ds_read_b64_tr_b16 v[78:79], v3 offset:49952
v_mfma_f32_16x16x32_bf16 v[248:251], v[84:87], v[52:55], v[248:251]
ds_read_b64_tr_b16 v[72:73], v3 offset:40992
v_mfma_f32_16x16x32_bf16 v[228:231], v[84:87], v[44:47], v[228:231]
ds_read_b64_tr_b16 v[74:75], v3 offset:42784
v_mfma_f32_16x16x32_bf16 v[228:231], v[80:83], v[40:43], v[228:231]
ds_read_b64_tr_b16 v[84:85], v3 offset:62496
v_mfma_f32_16x16x32_bf16 v[232:235], v[88:91], v[40:43], v[232:235]
ds_read_b64_tr_b16 v[86:87], v3 offset:64288
v_mfma_f32_16x16x32_bf16 v[232:235], v[92:95], v[44:47], v[232:235]
ds_read_b64_tr_b16 v[80:81], v3 offset:55328
v_mfma_f32_16x16x32_bf16 v[252:255], v[92:95], v[52:55], v[252:255]
ds_read_b64_tr_b16 v[82:83], v3 offset:57120
v_mfma_f32_16x16x32_bf16 v[252:255], v[88:91], v[48:51], v[252:255]
ds_read_b64_tr_b16 v[92:93], v4 offset:47104
s_waitcnt lgkmcnt(13)
v_mfma_f32_16x16x32_bf16 v[96:99], v[56:59], v[24:27], v[96:99]
ds_read_b64_tr_b16 v[94:95], v4 offset:48640
v_mfma_f32_16x16x32_bf16 v[96:99], v[60:63], v[28:31], v[96:99]
ds_read_b64_tr_b16 v[88:89], v4 offset:40960
v_mfma_f32_16x16x32_bf16 v[116:119], v[60:63], v[36:39], v[116:119]
ds_read_b64_tr_b16 v[90:91], v4 offset:42496
v_mfma_f32_16x16x32_bf16 v[116:119], v[56:59], v[32:35], v[116:119]
ds_read_b128 v[40:43], v1 offset:36864
s_mov_b32 m0, s39
s_waitcnt lgkmcnt(13)
v_mfma_f32_16x16x32_bf16 v[120:123], v[64:67], v[32:35], v[120:123]
ds_read_b128 v[44:47], v2 offset:36864
buffer_load_dwordx4 v8, s[20:23], s30 offen lds
v_mfma_f32_16x16x32_bf16 v[120:123], v[68:71], v[36:39], v[120:123]
ds_read_b128 v[52:55], v2 offset:38912
v_mfma_f32_16x16x32_bf16 v[100:103], v[68:71], v[28:31], v[100:103]
ds_read_b128 v[48:51], v1 offset:38912
v_mfma_f32_16x16x32_bf16 v[100:103], v[64:67], v[24:27], v[100:103]
s_add_u32 s41, s28, 131072
s_waitcnt lgkmcnt(12)
v_mfma_f32_16x16x32_bf16 v[104:107], v[72:75], v[24:27], v[104:107]
s_add_u32 m0, s40, 8192
v_mfma_f32_16x16x32_bf16 v[104:107], v[76:79], v[28:31], v[104:107]
buffer_load_dwordx4 v6, s[8:11], s41 offen lds
v_mfma_f32_16x16x32_bf16 v[124:127], v[76:79], v[36:39], v[124:127]
v_mfma_f32_16x16x32_bf16 v[124:127], v[72:75], v[32:35], v[124:127]
s_waitcnt lgkmcnt(8)
v_mfma_f32_16x16x32_bf16 v[128:131], v[80:83], v[32:35], v[128:131]
s_add_u32 s41, s28, 393216
v_mfma_f32_16x16x32_bf16 v[128:131], v[84:87], v[36:39], v[128:131]
s_add_u32 m0, s40, 24576
v_mfma_f32_16x16x32_bf16 v[108:111], v[84:87], v[28:31], v[108:111]
buffer_load_dwordx4 v6, s[8:11], s41 offen lds
v_mfma_f32_16x16x32_bf16 v[108:111], v[80:83], v[24:27], v[108:111]
s_waitcnt lgkmcnt(4)
v_mfma_f32_16x16x32_bf16 v[112:115], v[88:91], v[24:27], v[112:115]
v_mfma_f32_16x16x32_bf16 v[112:115], v[92:95], v[28:31], v[112:115]
v_mfma_f32_16x16x32_bf16 v[132:135], v[92:95], v[36:39], v[132:135]
v_mfma_f32_16x16x32_bf16 v[132:135], v[88:91], v[32:35], v[132:135]
s_waitcnt vmcnt(9) lgkmcnt(0)
s_barrier
v_mfma_f32_16x16x32_bf16 v[136:139], v[56:59], v[40:43], v[136:139]
ds_read_b128 v[24:27], v1 offset:40960
s_add_u32 s28, s28, 128
v_mfma_f32_16x16x32_bf16 v[136:139], v[60:63], v[44:47], v[136:139]
ds_read_b128 v[28:31], v2 offset:40960
s_add_u32 s29, s29, s31
v_mfma_f32_16x16x32_bf16 v[156:159], v[60:63], v[52:55], v[156:159]
ds_read_b128 v[36:39], v2 offset:43008
s_add_u32 s30, s30, 393216
s_cmp_eq_u32 s49, s42
s_cbranch_scc1 L_rs_32
L_rsb_33:
s_cmp_eq_u32 s48, s42
s_cbranch_scc1 L_rw_34
L_rwb_35:
s_cmp_eq_u32 s88, s42
s_cbranch_scc1 L_fs_36
L_fsb_37:
v_mfma_f32_16x16x32_bf16 v[156:159], v[56:59], v[48:51], v[156:159]
ds_read_b128 v[32:35], v1 offset:43008
v_mfma_f32_16x16x32_bf16 v[160:163], v[64:67], v[48:51], v[160:163]
s_add_u32 m0, s40, 32768
v_mfma_f32_16x16x32_bf16 v[160:163], v[68:71], v[52:55], v[160:163]
buffer_load_dwordx4 v6, s[8:11], s28 offen lds
v_mfma_f32_16x16x32_bf16 v[140:143], v[68:71], v[44:47], v[140:143]
v_mfma_f32_16x16x32_bf16 v[140:143], v[64:67], v[40:43], v[140:143]
v_mfma_f32_16x16x32_bf16 v[144:147], v[72:75], v[40:43], v[144:147]
v_mfma_f32_16x16x32_bf16 v[144:147], v[76:79], v[44:47], v[144:147]
s_add_u32 s41, s28, 262144
v_mfma_f32_16x16x32_bf16 v[164:167], v[76:79], v[52:55], v[164:167]
s_add_u32 m0, s40, 49152
v_mfma_f32_16x16x32_bf16 v[164:167], v[72:75], v[48:51], v[164:167]
buffer_load_dwordx4 v6, s[8:11], s41 offen lds
v_mfma_f32_16x16x32_bf16 v[168:171], v[80:83], v[48:51], v[168:171]
v_mfma_f32_16x16x32_bf16 v[168:171], v[84:87], v[52:55], v[168:171]
v_mfma_f32_16x16x32_bf16 v[148:151], v[84:87], v[44:47], v[148:151]
v_mfma_f32_16x16x32_bf16 v[148:151], v[80:83], v[40:43], v[148:151]
v_mfma_f32_16x16x32_bf16 v[152:155], v[88:91], v[40:43], v[152:155]
s_add_u32 m0, s35, 40960
v_mfma_f32_16x16x32_bf16 v[152:155], v[92:95], v[44:47], v[152:155]
buffer_load_dwordx4 v7, s[12:15], s29 offen lds
v_mfma_f32_16x16x32_bf16 v[172:175], v[92:95], v[52:55], v[172:175]
v_mfma_f32_16x16x32_bf16 v[172:175], v[88:91], v[48:51], v[172:175]
s_waitcnt lgkmcnt(3)
v_mfma_f32_16x16x32_bf16 v[176:179], v[56:59], v[24:27], v[176:179]
ds_read_b128 v[40:43], v1 offset:45056
s_waitcnt lgkmcnt(3)
v_mfma_f32_16x16x32_bf16 v[176:179], v[60:63], v[28:31], v[176:179]
ds_read_b128 v[44:47], v2 offset:45056
s_waitcnt lgkmcnt(3)
v_mfma_f32_16x16x32_bf16 v[196:199], v[60:63], v[36:39], v[196:199]
ds_read_b128 v[52:55], v2 offset:47104
s_waitcnt lgkmcnt(3)
v_mfma_f32_16x16x32_bf16 v[196:199], v[56:59], v[32:35], v[196:199]
ds_read_b128 v[48:51], v1 offset:47104
v_mfma_f32_16x16x32_bf16 v[200:203], v[64:67], v[32:35], v[200:203]
s_add_u32 s41, s29, s32
v_mfma_f32_16x16x32_bf16 v[200:203], v[68:71], v[36:39], v[200:203]
s_add_u32 m0, s36, 40960
v_mfma_f32_16x16x32_bf16 v[180:183], v[68:71], v[28:31], v[180:183]
buffer_load_dwordx4 v7, s[12:15], s41 offen lds
v_mfma_f32_16x16x32_bf16 v[180:183], v[64:67], v[24:27], v[180:183]
s_add_u32 s41, s29, s33
v_mfma_f32_16x16x32_bf16 v[184:187], v[72:75], v[24:27], v[184:187]
s_add_u32 m0, s37, 40960
v_mfma_f32_16x16x32_bf16 v[184:187], v[76:79], v[28:31], v[184:187]
buffer_load_dwordx4 v7, s[16:19], s41 offen lds
v_mfma_f32_16x16x32_bf16 v[204:207], v[76:79], v[36:39], v[204:207]
v_mfma_f32_16x16x32_bf16 v[204:207], v[72:75], v[32:35], v[204:207]
v_mfma_f32_16x16x32_bf16 v[208:211], v[80:83], v[32:35], v[208:211]
v_mfma_f32_16x16x32_bf16 v[208:211], v[84:87], v[36:39], v[208:211]
v_mfma_f32_16x16x32_bf16 v[188:191], v[84:87], v[28:31], v[188:191]
v_mfma_f32_16x16x32_bf16 v[188:191], v[80:83], v[24:27], v[188:191]
v_mfma_f32_16x16x32_bf16 v[192:195], v[88:91], v[24:27], v[192:195]
v_mfma_f32_16x16x32_bf16 v[192:195], v[92:95], v[28:31], v[192:195]
v_mfma_f32_16x16x32_bf16 v[212:215], v[92:95], v[36:39], v[212:215]
v_mfma_f32_16x16x32_bf16 v[212:215], v[88:91], v[32:35], v[212:215]
s_cmp_eq_u32 s50, s42
s_cbranch_scc1 L_cs_38
L_csb_39:
s_cmp_eq_u32 s51, s42
s_cbranch_scc1 L_cs_41
L_csb_42:
s_waitcnt vmcnt(7) lgkmcnt(0)
s_barrier
v_mfma_f32_16x16x32_bf16 v[216:219], v[56:59], v[40:43], v[216:219]
ds_read_b128 v[24:27], v1 offset:0
v_mfma_f32_16x16x32_bf16 v[216:219], v[60:63], v[44:47], v[216:219]
ds_read_b128 v[28:31], v2 offset:0
s_cmp_eq_u32 s89, s42
s_cbranch_scc1 L_fl_43
L_flb_44:
v_mfma_f32_16x16x32_bf16 v[236:239], v[60:63], v[52:55], v[236:239]
ds_read_b128 v[36:39], v2 offset:2048
s_add_u32 s42, s42, 1
v_mfma_f32_16x16x32_bf16 v[236:239], v[56:59], v[48:51], v[236:239]
ds_read_b128 v[32:35], v1 offset:2048
ds_read_b64_tr_b16 v[60:61], v3 offset:7168
v_mfma_f32_16x16x32_bf16 v[240:243], v[64:67], v[48:51], v[240:243]
ds_read_b64_tr_b16 v[62:63], v3 offset:8960
s_add_u32 s41, s29, s34
v_mfma_f32_16x16x32_bf16 v[240:243], v[68:71], v[52:55], v[240:243]
ds_read_b64_tr_b16 v[56:57], v3 offset:0
s_add_u32 m0, s38, 40960
v_mfma_f32_16x16x32_bf16 v[220:223], v[68:71], v[44:47], v[220:223]
ds_read_b64_tr_b16 v[58:59], v3 offset:1792
buffer_load_dwordx4 v7, s[16:19], s41 offen lds
v_mfma_f32_16x16x32_bf16 v[220:223], v[64:67], v[40:43], v[220:223]
ds_read_b64_tr_b16 v[68:69], v3 offset:21504
v_mfma_f32_16x16x32_bf16 v[224:227], v[72:75], v[40:43], v[224:227]
ds_read_b64_tr_b16 v[70:71], v3 offset:23296
v_mfma_f32_16x16x32_bf16 v[224:227], v[76:79], v[44:47], v[224:227]
ds_read_b64_tr_b16 v[64:65], v3 offset:14336
v_mfma_f32_16x16x32_bf16 v[244:247], v[76:79], v[52:55], v[244:247]
ds_read_b64_tr_b16 v[66:67], v3 offset:16128
v_mfma_f32_16x16x32_bf16 v[244:247], v[72:75], v[48:51], v[244:247]
ds_read_b64_tr_b16 v[76:77], v3 offset:7200
v_mfma_f32_16x16x32_bf16 v[248:251], v[80:83], v[48:51], v[248:251]
ds_read_b64_tr_b16 v[78:79], v3 offset:8992
v_mfma_f32_16x16x32_bf16 v[248:251], v[84:87], v[52:55], v[248:251]
ds_read_b64_tr_b16 v[72:73], v3 offset:32
v_mfma_f32_16x16x32_bf16 v[228:231], v[84:87], v[44:47], v[228:231]
ds_read_b64_tr_b16 v[74:75], v3 offset:1824
v_mfma_f32_16x16x32_bf16 v[228:231], v[80:83], v[40:43], v[228:231]
ds_read_b64_tr_b16 v[84:85], v3 offset:21536
v_mfma_f32_16x16x32_bf16 v[232:235], v[88:91], v[40:43], v[232:235]
ds_read_b64_tr_b16 v[86:87], v3 offset:23328
v_mfma_f32_16x16x32_bf16 v[232:235], v[92:95], v[44:47], v[232:235]
ds_read_b64_tr_b16 v[80:81], v3 offset:14368
v_mfma_f32_16x16x32_bf16 v[252:255], v[92:95], v[52:55], v[252:255]
ds_read_b64_tr_b16 v[82:83], v3 offset:16160
v_mfma_f32_16x16x32_bf16 v[252:255], v[88:91], v[48:51], v[252:255]
ds_read_b64_tr_b16 v[92:93], v4 offset:6144
s_cmp_lg_u32 s42, 14
s_cbranch_scc1 L_loop_20
s_waitcnt lgkmcnt(13)
v_mfma_f32_16x16x32_bf16 v[96:99], v[56:59], v[24:27], v[96:99]
ds_read_b64_tr_b16 v[94:95], v4 offset:7680
v_mfma_f32_16x16x32_bf16 v[96:99], v[60:63], v[28:31], v[96:99]
ds_read_b64_tr_b16 v[88:89], v4 offset:0
v_mfma_f32_16x16x32_bf16 v[116:119], v[60:63], v[36:39], v[116:119]
ds_read_b64_tr_b16 v[90:91], v4 offset:1536
v_mfma_f32_16x16x32_bf16 v[116:119], v[56:59], v[32:35], v[116:119]
ds_read_b128 v[40:43], v1 offset:4096
s_add_u32 m0, s39, 40960
s_waitcnt lgkmcnt(13)
v_mfma_f32_16x16x32_bf16 v[120:123], v[64:67], v[32:35], v[120:123]
ds_read_b128 v[44:47], v2 offset:4096
buffer_load_dwordx4 v8, s[20:23], s30 offen lds
v_mfma_f32_16x16x32_bf16 v[120:123], v[68:71], v[36:39], v[120:123]
ds_read_b128 v[52:55], v2 offset:6144
v_mfma_f32_16x16x32_bf16 v[100:103], v[68:71], v[28:31], v[100:103]
ds_read_b128 v[48:51], v1 offset:6144
v_mfma_f32_16x16x32_bf16 v[100:103], v[64:67], v[24:27], v[100:103]
s_add_u32 s41, s28, 131072
s_waitcnt lgkmcnt(12)
v_mfma_f32_16x16x32_bf16 v[104:107], v[72:75], v[24:27], v[104:107]
s_add_u32 m0, s40, 40960
v_mfma_f32_16x16x32_bf16 v[104:107], v[76:79], v[28:31], v[104:107]
buffer_load_dwordx4 v6, s[8:11], s41 offen lds
v_mfma_f32_16x16x32_bf16 v[124:127], v[76:79], v[36:39], v[124:127]
v_mfma_f32_16x16x32_bf16 v[124:127], v[72:75], v[32:35], v[124:127]
s_waitcnt lgkmcnt(8)
v_mfma_f32_16x16x32_bf16 v[128:131], v[80:83], v[32:35], v[128:131]
s_add_u32 s41, s28, 393216
v_mfma_f32_16x16x32_bf16 v[128:131], v[84:87], v[36:39], v[128:131]
s_add_u32 m0, s40, 57344
v_mfma_f32_16x16x32_bf16 v[108:111], v[84:87], v[28:31], v[108:111]
buffer_load_dwordx4 v6, s[8:11], s41 offen lds
v_mfma_f32_16x16x32_bf16 v[108:111], v[80:83], v[24:27], v[108:111]
s_waitcnt lgkmcnt(4)
v_mfma_f32_16x16x32_bf16 v[112:115], v[88:91], v[24:27], v[112:115]
v_mfma_f32_16x16x32_bf16 v[112:115], v[92:95], v[28:31], v[112:115]
v_mfma_f32_16x16x32_bf16 v[132:135], v[92:95], v[36:39], v[132:135]
v_mfma_f32_16x16x32_bf16 v[132:135], v[88:91], v[32:35], v[132:135]
s_waitcnt vmcnt(9) lgkmcnt(0)
s_barrier
v_mfma_f32_16x16x32_bf16 v[136:139], v[56:59], v[40:43], v[136:139]
ds_read_b128 v[24:27], v1 offset:8192
v_mfma_f32_16x16x32_bf16 v[136:139], v[60:63], v[44:47], v[136:139]
ds_read_b128 v[28:31], v2 offset:8192
v_mfma_f32_16x16x32_bf16 v[156:159], v[60:63], v[52:55], v[156:159]
ds_read_b128 v[36:39], v2 offset:10240
v_mfma_f32_16x16x32_bf16 v[156:159], v[56:59], v[48:51], v[156:159]
ds_read_b128 v[32:35], v1 offset:10240
v_mfma_f32_16x16x32_bf16 v[160:163], v[64:67], v[48:51], v[160:163]
v_mov_b32 v10, 152576
ds_read_b32 v10, v10
v_mfma_f32_16x16x32_bf16 v[160:163], v[68:71], v[52:55], v[160:163]
v_mfma_f32_16x16x32_bf16 v[140:143], v[68:71], v[44:47], v[140:143]
v_mfma_f32_16x16x32_bf16 v[140:143], v[64:67], v[40:43], v[140:143]
v_mfma_f32_16x16x32_bf16 v[144:147], v[72:75], v[40:43], v[144:147]
v_mfma_f32_16x16x32_bf16 v[144:147], v[76:79], v[44:47], v[144:147]
v_mfma_f32_16x16x32_bf16 v[164:167], v[76:79], v[52:55], v[164:167]
v_mfma_f32_16x16x32_bf16 v[164:167], v[72:75], v[48:51], v[164:167]
v_mfma_f32_16x16x32_bf16 v[168:171], v[80:83], v[48:51], v[168:171]
s_waitcnt lgkmcnt(0)
v_readfirstlane_b32 s86, v10
v_mfma_f32_16x16x32_bf16 v[168:171], v[84:87], v[52:55], v[168:171]
v_mfma_f32_16x16x32_bf16 v[148:151], v[84:87], v[44:47], v[148:151]
s_cmp_eq_u32 s43, 0
s_cbranch_scc1 L_li_45
L_lib_46:
v_mfma_f32_16x16x32_bf16 v[148:151], v[80:83], v[40:43], v[148:151]
v_mfma_f32_16x16x32_bf16 v[152:155], v[88:91], v[40:43], v[152:155]
v_mfma_f32_16x16x32_bf16 v[152:155], v[92:95], v[44:47], v[152:155]
v_mfma_f32_16x16x32_bf16 v[172:175], v[92:95], v[52:55], v[172:175]
v_mfma_f32_16x16x32_bf16 v[172:175], v[88:91], v[48:51], v[172:175]
v_mfma_f32_16x16x32_bf16 v[176:179], v[56:59], v[24:27], v[176:179]
ds_read_b128 v[40:43], v1 offset:12288
v_mfma_f32_16x16x32_bf16 v[176:179], v[60:63], v[28:31], v[176:179]
ds_read_b128 v[44:47], v2 offset:12288
v_mfma_f32_16x16x32_bf16 v[196:199], v[60:63], v[36:39], v[196:199]
ds_read_b128 v[52:55], v2 offset:14336
v_mfma_f32_16x16x32_bf16 v[196:199], v[56:59], v[32:35], v[196:199]
ds_read_b128 v[48:51], v1 offset:14336
v_mfma_f32_16x16x32_bf16 v[200:203], v[64:67], v[32:35], v[200:203]
v_mfma_f32_16x16x32_bf16 v[200:203], v[68:71], v[36:39], v[200:203]
v_mfma_f32_16x16x32_bf16 v[180:183], v[68:71], v[28:31], v[180:183]
v_mfma_f32_16x16x32_bf16 v[180:183], v[64:67], v[24:27], v[180:183]
v_mfma_f32_16x16x32_bf16 v[184:187], v[72:75], v[24:27], v[184:187]
v_mfma_f32_16x16x32_bf16 v[184:187], v[76:79], v[28:31], v[184:187]
v_mfma_f32_16x16x32_bf16 v[204:207], v[76:79], v[36:39], v[204:207]
v_mfma_f32_16x16x32_bf16 v[204:207], v[72:75], v[32:35], v[204:207]
v_mfma_f32_16x16x32_bf16 v[208:211], v[80:83], v[32:35], v[208:211]
v_mfma_f32_16x16x32_bf16 v[208:211], v[84:87], v[36:39], v[208:211]
v_mfma_f32_16x16x32_bf16 v[188:191], v[84:87], v[28:31], v[188:191]
v_mfma_f32_16x16x32_bf16 v[188:191], v[80:83], v[24:27], v[188:191]
v_mfma_f32_16x16x32_bf16 v[192:195], v[88:91], v[24:27], v[192:195]
v_mfma_f32_16x16x32_bf16 v[192:195], v[92:95], v[28:31], v[192:195]
v_mfma_f32_16x16x32_bf16 v[212:215], v[92:95], v[36:39], v[212:215]
v_mfma_f32_16x16x32_bf16 v[212:215], v[88:91], v[32:35], v[212:215]
s_cmp_eq_u32 s46, 0
s_cbranch_scc1 L_cs_47
L_csb_48:
s_cmp_eq_u32 s43, 0
s_cbranch_scc1 L_lc_49
L_lcb_50:
s_waitcnt vmcnt(0) lgkmcnt(0)
s_barrier
v_mfma_f32_16x16x32_bf16 v[216:219], v[56:59], v[40:43], v[216:219]
ds_read_b128 v[24:27], v1 offset:32768
v_mfma_f32_16x16x32_bf16 v[216:219], v[60:63], v[44:47], v[216:219]
ds_read_b128 v[28:31], v2 offset:32768
v_mfma_f32_16x16x32_bf16 v[236:239], v[60:63], v[52:55], v[236:239]
ds_read_b128 v[36:39], v2 offset:34816
s_add_u32 s42, s42, 1
v_mfma_f32_16x16x32_bf16 v[236:239], v[56:59], v[48:51], v[236:239]
ds_read_b128 v[32:35], v1 offset:34816
ds_read_b64_tr_b16 v[60:61], v3 offset:48128
s_mul_i32 s93, s47, 320
v_min_u32 v9, 39, v0
v_lshlrev_b32 v9, 3, v9
v_add_u32 v9, s93, v9
v_lshlrev_b32 v6, 4, v0
s_mov_b32 s12, s24
s_mov_b32 s13, s25
s_mov_b32 s15, 0x20000
s_cmp_eq_u32 s46, 1
s_cbranch_scc1 L_pc_54
L_pcb_55:
s_lshl_b32 s94, s43, 10
s_lshl_b32 s93, s44, 11
s_add_u32 s93, s93, s94
s_add_u32 s93, s93, 0x2f00000
s_cmp_lt_u32 s43, 2
s_cselect_b32 s14, s26, 0
s_cselect_b32 m0, s94, 152640
s_nop 0
buffer_load_dwordx4 v6, s[12:15], s93 offen sc1 lds
v_mfma_f32_16x16x32_bf16 v[240:243], v[64:67], v[48:51], v[240:243]
ds_read_b64_tr_b16 v[62:63], v3 offset:49920
v_mfma_f32_16x16x32_bf16 v[240:243], v[68:71], v[52:55], v[240:243]
ds_read_b64_tr_b16 v[56:57], v3 offset:40960
v_mfma_f32_16x16x32_bf16 v[220:223], v[68:71], v[44:47], v[220:223]
ds_read_b64_tr_b16 v[58:59], v3 offset:42752
v_mfma_f32_16x16x32_bf16 v[220:223], v[64:67], v[40:43], v[220:223]
ds_read_b64_tr_b16 v[68:69], v3 offset:62464
v_mfma_f32_16x16x32_bf16 v[224:227], v[72:75], v[40:43], v[224:227]
ds_read_b64_tr_b16 v[70:71], v3 offset:64256
v_mfma_f32_16x16x32_bf16 v[224:227], v[76:79], v[44:47], v[224:227]
ds_read_b64_tr_b16 v[64:65], v3 offset:55296
v_mfma_f32_16x16x32_bf16 v[244:247], v[76:79], v[52:55], v[244:247]
ds_read_b64_tr_b16 v[66:67], v3 offset:57088
v_mfma_f32_16x16x32_bf16 v[244:247], v[72:75], v[48:51], v[244:247]
ds_read_b64_tr_b16 v[76:77], v3 offset:48160
v_mfma_f32_16x16x32_bf16 v[248:251], v[80:83], v[48:51], v[248:251]
ds_read_b64_tr_b16 v[78:79], v3 offset:49952
v_mfma_f32_16x16x32_bf16 v[248:251], v[84:87], v[52:55], v[248:251]
ds_read_b64_tr_b16 v[72:73], v3 offset:40992
v_mfma_f32_16x16x32_bf16 v[228:231], v[84:87], v[44:47], v[228:231]
ds_read_b64_tr_b16 v[74:75], v3 offset:42784
v_mfma_f32_16x16x32_bf16 v[228:231], v[80:83], v[40:43], v[228:231]
ds_read_b64_tr_b16 v[84:85], v3 offset:62496
v_mfma_f32_16x16x32_bf16 v[232:235], v[88:91], v[40:43], v[232:235]
ds_read_b64_tr_b16 v[86:87], v3 offset:64288
v_mfma_f32_16x16x32_bf16 v[232:235], v[92:95], v[44:47], v[232:235]
ds_read_b64_tr_b16 v[80:81], v3 offset:55328
v_mfma_f32_16x16x32_bf16 v[252:255], v[92:95], v[52:55], v[252:255]
ds_read_b64_tr_b16 v[82:83], v3 offset:57120
v_mfma_f32_16x16x32_bf16 v[252:255], v[88:91], v[48:51], v[252:255]
ds_read_b64_tr_b16 v[92:93], v4 offset:47104
s_waitcnt lgkmcnt(13)
v_mfma_f32_16x16x32_bf16 v[96:99], v[56:59], v[24:27], v[96:99]
ds_read_b64_tr_b16 v[94:95], v4 offset:48640
v_mfma_f32_16x16x32_bf16 v[96:99], v[60:63], v[28:31], v[96:99]
ds_read_b64_tr_b16 v[88:89], v4 offset:40960
v_mfma_f32_16x16x32_bf16 v[116:119], v[60:63], v[36:39], v[116:119]
ds_read_b64_tr_b16 v[90:91], v4 offset:42496
v_mfma_f32_16x16x32_bf16 v[116:119], v[56:59], v[32:35], v[116:119]
ds_read_b128 v[40:43], v1 offset:36864
s_waitcnt lgkmcnt(13)
v_mfma_f32_16x16x32_bf16 v[120:123], v[64:67], v[32:35], v[120:123]
ds_read_b128 v[44:47], v2 offset:36864
v_mfma_f32_16x16x32_bf16 v[120:123], v[68:71], v[36:39], v[120:123]
ds_read_b128 v[52:55], v2 offset:38912
v_mfma_f32_16x16x32_bf16 v[100:103], v[68:71], v[28:31], v[100:103]
ds_read_b128 v[48:51], v1 offset:38912
v_mfma_f32_16x16x32_bf16 v[100:103], v[64:67], v[24:27], v[100:103]
s_waitcnt lgkmcnt(12)
v_mfma_f32_16x16x32_bf16 v[104:107], v[72:75], v[24:27], v[104:107]
v_mfma_f32_16x16x32_bf16 v[104:107], v[76:79], v[28:31], v[104:107]
v_mfma_f32_16x16x32_bf16 v[124:127], v[76:79], v[36:39], v[124:127]
v_mfma_f32_16x16x32_bf16 v[124:127], v[72:75], v[32:35], v[124:127]
s_waitcnt lgkmcnt(8)
v_mfma_f32_16x16x32_bf16 v[128:131], v[80:83], v[32:35], v[128:131]
v_mfma_f32_16x16x32_bf16 v[128:131], v[84:87], v[36:39], v[128:131]
v_mfma_f32_16x16x32_bf16 v[108:111], v[84:87], v[28:31], v[108:111]
v_mfma_f32_16x16x32_bf16 v[108:111], v[80:83], v[24:27], v[108:111]
s_waitcnt lgkmcnt(4)
v_mfma_f32_16x16x32_bf16 v[112:115], v[88:91], v[24:27], v[112:115]
v_mfma_f32_16x16x32_bf16 v[112:115], v[92:95], v[28:31], v[112:115]
v_mfma_f32_16x16x32_bf16 v[132:135], v[92:95], v[36:39], v[132:135]
v_mfma_f32_16x16x32_bf16 v[132:135], v[88:91], v[32:35], v[132:135]
s_cmp_eq_u32 s46, 0
s_cbranch_scc1 L_cs_56
L_csb_57:
s_waitcnt lgkmcnt(0)
s_barrier
v_mfma_f32_16x16x32_bf16 v[136:139], v[56:59], v[40:43], v[136:139]
ds_read_b128 v[24:27], v1 offset:40960
v_mfma_f32_16x16x32_bf16 v[136:139], v[60:63], v[44:47], v[136:139]
ds_read_b128 v[28:31], v2 offset:40960
v_mfma_f32_16x16x32_bf16 v[156:159], v[60:63], v[52:55], v[156:159]
ds_read_b128 v[36:39], v2 offset:43008
v_mfma_f32_16x16x32_bf16 v[156:159], v[56:59], v[48:51], v[156:159]
ds_read_b128 v[32:35], v1 offset:43008
v_mfma_f32_16x16x32_bf16 v[160:163], v[64:67], v[48:51], v[160:163]
v_add_u32 v7, 147456, v9
ds_read_b64 v[6:7], v7
v_mfma_f32_16x16x32_bf16 v[160:163], v[68:71], v[52:55], v[160:163]
v_mfma_f32_16x16x32_bf16 v[140:143], v[68:71], v[44:47], v[140:143]
v_mfma_f32_16x16x32_bf16 v[140:143], v[64:67], v[40:43], v[140:143]
v_mfma_f32_16x16x32_bf16 v[144:147], v[72:75], v[40:43], v[144:147]
v_mfma_f32_16x16x32_bf16 v[144:147], v[76:79], v[44:47], v[144:147]
v_mfma_f32_16x16x32_bf16 v[164:167], v[76:79], v[52:55], v[164:167]
v_mfma_f32_16x16x32_bf16 v[164:167], v[72:75], v[48:51], v[164:167]
v_mfma_f32_16x16x32_bf16 v[168:171], v[80:83], v[48:51], v[168:171]
v_mfma_f32_16x16x32_bf16 v[168:171], v[84:87], v[52:55], v[168:171]
v_mfma_f32_16x16x32_bf16 v[148:151], v[84:87], v[44:47], v[148:151]
v_mfma_f32_16x16x32_bf16 v[148:151], v[80:83], v[40:43], v[148:151]
v_mfma_f32_16x16x32_bf16 v[152:155], v[88:91], v[40:43], v[152:155]
v_mfma_f32_16x16x32_bf16 v[152:155], v[92:95], v[44:47], v[152:155]
v_mfma_f32_16x16x32_bf16 v[172:175], v[92:95], v[52:55], v[172:175]
v_mfma_f32_16x16x32_bf16 v[172:175], v[88:91], v[48:51], v[172:175]
s_waitcnt lgkmcnt(4)
v_mfma_f32_16x16x32_bf16 v[176:179], v[56:59], v[24:27], v[176:179]
ds_read_b128 v[40:43], v1 offset:45056
s_waitcnt lgkmcnt(4)
v_mfma_f32_16x16x32_bf16 v[176:179], v[60:63], v[28:31], v[176:179]
ds_read_b128 v[44:47], v2 offset:45056
s_waitcnt lgkmcnt(4)
v_mfma_f32_16x16x32_bf16 v[196:199], v[60:63], v[36:39], v[196:199]
ds_read_b128 v[52:55], v2 offset:47104
s_waitcnt lgkmcnt(4)
v_mfma_f32_16x16x32_bf16 v[196:199], v[56:59], v[32:35], v[196:199]
ds_read_b128 v[48:51], v1 offset:47104
v_mfma_f32_16x16x32_bf16 v[200:203], v[64:67], v[32:35], v[200:203]
v_mfma_f32_16x16x32_bf16 v[200:203], v[68:71], v[36:39], v[200:203]
v_mfma_f32_16x16x32_bf16 v[180:183], v[68:71], v[28:31], v[180:183]
s_waitcnt lgkmcnt(4)
s_cmp_eq_u32 s46, 1
s_cbranch_scc1 L_ps_59
L_psb_60:
v_mfma_f32_16x16x32_bf16 v[180:183], v[64:67], v[24:27], v[180:183]
v_mfma_f32_16x16x32_bf16 v[184:187], v[72:75], v[24:27], v[184:187]
v_mfma_f32_16x16x32_bf16 v[184:187], v[76:79], v[28:31], v[184:187]
v_mfma_f32_16x16x32_bf16 v[204:207], v[76:79], v[36:39], v[204:207]
v_mfma_f32_16x16x32_bf16 v[204:207], v[72:75], v[32:35], v[204:207]
v_mfma_f32_16x16x32_bf16 v[208:211], v[80:83], v[32:35], v[208:211]
v_mfma_f32_16x16x32_bf16 v[208:211], v[84:87], v[36:39], v[208:211]
v_mfma_f32_16x16x32_bf16 v[188:191], v[84:87], v[28:31], v[188:191]
v_mfma_f32_16x16x32_bf16 v[188:191], v[80:83], v[24:27], v[188:191]
v_mfma_f32_16x16x32_bf16 v[192:195], v[88:91], v[24:27], v[192:195]
v_mfma_f32_16x16x32_bf16 v[192:195], v[92:95], v[28:31], v[192:195]
v_mfma_f32_16x16x32_bf16 v[212:215], v[92:95], v[36:39], v[212:215]
v_mfma_f32_16x16x32_bf16 v[212:215], v[88:91], v[32:35], v[212:215]
s_waitcnt vmcnt(0) lgkmcnt(0)
s_barrier
v_mfma_f32_16x16x32_bf16 v[216:219], v[56:59], v[40:43], v[216:219]
v_and_b32 v1, 15, v0
v_lshlrev_b32 v1, 3, v1
s_lshl_b32 s93, s46, 10
v_add_u32 v1, s93, v1
ds_read_b64 v[24:25], v1 offset:0
ds_read_b64 v[26:27], v1 offset:128
ds_read_b64 v[28:29], v1 offset:256
ds_read_b64 v[30:31], v1 offset:384
ds_read_b64 v[32:33], v1 offset:512
ds_read_b64 v[34:35], v1 offset:640
ds_read_b64 v[36:37], v1 offset:768
ds_read_b64 v[38:39], v1 offset:896
v_lshrrev_b32 v22, 4, v0
v_lshlrev_b32 v22, 4, v22
v_add_u32 v22, 151296, v22
v_add_u32 v23, s90, v22
v_add_u32 v22, s91, v22
ds_read_b128 v[2:5], v23 offset:0
ds_read_b128 v[6:9], v23 offset:448
ds_read_b128 v[10:13], v23 offset:64
ds_read_b128 v[14:17], v23 offset:512
ds_read_b128 v[18:21], v22 offset:0
v_mfma_f32_16x16x32_bf16 v[216:219], v[60:63], v[44:47], v[216:219]
v_mfma_f32_16x16x32_bf16 v[236:239], v[60:63], v[52:55], v[236:239]
v_mfma_f32_16x16x32_bf16 v[236:239], v[56:59], v[48:51], v[236:239]
v_mfma_f32_16x16x32_bf16 v[240:243], v[64:67], v[48:51], v[240:243]
v_mfma_f32_16x16x32_bf16 v[240:243], v[68:71], v[52:55], v[240:243]
v_mfma_f32_16x16x32_bf16 v[220:223], v[68:71], v[44:47], v[220:223]
v_mfma_f32_16x16x32_bf16 v[220:223], v[64:67], v[40:43], v[220:223]
v_mfma_f32_16x16x32_bf16 v[224:227], v[72:75], v[40:43], v[224:227]
v_mfma_f32_16x16x32_bf16 v[224:227], v[76:79], v[44:47], v[224:227]
v_mfma_f32_16x16x32_bf16 v[244:247], v[76:79], v[52:55], v[244:247]
v_mfma_f32_16x16x32_bf16 v[244:247], v[72:75], v[48:51], v[244:247]
v_mfma_f32_16x16x32_bf16 v[248:251], v[80:83], v[48:51], v[248:251]
v_mfma_f32_16x16x32_bf16 v[248:251], v[84:87], v[52:55], v[248:251]
v_mfma_f32_16x16x32_bf16 v[228:231], v[84:87], v[44:47], v[228:231]
v_mfma_f32_16x16x32_bf16 v[228:231], v[80:83], v[40:43], v[228:231]
v_mfma_f32_16x16x32_bf16 v[232:235], v[88:91], v[40:43], v[232:235]
v_mfma_f32_16x16x32_bf16 v[232:235], v[92:95], v[44:47], v[232:235]
v_mfma_f32_16x16x32_bf16 v[252:255], v[92:95], v[52:55], v[252:255]
v_mfma_f32_16x16x32_bf16 v[252:255], v[88:91], v[48:51], v[252:255]
s_waitcnt lgkmcnt(0)
v_lshlrev_b32 v76, 3, v0
s_lshl_b32 s31, s44, 4
s_lshl_b32 s32, s46, 3
s_add_u32 s31, s31, s32
s_lshr_b32 s33, s45, 1
s_mul_i32 s33, s33, 7
s_and_b32 s34, s45, 1
s_lshl_b32 s35, s34, 2
s_add_u32 s33, s33, s35
s_add_u32 s33, s33, s47
s_mul_i32 s42, s31, 144
s_add_u32 s42, s42, s33
s_lshl_b32 s42, s42, 10
s_mov_b32 s12, s58
s_mov_b32 s13, s59
s_mov_b32 s15, 0x20000
s_cmp_eq_u32 s44, 7
s_cselect_b32 s14, 0, s26
s_lshl_b32 s35, s45, 7
s_add_u32 s35, s35, s31
s_lshl_b32 s35, s35, 10
s_lshl_b32 s37, s45, 1
s_add_u32 s37, s37, s47
s_sub_u32 s37, s37, 1
s_lshl_b32 s37, s37, 16
s_lshl_b32 s38, s31, 9
s_add_u32 s37, s37, s38
s_add_u32 s29, s37, 0x1a00000
s_lshl_b32 s38, s32, 10
s_add_u32 s38, s38, 131080
s_lshl_b32 s39, s47, 14
s_lshl_b32 s40, s32, 9
s_add_u32 s39, s39, s40
s_add_u32 s39, s39, 90112
v_and_b32 v77, 15, v0
v_lshlrev_b32 v77, 5, v77
v_lshrrev_b32 v40, 4, v0
v_lshl_add_u32 v77, v40, 3, v77
v_lshlrev_b32 v40, 4, v0
s_cmp_eq_u32 s47, 0
s_cselect_b32 s38, s38, s39
s_cmov_b32 s14, 0
s_mov_b32 s30, 512
s_cmov_b32 s30, 1024
s_cselect_b64 vcc, -1, 0
v_cndmask_b32 v40, v77, v40, vcc
v_add_u32 v40, s38, v40
v_lshlrev_b32 v42, 4, v0
v_mov_b32 v43, 0x7fff0000
s_add_u32 s42, s42, 1032192
s_setprio 2
v_rcp_f32 v68, v25
v_rcp_f32 v69, v27
v_pk_fma_f32 v[112:113], v[18:19], v[24:25], v[112:113] op_sel_hi:[1,0,1]
v_pk_fma_f32 v[114:115], v[20:21], v[24:25], v[114:115] op_sel_hi:[1,0,1]
v_pk_mul_f32 v[112:113], v[112:113], v[68:69] op_sel:[0,0] op_sel_hi:[1,0]
v_pk_mul_f32 v[114:115], v[114:115], v[68:69] op_sel:[0,0] op_sel_hi:[1,0]
v_pk_fma_f32 v[132:133], v[18:19], v[26:27], v[132:133] op_sel_hi:[1,0,1]
v_cvt_pk_bf16_f32 v112, v112, v113
v_rcp_f32 v70, v29
v_rcp_f32 v71, v31
v_pk_fma_f32 v[134:135], v[20:21], v[26:27], v[134:135] op_sel_hi:[1,0,1]
v_cvt_pk_bf16_f32 v113, v114, v115
v_pk_mul_f32 v[132:133], v[132:133], v[68:69] op_sel:[0,1] op_sel_hi:[1,1]
ds_write_b64 v40, v[112:113]
v_pk_mul_f32 v[134:135], v[134:135], v[68:69] op_sel:[0,1] op_sel_hi:[1,1]
v_pk_fma_f32 v[152:153], v[18:19], v[28:29], v[152:153] op_sel_hi:[1,0,1]
v_cvt_pk_bf16_f32 v132, v132, v133
v_pk_fma_f32 v[154:155], v[20:21], v[28:29], v[154:155] op_sel_hi:[1,0,1]
v_add_u32 v40, s30, v40
v_cvt_pk_bf16_f32 v133, v134, v135
v_pk_mul_f32 v[152:153], v[152:153], v[70:71] op_sel:[0,0] op_sel_hi:[1,0]
ds_write_b64 v40, v[132:133]
v_pk_mul_f32 v[154:155], v[154:155], v[70:71] op_sel:[0,0] op_sel_hi:[1,0]
v_pk_fma_f32 v[172:173], v[18:19], v[30:31], v[172:173] op_sel_hi:[1,0,1]
v_cvt_pk_bf16_f32 v152, v152, v153
v_rcp_f32 v72, v33
v_rcp_f32 v73, v35
v_pk_fma_f32 v[174:175], v[20:21], v[30:31], v[174:175] op_sel_hi:[1,0,1]
v_add_u32 v40, s30, v40
v_cvt_pk_bf16_f32 v153, v154, v155
v_pk_mul_f32 v[172:173], v[172:173], v[70:71] op_sel:[0,1] op_sel_hi:[1,1]
ds_write_b64 v40, v[152:153]
v_pk_mul_f32 v[174:175], v[174:175], v[70:71] op_sel:[0,1] op_sel_hi:[1,1]
v_pk_fma_f32 v[192:193], v[18:19], v[32:33], v[192:193] op_sel_hi:[1,0,1]
v_cvt_pk_bf16_f32 v172, v172, v173
buffer_store_dwordx2 v[112:113], v77, s[12:15], s29 offen sc1
v_pk_fma_f32 v[194:195], v[20:21], v[32:33], v[194:195] op_sel_hi:[1,0,1]
v_add_u32 v40, s30, v40
v_cvt_pk_bf16_f32 v173, v174, v175
v_pk_mul_f32 v[192:193], v[192:193], v[72:73] op_sel:[0,0] op_sel_hi:[1,0]
ds_write_b64 v40, v[172:173]
s_add_u32 s29, s29, s30
v_pk_mul_f32 v[194:195], v[194:195], v[72:73] op_sel:[0,0] op_sel_hi:[1,0]
v_pk_fma_f32 v[212:213], v[18:19], v[34:35], v[212:213] op_sel_hi:[1,0,1]
buffer_store_dwordx2 v[132:133], v77, s[12:15], s29 offen sc1
v_cvt_pk_bf16_f32 v192, v192, v193
v_rcp_f32 v74, v37
v_rcp_f32 v75, v39
v_pk_fma_f32 v[214:215], v[20:21], v[34:35], v[214:215] op_sel_hi:[1,0,1]
s_add_u32 s29, s29, s30
v_add_u32 v40, s30, v40
v_cvt_pk_bf16_f32 v193, v194, v195
v_pk_mul_f32 v[212:213], v[212:213], v[72:73] op_sel:[0,1] op_sel_hi:[1,1]
ds_write_b64 v40, v[192:193]
buffer_store_dwordx2 v[152:153], v77, s[12:15], s29 offen sc1
v_pk_mul_f32 v[214:215], v[214:215], v[72:73] op_sel:[0,1] op_sel_hi:[1,1]
v_pk_fma_f32 v[232:233], v[18:19], v[36:37], v[232:233] op_sel_hi:[1,0,1]
s_add_u32 s29, s29, s30
v_cvt_pk_bf16_f32 v212, v212, v213
v_pk_fma_f32 v[234:235], v[20:21], v[36:37], v[234:235] op_sel_hi:[1,0,1]
buffer_store_dwordx2 v[172:173], v77, s[12:15], s29 offen sc1
v_add_u32 v40, s30, v40
v_cvt_pk_bf16_f32 v213, v214, v215
v_pk_mul_f32 v[232:233], v[232:233], v[74:75] op_sel:[0,0] op_sel_hi:[1,0]
ds_write_b64 v40, v[212:213]
s_add_u32 s29, s29, s30
v_pk_mul_f32 v[234:235], v[234:235], v[74:75] op_sel:[0,0] op_sel_hi:[1,0]
v_pk_fma_f32 v[252:253], v[18:19], v[38:39], v[252:253] op_sel_hi:[1,0,1]
buffer_store_dwordx2 v[192:193], v77, s[12:15], s29 offen sc1
v_cvt_pk_bf16_f32 v232, v232, v233
v_pk_fma_f32 v[254:255], v[20:21], v[38:39], v[254:255] op_sel_hi:[1,0,1]
s_add_u32 s29, s29, s30
v_add_u32 v40, s30, v40
v_cvt_pk_bf16_f32 v233, v234, v235
v_pk_mul_f32 v[252:253], v[252:253], v[74:75] op_sel:[0,1] op_sel_hi:[1,1]
ds_write_b64 v40, v[232:233]
buffer_store_dwordx2 v[212:213], v77, s[12:15], s29 offen sc1
v_pk_mul_f32 v[254:255], v[254:255], v[74:75] op_sel:[0,1] op_sel_hi:[1,1]
v_cvt_pk_bf16_f32 v252, v252, v253
s_add_u32 s29, s29, s30
v_add_u32 v40, s30, v40
buffer_store_dwordx2 v[232:233], v77, s[12:15], s29 offen sc1
v_cvt_pk_bf16_f32 v253, v254, v255
s_add_u32 s29, s29, s30
ds_write_b64 v40, v[252:253]
buffer_store_dwordx2 v[252:253], v77, s[12:15], s29 offen sc1
v_add_u32 v40, s30, v40
s_add_u32 s29, s29, s30
s_setprio 0
v_mul_f32 v65, v75, v75
v_mul_f32 v64, 0xc0135761, v75
v_mul_f32 v65, 0x3d372713, v65
v_pk_fma_f32 v[236:237], v[2:3], v[38:39], v[236:237] op_sel_hi:[1,0,1]
v_pk_fma_f32 v[238:239], v[4:5], v[38:39], v[238:239] op_sel_hi:[1,0,1]
v_pk_fma_f32 v[244:245], v[10:11], v[38:39], v[244:245] op_sel_hi:[1,0,1]
v_pk_fma_f32 v[246:247], v[12:13], v[38:39], v[246:247] op_sel_hi:[1,0,1]
v_mul_f32 v65, v65, v64
v_pk_mul_f32 v[88:89], v[236:237], v[236:237]
v_pk_mul_f32 v[90:91], v[238:239], v[238:239]
v_pk_mul_f32 v[92:93], v[244:245], v[244:245]
v_pk_mul_f32 v[94:95], v[246:247], v[246:247]
v_pk_fma_f32 v[88:89], v[88:89], v[64:65], v[64:65] op_sel:[0,1,0] op_sel_hi:[1,1,0]
v_pk_fma_f32 v[90:91], v[90:91], v[64:65], v[64:65] op_sel:[0,1,0] op_sel_hi:[1,1,0]
v_pk_fma_f32 v[92:93], v[92:93], v[64:65], v[64:65] op_sel:[0,1,0] op_sel_hi:[1,1,0]
v_pk_fma_f32 v[94:95], v[94:95], v[64:65], v[64:65] op_sel:[0,1,0] op_sel_hi:[1,1,0]
v_pk_mul_f32 v[88:89], v[88:89], v[236:237]
v_pk_mul_f32 v[90:91], v[90:91], v[238:239]
v_pk_mul_f32 v[92:93], v[92:93], v[244:245]
v_pk_mul_f32 v[94:95], v[94:95], v[246:247]
v_exp_f32 v88, v88
v_exp_f32 v89, v89
v_exp_f32 v90, v90
v_exp_f32 v91, v91
v_exp_f32 v92, v92
v_exp_f32 v93, v93
v_exp_f32 v94, v94
v_exp_f32 v95, v95
v_mul_f32 v66, v39, v39
v_pk_fma_f32 v[240:241], v[6:7], v[38:39], v[240:241] op_sel_hi:[1,0,1]
v_pk_fma_f32 v[88:89], v[88:89], v[66:67], v[66:67] op_sel_hi:[1,0,0]
v_pk_fma_f32 v[90:91], v[90:91], v[66:67], v[66:67] op_sel_hi:[1,0,0]
v_pk_fma_f32 v[92:93], v[92:93], v[66:67], v[66:67] op_sel_hi:[1,0,0]
v_pk_fma_f32 v[94:95], v[94:95], v[66:67], v[66:67] op_sel_hi:[1,0,0]
v_pk_fma_f32 v[242:243], v[8:9], v[38:39], v[242:243] op_sel_hi:[1,0,1]
v_pk_fma_f32 v[248:249], v[14:15], v[38:39], v[248:249] op_sel_hi:[1,0,1]
v_pk_fma_f32 v[250:251], v[16:17], v[38:39], v[250:251] op_sel_hi:[1,0,1]
v_rcp_f32 v88, v88
v_rcp_f32 v89, v89
v_rcp_f32 v90, v90
v_rcp_f32 v91, v91
v_rcp_f32 v92, v92
v_rcp_f32 v93, v93
v_rcp_f32 v94, v94
v_rcp_f32 v95, v95
v_mul_f32 v61, v74, v74
v_mul_f32 v65, v73, v73
v_pk_mul_f32 v[236:237], v[236:237], v[240:241]
v_pk_mul_f32 v[238:239], v[238:239], v[242:243]
v_pk_mul_f32 v[244:245], v[244:245], v[248:249]
v_pk_mul_f32 v[246:247], v[246:247], v[250:251]
v_mul_f32 v60, 0xc0135761, v74
v_mul_f32 v61, 0x3d372713, v61
v_pk_fma_f32 v[216:217], v[2:3], v[36:37], v[216:217] op_sel_hi:[1,0,1]
v_pk_fma_f32 v[218:219], v[4:5], v[36:37], v[218:219] op_sel_hi:[1,0,1]
v_pk_fma_f32 v[224:225], v[10:11], v[36:37], v[224:225] op_sel_hi:[1,0,1]
v_pk_fma_f32 v[226:227], v[12:13], v[36:37], v[226:227] op_sel_hi:[1,0,1]
v_mul_f32 v64, 0xc0135761, v73
v_mul_f32 v65, 0x3d372713, v65
v_pk_fma_f32 v[196:197], v[2:3], v[34:35], v[196:197] op_sel_hi:[1,0,1]
v_pk_fma_f32 v[198:199], v[4:5], v[34:35], v[198:199] op_sel_hi:[1,0,1]
v_pk_fma_f32 v[204:205], v[10:11], v[34:35], v[204:205] op_sel_hi:[1,0,1]
v_pk_fma_f32 v[206:207], v[12:13], v[34:35], v[206:207] op_sel_hi:[1,0,1]
v_pk_mul_f32 v[236:237], v[236:237], v[88:89]
v_pk_mul_f32 v[238:239], v[238:239], v[90:91]
v_pk_mul_f32 v[244:245], v[244:245], v[92:93]
v_pk_mul_f32 v[246:247], v[246:247], v[94:95]
v_mul_f32 v61, v61, v60
v_pk_mul_f32 v[80:81], v[216:217], v[216:217]
v_pk_mul_f32 v[82:83], v[218:219], v[218:219]
v_pk_mul_f32 v[84:85], v[224:225], v[224:225]
v_pk_mul_f32 v[86:87], v[226:227], v[226:227]
v_mul_f32 v65, v65, v64
v_pk_mul_f32 v[88:89], v[196:197], v[196:197]
v_pk_mul_f32 v[90:91], v[198:199], v[198:199]
v_pk_mul_f32 v[92:93], v[204:205], v[204:205]
v_pk_mul_f32 v[94:95], v[206:207], v[206:207]
v_pk_fma_f32 v[80:81], v[80:81], v[60:61], v[60:61] op_sel:[0,1,0] op_sel_hi:[1,1,0]
v_pk_fma_f32 v[82:83], v[82:83], v[60:61], v[60:61] op_sel:[0,1,0] op_sel_hi:[1,1,0]
v_pk_fma_f32 v[84:85], v[84:85], v[60:61], v[60:61] op_sel:[0,1,0] op_sel_hi:[1,1,0]
v_pk_fma_f32 v[86:87], v[86:87], v[60:61], v[60:61] op_sel:[0,1,0] op_sel_hi:[1,1,0]
v_pk_fma_f32 v[88:89], v[88:89], v[64:65], v[64:65] op_sel:[0,1,0] op_sel_hi:[1,1,0]
v_pk_fma_f32 v[90:91], v[90:91], v[64:65], v[64:65] op_sel:[0,1,0] op_sel_hi:[1,1,0]
v_pk_fma_f32 v[92:93], v[92:93], v[64:65], v[64:65] op_sel:[0,1,0] op_sel_hi:[1,1,0]
v_pk_fma_f32 v[94:95], v[94:95], v[64:65], v[64:65] op_sel:[0,1,0] op_sel_hi:[1,1,0]
v_pk_mul_f32 v[80:81], v[80:81], v[216:217]
v_pk_mul_f32 v[82:83], v[82:83], v[218:219]
v_pk_mul_f32 v[84:85], v[84:85], v[224:225]
v_pk_mul_f32 v[86:87], v[86:87], v[226:227]
v_pk_mul_f32 v[88:89], v[88:89], v[196:197]
v_pk_mul_f32 v[90:91], v[90:91], v[198:199]
v_pk_mul_f32 v[92:93], v[92:93], v[204:205]
v_pk_mul_f32 v[94:95], v[94:95], v[206:207]
v_exp_f32 v80, v80
v_exp_f32 v81, v81
v_exp_f32 v82, v82
v_exp_f32 v83, v83
v_exp_f32 v84, v84
v_exp_f32 v85, v85
v_exp_f32 v86, v86
v_exp_f32 v87, v87
v_exp_f32 v88, v88
v_exp_f32 v89, v89
v_exp_f32 v90, v90
v_exp_f32 v91, v91
v_exp_f32 v92, v92
v_exp_f32 v93, v93
v_exp_f32 v94, v94
v_exp_f32 v95, v95
v_mul_f32 v62, v37, v37
v_mul_f32 v66, v35, v35
v_pk_fma_f32 v[80:81], v[80:81], v[62:63], v[62:63] op_sel_hi:[1,0,0]
v_pk_fma_f32 v[82:83], v[82:83], v[62:63], v[62:63] op_sel_hi:[1,0,0]
v_pk_fma_f32 v[84:85], v[84:85], v[62:63], v[62:63] op_sel_hi:[1,0,0]
v_pk_fma_f32 v[86:87], v[86:87], v[62:63], v[62:63] op_sel_hi:[1,0,0]
v_pk_fma_f32 v[88:89], v[88:89], v[66:67], v[66:67] op_sel_hi:[1,0,0]
v_pk_fma_f32 v[90:91], v[90:91], v[66:67], v[66:67] op_sel_hi:[1,0,0]
v_pk_fma_f32 v[92:93], v[92:93], v[66:67], v[66:67] op_sel_hi:[1,0,0]
v_pk_fma_f32 v[94:95], v[94:95], v[66:67], v[66:67] op_sel_hi:[1,0,0]
v_pk_fma_f32 v[220:221], v[6:7], v[36:37], v[220:221] op_sel_hi:[1,0,1]
v_pk_fma_f32 v[222:223], v[8:9], v[36:37], v[222:223] op_sel_hi:[1,0,1]
v_pk_fma_f32 v[228:229], v[14:15], v[36:37], v[228:229] op_sel_hi:[1,0,1]
v_pk_fma_f32 v[230:231], v[16:17], v[36:37], v[230:231] op_sel_hi:[1,0,1]
v_rcp_f32 v80, v80
v_rcp_f32 v81, v81
v_rcp_f32 v82, v82
v_rcp_f32 v83, v83
v_rcp_f32 v84, v84
v_rcp_f32 v85, v85
v_rcp_f32 v86, v86
v_rcp_f32 v87, v87
v_pk_fma_f32 v[200:201], v[6:7], v[34:35], v[200:201] op_sel_hi:[1,0,1]
v_pk_fma_f32 v[202:203], v[8:9], v[34:35], v[202:203] op_sel_hi:[1,0,1]
v_pk_fma_f32 v[208:209], v[14:15], v[34:35], v[208:209] op_sel_hi:[1,0,1]
v_pk_fma_f32 v[210:211], v[16:17], v[34:35], v[210:211] op_sel_hi:[1,0,1]
v_rcp_f32 v88, v88
v_rcp_f32 v89, v89
v_rcp_f32 v90, v90
v_rcp_f32 v91, v91
v_rcp_f32 v92, v92
v_rcp_f32 v93, v93
v_rcp_f32 v94, v94
v_rcp_f32 v95, v95
v_pk_mul_f32 v[216:217], v[216:217], v[220:221]
v_pk_mul_f32 v[218:219], v[218:219], v[222:223]
v_pk_mul_f32 v[224:225], v[224:225], v[228:229]
v_pk_mul_f32 v[226:227], v[226:227], v[230:231]
v_pk_mul_f32 v[196:197], v[196:197], v[200:201]
v_pk_mul_f32 v[198:199], v[198:199], v[202:203]
v_pk_mul_f32 v[204:205], v[204:205], v[208:209]
v_pk_mul_f32 v[206:207], v[206:207], v[210:211]
v_pk_mul_f32 v[216:217], v[216:217], v[80:81]
v_pk_mul_f32 v[218:219], v[218:219], v[82:83]
v_pk_mul_f32 v[224:225], v[224:225], v[84:85]
v_pk_mul_f32 v[226:227], v[226:227], v[86:87]
v_pk_mul_f32 v[196:197], v[196:197], v[88:89]
v_pk_mul_f32 v[198:199], v[198:199], v[90:91]
v_pk_mul_f32 v[204:205], v[204:205], v[92:93]
v_pk_mul_f32 v[206:207], v[206:207], v[94:95]
v_cvt_pk_bf16_f32 v254, v244, v245
v_cvt_pk_bf16_f32 v255, v246, v247
v_cvt_pk_bf16_f32 v252, v236, v237
v_cvt_pk_bf16_f32 v253, v238, v239
v_cvt_pk_bf16_f32 v248, v216, v217
v_cvt_pk_bf16_f32 v249, v218, v219
v_cvt_pk_bf16_f32 v250, v224, v225
v_cvt_pk_bf16_f32 v251, v226, v227
v_cvt_pk_bf16_f32 v244, v196, v197
v_cvt_pk_bf16_f32 v245, v198, v199
v_cvt_pk_bf16_f32 v246, v204, v205
v_cvt_pk_bf16_f32 v247, v206, v207
s_waitcnt vmcnt(0) lgkmcnt(0)
s_barrier
s_cmp_lg_u32 s43, 0
s_cbranch_scc1 L_wf_61
s_lshl_b32 s93, s44, 12
s_lshl_b32 s94, s45, 7
s_add_u32 s93, s93, s94
s_add_u32 s93, s93, 0x2f70000
v_mov_b32 v40, s86
buffer_store_dword v40, off, s[24:27], s93 sc1
L_wf_61:
v_mul_f32 v61, v72, v72
v_mul_f32 v65, v71, v71
v_mul_f32 v60, 0xc0135761, v72
v_mul_f32 v61, 0x3d372713, v61
v_pk_fma_f32 v[176:177], v[2:3], v[32:33], v[176:177] op_sel_hi:[1,0,1]
v_pk_fma_f32 v[178:179], v[4:5], v[32:33], v[178:179] op_sel_hi:[1,0,1]
v_pk_fma_f32 v[184:185], v[10:11], v[32:33], v[184:185] op_sel_hi:[1,0,1]
v_pk_fma_f32 v[186:187], v[12:13], v[32:33], v[186:187] op_sel_hi:[1,0,1]
v_mul_f32 v64, 0xc0135761, v71
v_mul_f32 v65, 0x3d372713, v65
v_pk_fma_f32 v[156:157], v[2:3], v[30:31], v[156:157] op_sel_hi:[1,0,1]
v_pk_fma_f32 v[158:159], v[4:5], v[30:31], v[158:159] op_sel_hi:[1,0,1]
v_pk_fma_f32 v[164:165], v[10:11], v[30:31], v[164:165] op_sel_hi:[1,0,1]
v_pk_fma_f32 v[166:167], v[12:13], v[30:31], v[166:167] op_sel_hi:[1,0,1]
v_mul_f32 v61, v61, v60
v_pk_mul_f32 v[80:81], v[176:177], v[176:177]
v_pk_mul_f32 v[82:83], v[178:179], v[178:179]
v_pk_mul_f32 v[84:85], v[184:185], v[184:185]
v_pk_mul_f32 v[86:87], v[186:187], v[186:187]
v_mul_f32 v65, v65, v64
v_pk_mul_f32 v[88:89], v[156:157], v[156:157]
v_pk_mul_f32 v[90:91], v[158:159], v[158:159]
v_pk_mul_f32 v[92:93], v[164:165], v[164:165]
v_pk_mul_f32 v[94:95], v[166:167], v[166:167]
v_pk_fma_f32 v[80:81], v[80:81], v[60:61], v[60:61] op_sel:[0,1,0] op_sel_hi:[1,1,0]
v_pk_fma_f32 v[82:83], v[82:83], v[60:61], v[60:61] op_sel:[0,1,0] op_sel_hi:[1,1,0]
v_pk_fma_f32 v[84:85], v[84:85], v[60:61], v[60:61] op_sel:[0,1,0] op_sel_hi:[1,1,0]
v_pk_fma_f32 v[86:87], v[86:87], v[60:61], v[60:61] op_sel:[0,1,0] op_sel_hi:[1,1,0]
v_pk_fma_f32 v[88:89], v[88:89], v[64:65], v[64:65] op_sel:[0,1,0] op_sel_hi:[1,1,0]
v_pk_fma_f32 v[90:91], v[90:91], v[64:65], v[64:65] op_sel:[0,1,0] op_sel_hi:[1,1,0]
v_pk_fma_f32 v[92:93], v[92:93], v[64:65], v[64:65] op_sel:[0,1,0] op_sel_hi:[1,1,0]
v_pk_fma_f32 v[94:95], v[94:95], v[64:65], v[64:65] op_sel:[0,1,0] op_sel_hi:[1,1,0]
v_pk_mul_f32 v[80:81], v[80:81], v[176:177]
v_pk_mul_f32 v[82:83], v[82:83], v[178:179]
v_pk_mul_f32 v[84:85], v[84:85], v[184:185]
v_pk_mul_f32 v[86:87], v[86:87], v[186:187]
v_pk_mul_f32 v[88:89], v[88:89], v[156:157]
v_pk_mul_f32 v[90:91], v[90:91], v[158:159]
v_pk_mul_f32 v[92:93], v[92:93], v[164:165]
v_pk_mul_f32 v[94:95], v[94:95], v[166:167]
v_exp_f32 v80, v80
v_exp_f32 v81, v81
v_exp_f32 v82, v82
v_exp_f32 v83, v83
v_exp_f32 v84, v84
v_exp_f32 v85, v85
v_exp_f32 v86, v86
v_exp_f32 v87, v87
v_exp_f32 v88, v88
v_exp_f32 v89, v89
v_exp_f32 v90, v90
v_exp_f32 v91, v91
v_exp_f32 v92, v92
v_exp_f32 v93, v93
v_exp_f32 v94, v94
v_exp_f32 v95, v95
v_mul_f32 v62, v33, v33
v_mul_f32 v66, v31, v31
v_pk_fma_f32 v[80:81], v[80:81], v[62:63], v[62:63] op_sel_hi:[1,0,0]
v_pk_fma_f32 v[82:83], v[82:83], v[62:63], v[62:63] op_sel_hi:[1,0,0]
v_pk_fma_f32 v[84:85], v[84:85], v[62:63], v[62:63] op_sel_hi:[1,0,0]
v_pk_fma_f32 v[86:87], v[86:87], v[62:63], v[62:63] op_sel_hi:[1,0,0]
v_pk_fma_f32 v[88:89], v[88:89], v[66:67], v[66:67] op_sel_hi:[1,0,0]
v_pk_fma_f32 v[90:91], v[90:91], v[66:67], v[66:67] op_sel_hi:[1,0,0]
v_pk_fma_f32 v[92:93], v[92:93], v[66:67], v[66:67] op_sel_hi:[1,0,0]
v_pk_fma_f32 v[94:95], v[94:95], v[66:67], v[66:67] op_sel_hi:[1,0,0]
v_pk_fma_f32 v[180:181], v[6:7], v[32:33], v[180:181] op_sel_hi:[1,0,1]
v_pk_fma_f32 v[182:183], v[8:9], v[32:33], v[182:183] op_sel_hi:[1,0,1]
v_pk_fma_f32 v[188:189], v[14:15], v[32:33], v[188:189] op_sel_hi:[1,0,1]
v_pk_fma_f32 v[190:191], v[16:17], v[32:33], v[190:191] op_sel_hi:[1,0,1]
v_rcp_f32 v80, v80
v_rcp_f32 v81, v81
v_rcp_f32 v82, v82
v_rcp_f32 v83, v83
v_rcp_f32 v84, v84
v_rcp_f32 v85, v85
v_rcp_f32 v86, v86
v_rcp_f32 v87, v87
v_pk_fma_f32 v[160:161], v[6:7], v[30:31], v[160:161] op_sel_hi:[1,0,1]
v_pk_fma_f32 v[162:163], v[8:9], v[30:31], v[162:163] op_sel_hi:[1,0,1]
v_pk_fma_f32 v[168:169], v[14:15], v[30:31], v[168:169] op_sel_hi:[1,0,1]
v_pk_fma_f32 v[170:171], v[16:17], v[30:31], v[170:171] op_sel_hi:[1,0,1]
v_rcp_f32 v88, v88
v_rcp_f32 v89, v89
v_rcp_f32 v90, v90
v_rcp_f32 v91, v91
v_rcp_f32 v92, v92
v_rcp_f32 v93, v93
v_rcp_f32 v94, v94
v_rcp_f32 v95, v95
v_pk_mul_f32 v[176:177], v[176:177], v[180:181]
v_pk_mul_f32 v[178:179], v[178:179], v[182:183]
v_pk_mul_f32 v[184:185], v[184:185], v[188:189]
v_pk_mul_f32 v[186:187], v[186:187], v[190:191]
v_pk_mul_f32 v[156:157], v[156:157], v[160:161]
v_pk_mul_f32 v[158:159], v[158:159], v[162:163]
v_pk_mul_f32 v[164:165], v[164:165], v[168:169]
v_pk_mul_f32 v[166:167], v[166:167], v[170:171]
v_pk_mul_f32 v[176:177], v[176:177], v[80:81]
v_pk_mul_f32 v[178:179], v[178:179], v[82:83]
v_pk_mul_f32 v[184:185], v[184:185], v[84:85]
v_pk_mul_f32 v[186:187], v[186:187], v[86:87]
v_pk_mul_f32 v[156:157], v[156:157], v[88:89]
v_pk_mul_f32 v[158:159], v[158:159], v[90:91]
v_pk_mul_f32 v[164:165], v[164:165], v[92:93]
v_pk_mul_f32 v[166:167], v[166:167], v[94:95]
v_cvt_pk_bf16_f32 v240, v176, v177
v_cvt_pk_bf16_f32 v241, v178, v179
v_cvt_pk_bf16_f32 v242, v184, v185
v_cvt_pk_bf16_f32 v243, v186, v187
v_cvt_pk_bf16_f32 v236, v156, v157
v_cvt_pk_bf16_f32 v237, v158, v159
v_cvt_pk_bf16_f32 v238, v164, v165
v_cvt_pk_bf16_f32 v239, v166, v167
s_lshl_b32 s35, s44, 12
s_lshl_b32 s94, s45, 7
s_add_u32 s35, s35, s94
s_add_u32 s35, s35, 0x2f6f000
buffer_load_dword v185, off, s[24:27], s35 sc1
v_mul_f32 v61, v70, v70
v_mul_f32 v65, v69, v69
v_mul_f32 v60, 0xc0135761, v70
v_mul_f32 v61, 0x3d372713, v61
v_pk_fma_f32 v[136:137], v[2:3], v[28:29], v[136:137] op_sel_hi:[1,0,1]
v_pk_fma_f32 v[138:139], v[4:5], v[28:29], v[138:139] op_sel_hi:[1,0,1]
v_pk_fma_f32 v[144:145], v[10:11], v[28:29], v[144:145] op_sel_hi:[1,0,1]
v_pk_fma_f32 v[146:147], v[12:13], v[28:29], v[146:147] op_sel_hi:[1,0,1]
v_mul_f32 v64, 0xc0135761, v69
v_mul_f32 v65, 0x3d372713, v65
v_pk_fma_f32 v[116:117], v[2:3], v[26:27], v[116:117] op_sel_hi:[1,0,1]
v_pk_fma_f32 v[118:119], v[4:5], v[26:27], v[118:119] op_sel_hi:[1,0,1]
v_pk_fma_f32 v[124:125], v[10:11], v[26:27], v[124:125] op_sel_hi:[1,0,1]
v_pk_fma_f32 v[126:127], v[12:13], v[26:27], v[126:127] op_sel_hi:[1,0,1]
v_mul_f32 v61, v61, v60
v_pk_mul_f32 v[80:81], v[136:137], v[136:137]
v_pk_mul_f32 v[82:83], v[138:139], v[138:139]
v_pk_mul_f32 v[84:85], v[144:145], v[144:145]
v_pk_mul_f32 v[86:87], v[146:147], v[146:147]
v_mul_f32 v65, v65, v64
v_pk_mul_f32 v[88:89], v[116:117], v[116:117]
v_pk_mul_f32 v[90:91], v[118:119], v[118:119]
v_pk_mul_f32 v[92:93], v[124:125], v[124:125]
v_pk_mul_f32 v[94:95], v[126:127], v[126:127]
v_pk_fma_f32 v[80:81], v[80:81], v[60:61], v[60:61] op_sel:[0,1,0] op_sel_hi:[1,1,0]
v_pk_fma_f32 v[82:83], v[82:83], v[60:61], v[60:61] op_sel:[0,1,0] op_sel_hi:[1,1,0]
v_pk_fma_f32 v[84:85], v[84:85], v[60:61], v[60:61] op_sel:[0,1,0] op_sel_hi:[1,1,0]
v_pk_fma_f32 v[86:87], v[86:87], v[60:61], v[60:61] op_sel:[0,1,0] op_sel_hi:[1,1,0]
v_pk_fma_f32 v[88:89], v[88:89], v[64:65], v[64:65] op_sel:[0,1,0] op_sel_hi:[1,1,0]
v_pk_fma_f32 v[90:91], v[90:91], v[64:65], v[64:65] op_sel:[0,1,0] op_sel_hi:[1,1,0]
v_pk_fma_f32 v[92:93], v[92:93], v[64:65], v[64:65] op_sel:[0,1,0] op_sel_hi:[1,1,0]
v_pk_fma_f32 v[94:95], v[94:95], v[64:65], v[64:65] op_sel:[0,1,0] op_sel_hi:[1,1,0]
v_pk_mul_f32 v[80:81], v[80:81], v[136:137]
v_pk_mul_f32 v[82:83], v[82:83], v[138:139]
v_pk_mul_f32 v[84:85], v[84:85], v[144:145]
v_pk_mul_f32 v[86:87], v[86:87], v[146:147]
v_pk_mul_f32 v[88:89], v[88:89], v[116:117]
v_pk_mul_f32 v[90:91], v[90:91], v[118:119]
v_pk_mul_f32 v[92:93], v[92:93], v[124:125]
v_pk_mul_f32 v[94:95], v[94:95], v[126:127]
v_exp_f32 v80, v80
v_exp_f32 v81, v81
v_exp_f32 v82, v82
v_exp_f32 v83, v83
v_exp_f32 v84, v84
v_exp_f32 v85, v85
v_exp_f32 v86, v86
v_exp_f32 v87, v87
v_exp_f32 v88, v88
v_exp_f32 v89, v89
v_exp_f32 v90, v90
v_exp_f32 v91, v91
v_exp_f32 v92, v92
v_exp_f32 v93, v93
v_exp_f32 v94, v94
v_exp_f32 v95, v95
v_mul_f32 v62, v29, v29
v_mul_f32 v66, v27, v27
v_pk_fma_f32 v[80:81], v[80:81], v[62:63], v[62:63] op_sel_hi:[1,0,0]
v_pk_fma_f32 v[82:83], v[82:83], v[62:63], v[62:63] op_sel_hi:[1,0,0]
v_pk_fma_f32 v[84:85], v[84:85], v[62:63], v[62:63] op_sel_hi:[1,0,0]
v_pk_fma_f32 v[86:87], v[86:87], v[62:63], v[62:63] op_sel_hi:[1,0,0]
v_pk_fma_f32 v[88:89], v[88:89], v[66:67], v[66:67] op_sel_hi:[1,0,0]
v_pk_fma_f32 v[90:91], v[90:91], v[66:67], v[66:67] op_sel_hi:[1,0,0]
v_pk_fma_f32 v[92:93], v[92:93], v[66:67], v[66:67] op_sel_hi:[1,0,0]
v_pk_fma_f32 v[94:95], v[94:95], v[66:67], v[66:67] op_sel_hi:[1,0,0]
v_pk_fma_f32 v[140:141], v[6:7], v[28:29], v[140:141] op_sel_hi:[1,0,1]
v_pk_fma_f32 v[142:143], v[8:9], v[28:29], v[142:143] op_sel_hi:[1,0,1]
v_pk_fma_f32 v[148:149], v[14:15], v[28:29], v[148:149] op_sel_hi:[1,0,1]
v_pk_fma_f32 v[150:151], v[16:17], v[28:29], v[150:151] op_sel_hi:[1,0,1]
v_rcp_f32 v80, v80
v_rcp_f32 v81, v81
v_rcp_f32 v82, v82
v_rcp_f32 v83, v83
v_rcp_f32 v84, v84
v_rcp_f32 v85, v85
v_rcp_f32 v86, v86
v_rcp_f32 v87, v87
v_pk_fma_f32 v[120:121], v[6:7], v[26:27], v[120:121] op_sel_hi:[1,0,1]
v_pk_fma_f32 v[122:123], v[8:9], v[26:27], v[122:123] op_sel_hi:[1,0,1]
v_pk_fma_f32 v[128:129], v[14:15], v[26:27], v[128:129] op_sel_hi:[1,0,1]
v_pk_fma_f32 v[130:131], v[16:17], v[26:27], v[130:131] op_sel_hi:[1,0,1]
v_rcp_f32 v88, v88
v_rcp_f32 v89, v89
v_rcp_f32 v90, v90
v_rcp_f32 v91, v91
v_rcp_f32 v92, v92
v_rcp_f32 v93, v93
v_rcp_f32 v94, v94
v_rcp_f32 v95, v95
v_pk_mul_f32 v[136:137], v[136:137], v[140:141]
v_pk_mul_f32 v[138:139], v[138:139], v[142:143]
v_pk_mul_f32 v[144:145], v[144:145], v[148:149]
v_pk_mul_f32 v[146:147], v[146:147], v[150:151]
v_pk_mul_f32 v[116:117], v[116:117], v[120:121]
v_pk_mul_f32 v[118:119], v[118:119], v[122:123]
v_pk_mul_f32 v[124:125], v[124:125], v[128:129]
v_pk_mul_f32 v[126:127], v[126:127], v[130:131]
v_pk_mul_f32 v[136:137], v[136:137], v[80:81]
v_pk_mul_f32 v[138:139], v[138:139], v[82:83]
v_pk_mul_f32 v[144:145], v[144:145], v[84:85]
v_pk_mul_f32 v[146:147], v[146:147], v[86:87]
v_pk_mul_f32 v[116:117], v[116:117], v[88:89]
v_pk_mul_f32 v[118:119], v[118:119], v[90:91]
v_pk_mul_f32 v[124:125], v[124:125], v[92:93]
v_pk_mul_f32 v[126:127], v[126:127], v[94:95]
v_cvt_pk_bf16_f32 v232, v136, v137
v_cvt_pk_bf16_f32 v233, v138, v139
v_cvt_pk_bf16_f32 v234, v144, v145
v_cvt_pk_bf16_f32 v235, v146, v147
v_cvt_pk_bf16_f32 v228, v116, v117
v_cvt_pk_bf16_f32 v229, v118, v119
v_cvt_pk_bf16_f32 v230, v124, v125
v_cvt_pk_bf16_f32 v231, v126, v127
s_cmp_lt_u32 s43, 4
s_cbranch_scc1 L_kv_62
L_kvb_63:
v_mul_f32 v61, v68, v68
v_mul_f32 v60, 0xc0135761, v68
v_mul_f32 v61, 0x3d372713, v61
v_pk_fma_f32 v[96:97], v[2:3], v[24:25], v[96:97] op_sel_hi:[1,0,1]
v_pk_fma_f32 v[98:99], v[4:5], v[24:25], v[98:99] op_sel_hi:[1,0,1]
v_pk_fma_f32 v[104:105], v[10:11], v[24:25], v[104:105] op_sel_hi:[1,0,1]
v_pk_fma_f32 v[106:107], v[12:13], v[24:25], v[106:107] op_sel_hi:[1,0,1]
v_mul_f32 v61, v61, v60
v_pk_mul_f32 v[80:81], v[96:97], v[96:97]
v_pk_mul_f32 v[82:83], v[98:99], v[98:99]
v_pk_mul_f32 v[84:85], v[104:105], v[104:105]
v_pk_mul_f32 v[86:87], v[106:107], v[106:107]
v_pk_fma_f32 v[80:81], v[80:81], v[60:61], v[60:61] op_sel:[0,1,0] op_sel_hi:[1,1,0]
v_pk_fma_f32 v[82:83], v[82:83], v[60:61], v[60:61] op_sel:[0,1,0] op_sel_hi:[1,1,0]
v_pk_fma_f32 v[84:85], v[84:85], v[60:61], v[60:61] op_sel:[0,1,0] op_sel_hi:[1,1,0]
v_pk_fma_f32 v[86:87], v[86:87], v[60:61], v[60:61] op_sel:[0,1,0] op_sel_hi:[1,1,0]
v_pk_mul_f32 v[80:81], v[80:81], v[96:97]
v_pk_mul_f32 v[82:83], v[82:83], v[98:99]
v_pk_mul_f32 v[84:85], v[84:85], v[104:105]
v_pk_mul_f32 v[86:87], v[86:87], v[106:107]
v_exp_f32 v80, v80
v_exp_f32 v81, v81
v_exp_f32 v82, v82
v_exp_f32 v83, v83
v_exp_f32 v84, v84
v_exp_f32 v85, v85
v_exp_f32 v86, v86
v_exp_f32 v87, v87
v_mul_f32 v62, v25, v25
v_pk_fma_f32 v[100:101], v[6:7], v[24:25], v[100:101] op_sel_hi:[1,0,1]
v_pk_fma_f32 v[80:81], v[80:81], v[62:63], v[62:63] op_sel_hi:[1,0,0]
v_pk_fma_f32 v[82:83], v[82:83], v[62:63], v[62:63] op_sel_hi:[1,0,0]
v_pk_fma_f32 v[84:85], v[84:85], v[62:63], v[62:63] op_sel_hi:[1,0,0]
v_pk_fma_f32 v[86:87], v[86:87], v[62:63], v[62:63] op_sel_hi:[1,0,0]
v_pk_fma_f32 v[102:103], v[8:9], v[24:25], v[102:103] op_sel_hi:[1,0,1]
v_pk_fma_f32 v[108:109], v[14:15], v[24:25], v[108:109] op_sel_hi:[1,0,1]
v_pk_fma_f32 v[110:111], v[16:17], v[24:25], v[110:111] op_sel_hi:[1,0,1]
v_rcp_f32 v80, v80
v_rcp_f32 v81, v81
v_rcp_f32 v82, v82
v_rcp_f32 v83, v83
v_rcp_f32 v84, v84
v_rcp_f32 v85, v85
v_rcp_f32 v86, v86
v_rcp_f32 v87, v87
v_pk_mul_f32 v[96:97], v[96:97], v[100:101]
v_pk_mul_f32 v[98:99], v[98:99], v[102:103]
v_pk_mul_f32 v[104:105], v[104:105], v[108:109]
v_pk_mul_f32 v[106:107], v[106:107], v[110:111]
buffer_store_dwordx4 v[252:255], v42, s[24:27], s42 offen sc1
v_pk_mul_f32 v[96:97], v[96:97], v[80:81]
v_pk_mul_f32 v[98:99], v[98:99], v[82:83]
v_pk_mul_f32 v[104:105], v[104:105], v[84:85]
v_pk_mul_f32 v[106:107], v[106:107], v[86:87]
s_sub_u32 s42, s42, 147456
v_cvt_pk_bf16_f32 v224, v96, v97
buffer_store_dwordx4 v[248:251], v42, s[24:27], s42 offen sc1
v_cvt_pk_bf16_f32 v225, v98, v99
v_cvt_pk_bf16_f32 v226, v104, v105
v_cvt_pk_bf16_f32 v227, v106, v107
s_sub_u32 s42, s42, 147456
v_mov_b32 v14, v42
v_mov_b32 v15, v43
v_lshlrev_b32 v7, 4, v0
v_lshlrev_b32 v3, 3, v0
s_lshl_b32 s31, s43, 1
s_lshl_b32 s35, s44, 4
s_add_u32 s35, s35, s31
s_mul_i32 s35, s35, 144
s_add_u32 s35, s35, s45
s_add_u32 s35, s35, 112
s_lshl_b32 s35, s35, 10
s_sub_u32 s34, 16, s31
s_cmp_eq_u32 s44, 0
s_cselect_b32 s34, s34, 0
s_lshl_b32 s31, s31, 10
s_add_u32 s36, s31, 65536
v_lshlrev_b32 v4, 4, v0
v_add_u32 v2, s36, v4
s_add_u32 s36, s31, 131072
v_add_u32 v4, s36, v4
s_cmp_lt_u32 s43, 4
s_cbranch_scc1 L_ap_67
s_setprio 1
L_ap_67:
s_lshr_b32 s31, s31, 1
s_add_u32 s36, s31, 98304
v_add_u32 v3, s36, v3
v_and_b32 v5, 15, v0
v_lshrrev_b32 v6, 4, v0
v_lshlrev_b32 v6, 2, v6
v_cmp_le_u32 s[96:97], v6, v5
v_add_u32 v6, 1, v6
v_cmp_le_u32 s[98:99], v6, v5
v_add_u32 v6, 1, v6
v_cmp_le_u32 s[100:101], v6, v5
v_add_u32 v6, 1, v6
v_cmp_le_u32 s[32:33], v6, v5
v_mov_b32 v184, 0x3e8293ee
v_mov_b32 v82, 0
v_mov_b32 v83, 0
v_mov_b32 v86, 0
v_mov_b32 v87, 0
v_mov_b32 v162, 0
v_mov_b32 v163, 0
v_mov_b32 v176, 0x3f803f80
v_mov_b32 v177, 0x3f803f80
v_mov_b32 v178, 0x3f803f80
v_mov_b32 v179, 0x3f803f80
s_cmp_lt_u32 s43, 4
s_cbranch_scc1 L_nw_68
L_nwb_69:
s_barrier
s_branch L_join_5
L_nl_6:
v_mov_b32 v5, 0
global_load_dword v5, v5, s[56:57] offset:128 sc1
s_branch L_nlb_7
L_cs_8:
v_and_b32 v10, 15, v0
v_mov_b32 v11, s92
v_cmp_eq_u32 vcc, 0, v10
s_nop 1
v_cndmask_b32 v16, 0, v11, vcc
v_mov_b32 v17, v16
v_mov_b32 v18, v16
v_mov_b32 v19, v16
v_mov_b32_dpp v20, v16 row_shr:1 row_mask:0xf bank_mask:0xf bound_ctrl:0
v_mov_b32_dpp v21, v17 row_shr:1 row_mask:0xf bank_mask:0xf bound_ctrl:0
v_mov_b32_dpp v22, v18 row_shr:1 row_mask:0xf bank_mask:0xf bound_ctrl:0
v_mov_b32_dpp v23, v19 row_shr:1 row_mask:0xf bank_mask:0xf bound_ctrl:0
v_mfma_f32_16x16x32_bf16 v[12:15], v[56:59], v[16:19], 0
v_mfma_f32_16x16x32_bf16 v[12:15], v[60:63], v[16:19], v[12:15]
v_mov_b32_dpp v16, v20 row_shr:1 row_mask:0xf bank_mask:0xf bound_ctrl:0
v_mov_b32_dpp v17, v21 row_shr:1 row_mask:0xf bank_mask:0xf bound_ctrl:0
v_mov_b32_dpp v18, v22 row_shr:1 row_mask:0xf bank_mask:0xf bound_ctrl:0
v_mov_b32_dpp v19, v23 row_shr:1 row_mask:0xf bank_mask:0xf bound_ctrl:0
v_mfma_f32_16x16x32_bf16 v[12:15], v[64:67], v[20:23], v[12:15]
v_mfma_f32_16x16x32_bf16 v[12:15], v[68:71], v[20:23], v[12:15]
v_mov_b32_dpp v20, v16 row_shr:1 row_mask:0xf bank_mask:0xf bound_ctrl:0
v_mov_b32_dpp v21, v17 row_shr:1 row_mask:0xf bank_mask:0xf bound_ctrl:0
v_mov_b32_dpp v22, v18 row_shr:1 row_mask:0xf bank_mask:0xf bound_ctrl:0
v_mov_b32_dpp v23, v19 row_shr:1 row_mask:0xf bank_mask:0xf bound_ctrl:0
v_mfma_f32_16x16x32_bf16 v[12:15], v[72:75], v[16:19], v[12:15]
v_mfma_f32_16x16x32_bf16 v[12:15], v[76:79], v[16:19], v[12:15]
v_mov_b32_dpp v16, v20 row_shr:1 row_mask:0xf bank_mask:0xf bound_ctrl:0
v_mov_b32_dpp v17, v21 row_shr:1 row_mask:0xf bank_mask:0xf bound_ctrl:0
v_mov_b32_dpp v18, v22 row_shr:1 row_mask:0xf bank_mask:0xf bound_ctrl:0
v_mov_b32_dpp v19, v23 row_shr:1 row_mask:0xf bank_mask:0xf bound_ctrl:0
v_mfma_f32_16x16x32_bf16 v[12:15], v[80:83], v[20:23], v[12:15]
v_mfma_f32_16x16x32_bf16 v[12:15], v[84:87], v[20:23], v[12:15]
v_mfma_f32_16x16x32_bf16 v[12:15], v[88:91], v[16:19], v[12:15]
v_mfma_f32_16x16x32_bf16 v[12:15], v[92:95], v[16:19], v[12:15]
s_cmp_lg_u32 s44, 6
s_cbranch_scc1 L_cx_10
v_mov_b32 v11, 2147418112
s_add_u32 s93, s90, 0
v_cmp_eq_u32 vcc, 0, v10
v_mov_b32 v9, s93
s_nop 0
v_cndmask_b32 v11, v11, v9, vcc
s_add_u32 s93, s90, 448
v_cmp_eq_u32 vcc, 1, v10
v_mov_b32 v9, s93
s_nop 0
v_cndmask_b32 v11, v11, v9, vcc
s_add_u32 s93, s90, 64
v_cmp_eq_u32 vcc, 2, v10
v_mov_b32 v9, s93
s_nop 0
v_cndmask_b32 v11, v11, v9, vcc
s_add_u32 s93, s90, 512
v_cmp_eq_u32 vcc, 3, v10
v_mov_b32 v9, s93
s_nop 0
v_cndmask_b32 v11, v11, v9, vcc
s_add_u32 s93, s91, 0
v_cmp_eq_u32 vcc, 4, v10
v_mov_b32 v9, s93
s_nop 0
v_cndmask_b32 v11, v11, v9, vcc
v_lshrrev_b32 v10, 4, v0
v_lshl_add_u32 v11, v10, 4, v11
s_lshl_b32 s93, s45, 3
s_add_u32 s93, s93, s44
s_mul_i32 s93, s93, 1280
s_add_u32 s93, s93, 0x2f10000
buffer_store_dwordx4 v[12:15], v11, s[24:27], s93 offen sc1
L_cx_10:
s_branch L_csb_9
L_pf_11:
v_bfe_u32 v9, v0, 1, 2
v_mul_u32_u24 v9, s0, v9
v_lshrrev_b32 v23, 3, v0
v_min_u32 v23, s3, v23
v_mul_u32_u24 v23, s1, v23
v_add3_u32 v9, v9, v23, 56
v_and_b32 v23, 1, v0
s_mov_b32 m0, 152640
v_lshl_add_u32 v9, v23, 7, v9
buffer_load_dwordx4 v9, s[96:99], s100 offen lds
s_add_u32 s100, s100, s101
s_lshl_b32 s93, s2, 13
s_add_u32 s93, s84, s93
s_addc_u32 s94, s85, 0
s_cmp_eq_u32 s100, 32768
s_cmov_b32 s96, s93
s_cmov_b32 s97, s94
s_cmov_b32 s98, 8192
s_cmov_b32 s100, 0
s_cmov_b32 s101, 65536
s_branch L_pfb_12
L_cs_13:
v_and_b32 v10, 15, v0
v_mov_b32 v11, s92
v_cmp_eq_u32 vcc, 0, v10
s_nop 1
v_cndmask_b32 v16, 0, v11, vcc
v_mov_b32 v17, v16
v_mov_b32 v18, v16
v_mov_b32 v19, v16
v_mov_b32_dpp v20, v16 row_shr:1 row_mask:0xf bank_mask:0xf bound_ctrl:0
v_mov_b32_dpp v21, v17 row_shr:1 row_mask:0xf bank_mask:0xf bound_ctrl:0
v_mov_b32_dpp v22, v18 row_shr:1 row_mask:0xf bank_mask:0xf bound_ctrl:0
v_mov_b32_dpp v23, v19 row_shr:1 row_mask:0xf bank_mask:0xf bound_ctrl:0
v_mfma_f32_16x16x32_bf16 v[12:15], v[56:59], v[16:19], v[12:15]
v_mfma_f32_16x16x32_bf16 v[12:15], v[60:63], v[16:19], v[12:15]
v_mov_b32_dpp v16, v20 row_shr:1 row_mask:0xf bank_mask:0xf bound_ctrl:0
v_mov_b32_dpp v17, v21 row_shr:1 row_mask:0xf bank_mask:0xf bound_ctrl:0
v_mov_b32_dpp v18, v22 row_shr:1 row_mask:0xf bank_mask:0xf bound_ctrl:0
v_mov_b32_dpp v19, v23 row_shr:1 row_mask:0xf bank_mask:0xf bound_ctrl:0
v_mfma_f32_16x16x32_bf16 v[12:15], v[64:67], v[20:23], v[12:15]
v_mfma_f32_16x16x32_bf16 v[12:15], v[68:71], v[20:23], v[12:15]
v_mov_b32_dpp v20, v16 row_shr:1 row_mask:0xf bank_mask:0xf bound_ctrl:0
v_mov_b32_dpp v21, v17 row_shr:1 row_mask:0xf bank_mask:0xf bound_ctrl:0
v_mov_b32_dpp v22, v18 row_shr:1 row_mask:0xf bank_mask:0xf bound_ctrl:0
v_mov_b32_dpp v23, v19 row_shr:1 row_mask:0xf bank_mask:0xf bound_ctrl:0
v_mfma_f32_16x16x32_bf16 v[12:15], v[72:75], v[16:19], v[12:15]
v_mfma_f32_16x16x32_bf16 v[12:15], v[76:79], v[16:19], v[12:15]
v_mov_b32_dpp v16, v20 row_shr:1 row_mask:0xf bank_mask:0xf bound_ctrl:0
v_mov_b32_dpp v17, v21 row_shr:1 row_mask:0xf bank_mask:0xf bound_ctrl:0
v_mov_b32_dpp v18, v22 row_shr:1 row_mask:0xf bank_mask:0xf bound_ctrl:0
v_mov_b32_dpp v19, v23 row_shr:1 row_mask:0xf bank_mask:0xf bound_ctrl:0
v_mfma_f32_16x16x32_bf16 v[12:15], v[80:83], v[20:23], v[12:15]
v_mfma_f32_16x16x32_bf16 v[12:15], v[84:87], v[20:23], v[12:15]
v_mfma_f32_16x16x32_bf16 v[12:15], v[88:91], v[16:19], v[12:15]
v_mfma_f32_16x16x32_bf16 v[12:15], v[92:95], v[16:19], v[12:15]
v_mov_b32 v11, 2147418112
s_add_u32 s93, s90, 0
v_cmp_eq_u32 vcc, 0, v10
v_mov_b32 v9, s93
s_nop 0
v_cndmask_b32 v11, v11, v9, vcc
s_add_u32 s93, s90, 448
v_cmp_eq_u32 vcc, 1, v10
v_mov_b32 v9, s93
s_nop 0
v_cndmask_b32 v11, v11, v9, vcc
s_add_u32 s93, s90, 64
v_cmp_eq_u32 vcc, 2, v10
v_mov_b32 v9, s93
s_nop 0
v_cndmask_b32 v11, v11, v9, vcc
s_add_u32 s93, s90, 512
v_cmp_eq_u32 vcc, 3, v10
v_mov_b32 v9, s93
s_nop 0
v_cndmask_b32 v11, v11, v9, vcc
s_add_u32 s93, s91, 0
v_cmp_eq_u32 vcc, 4, v10
v_mov_b32 v9, s93
s_nop 0
v_cndmask_b32 v11, v11, v9, vcc
v_lshrrev_b32 v10, 4, v0
v_lshl_add_u32 v11, v10, 4, v11
s_lshl_b32 s93, s45, 3
s_add_u32 s93, s93, s44
s_mul_i32 s93, s93, 1280
s_add_u32 s93, s93, 0x2f10000
buffer_store_dwordx4 v[12:15], v11, s[24:27], s93 offen sc1
L_cx_15:
s_branch L_csb_14
L_nc_16:
s_mov_b32 s94, 0
L_nlp_18:
v_readfirstlane_b32 s86, v5
s_nop 0
s_cmp_lg_u32 s86, 0
s_cbranch_scc1 L_nok_19
v_mov_b32 v5, 0
global_load_dword v5, v5, s[56:57] offset:128 sc1
s_waitcnt vmcnt(0)
s_add_u32 s94, s94, 1
s_cmp_lt_u32 s94, 0x100000
s_cbranch_scc1 L_nlp_18
L_nok_19:
v_mov_b32 v10, 152576
ds_write_b32 v10, v5
s_branch L_ncb_17
L_rs_21:
v_lshlrev_b32 v20, 16, v10
v_and_b32 v10, 0xffff0000, v10
v_mul_f32 v19, v20, v20
v_add_f32 v18, v20, v10
v_lshlrev_b32 v20, 16, v11
v_and_b32 v11, 0xffff0000, v11
v_add_f32 v18, v18, v20
v_fmac_f32 v19, v20, v20
v_add_f32 v18, v18, v11
v_lshlrev_b32 v20, 16, v12
v_and_b32 v12, 0xffff0000, v12
v_add_f32 v18, v18, v20
v_fmac_f32 v19, v20, v20
v_add_f32 v18, v18, v12
v_lshlrev_b32 v20, 16, v13
v_and_b32 v13, 0xffff0000, v13
v_add_f32 v18, v18, v20
v_fmac_f32 v19, v20, v20
v_add_f32 v18, v18, v13
v_lshlrev_b32 v20, 16, v14
v_mul_f32 v21, v10, v10
v_and_b32 v14, 0xffff0000, v14
v_add_f32 v18, v18, v20
v_fmac_f32 v21, v11, v11
v_fmac_f32 v19, v20, v20
v_add_f32 v18, v18, v14
v_lshlrev_b32 v20, 16, v15
v_fmac_f32 v21, v12, v12
v_and_b32 v15, 0xffff0000, v15
v_add_f32 v18, v18, v20
v_fmac_f32 v21, v13, v13
v_fmac_f32 v19, v20, v20
v_add_f32 v18, v18, v15
v_lshlrev_b32 v20, 16, v16
v_fmac_f32 v21, v14, v14
v_add_f32 v18, v18, v20
v_fmac_f32 v19, v20, v20
v_fmac_f32 v21, v15, v15
v_and_b32 v16, 0xffff0000, v16
v_lshlrev_b32 v20, 16, v17
v_add_f32 v18, v18, v16
v_fmac_f32 v21, v16, v16
v_and_b32 v17, 0xffff0000, v17
v_add_f32 v18, v18, v20
v_fmac_f32 v19, v20, v20
v_fmac_f32 v21, v17, v17
v_add_f32 v18, v18, v17
v_add_f32 v19, v19, v21
s_nop 0
v_add_f32_dpp v18, v18, v18 quad_perm:[1,0,3,2] row_mask:0xf bank_mask:0xf
v_add_f32_dpp v19, v19, v19 quad_perm:[1,0,3,2] row_mask:0xf bank_mask:0xf
s_nop 0
v_add_f32_dpp v18, v18, v18 quad_perm:[2,3,0,1] row_mask:0xf bank_mask:0xf
v_add_f32_dpp v19, v19, v19 quad_perm:[2,3,0,1] row_mask:0xf bank_mask:0xf
s_nop 0
v_add_f32_dpp v18, v18, v18 row_half_mirror row_mask:0xf bank_mask:0xf
v_add_f32_dpp v19, v19, v19 row_half_mirror row_mask:0xf bank_mask:0xf
s_nop 0
v_add_f32_dpp v18, v18, v18 row_mirror row_mask:0xf bank_mask:0xf
v_add_f32_dpp v19, v19, v19 row_mirror row_mask:0xf bank_mask:0xf
v_mov_b32 v20, v18
v_mov_b32 v21, v19
s_nop 0
v_permlane16_swap_b32 v18, v20
v_permlane16_swap_b32 v19, v21
v_add_f32 v18, v18, v20
v_add_f32 v19, v19, v21
v_mov_b32 v20, v18
v_mov_b32 v21, v19
s_nop 0
v_permlane32_swap_b32 v18, v20
v_permlane32_swap_b32 v19, v21
v_add_f32 v18, v18, v20
v_add_f32 v19, v19, v21
v_mul_f32 v18, 0xba800000, v18
v_mul_f32 v19, 0x3a800000, v19
v_fma_f32 v19, -v18, v18, v19
v_cvt_pk_bf16_f32 v18, v18, v18
v_max_f32 v19, 0, v19
v_lshlrev_b32 v18, 16, v18
v_cvt_pk_bf16_f32 v19, v19, v19
v_lshlrev_b32 v19, 16, v19
v_add_f32 v19, 0x3727c5ac, v19
v_cvt_pk_bf16_f32 v19, v19, v19
v_lshlrev_b32 v19, 16, v19
v_sqrt_f32 v19, v19
s_nop 0
v_cvt_pk_bf16_f32 v19, v19, v19
v_lshlrev_b32 v19, 16, v19
s_lshr_b32 s95, s95, 8
s_add_u32 s95, s95, 0x2f00000
buffer_store_dwordx2 v[18:19], off, s[24:27], s95 sc1
s_branch L_rsb_22
L_rw_23:
s_lshl_b32 s95, s44, 5
s_add_u32 s95, s95, s45
s_lshl_b32 s95, s95, 3
s_add_u32 s95, s95, s43
s_lshl_b32 s95, s95, 11
v_lshlrev_b32 v14, 4, v0
buffer_load_dwordx4 v[10:13], v14, s[8:11], s95 offen
buffer_load_dwordx4 v[14:17], v14, s[8:11], s95 offen offset:1024
s_branch L_rwb_24
L_pf_25:
v_bfe_u32 v9, v0, 1, 2
v_mul_u32_u24 v9, s0, v9
v_lshrrev_b32 v23, 3, v0
v_min_u32 v23, s3, v23
v_mul_u32_u24 v23, s1, v23
v_add3_u32 v9, v9, v23, 56
v_and_b32 v23, 1, v0
s_mov_b32 m0, 152640
v_lshl_add_u32 v9, v23, 7, v9
buffer_load_dwordx4 v9, s[96:99], s100 offen lds
s_add_u32 s100, s100, s101
s_lshl_b32 s93, s2, 13
s_add_u32 s93, s84, s93
s_addc_u32 s94, s85, 0
s_cmp_eq_u32 s100, 32768
s_cmov_b32 s96, s93
s_cmov_b32 s97, s94
s_cmov_b32 s98, 8192
s_cmov_b32 s100, 0
s_cmov_b32 s101, 65536
s_branch L_pfb_26
L_cs_27:
v_and_b32 v10, 15, v0
v_mov_b32 v11, s92
v_cmp_eq_u32 vcc, 0, v10
s_nop 1
v_cndmask_b32 v16, 0, v11, vcc
v_mov_b32 v17, v16
v_mov_b32 v18, v16
v_mov_b32 v19, v16
v_mov_b32_dpp v20, v16 row_shr:1 row_mask:0xf bank_mask:0xf bound_ctrl:0
v_mov_b32_dpp v21, v17 row_shr:1 row_mask:0xf bank_mask:0xf bound_ctrl:0
v_mov_b32_dpp v22, v18 row_shr:1 row_mask:0xf bank_mask:0xf bound_ctrl:0
v_mov_b32_dpp v23, v19 row_shr:1 row_mask:0xf bank_mask:0xf bound_ctrl:0
v_mfma_f32_16x16x32_bf16 v[12:15], v[56:59], v[16:19], 0
v_mfma_f32_16x16x32_bf16 v[12:15], v[60:63], v[16:19], v[12:15]
v_mov_b32_dpp v16, v20 row_shr:1 row_mask:0xf bank_mask:0xf bound_ctrl:0
v_mov_b32_dpp v17, v21 row_shr:1 row_mask:0xf bank_mask:0xf bound_ctrl:0
v_mov_b32_dpp v18, v22 row_shr:1 row_mask:0xf bank_mask:0xf bound_ctrl:0
v_mov_b32_dpp v19, v23 row_shr:1 row_mask:0xf bank_mask:0xf bound_ctrl:0
v_mfma_f32_16x16x32_bf16 v[12:15], v[64:67], v[20:23], v[12:15]
v_mfma_f32_16x16x32_bf16 v[12:15], v[68:71], v[20:23], v[12:15]
v_mov_b32_dpp v20, v16 row_shr:1 row_mask:0xf bank_mask:0xf bound_ctrl:0
v_mov_b32_dpp v21, v17 row_shr:1 row_mask:0xf bank_mask:0xf bound_ctrl:0
v_mov_b32_dpp v22, v18 row_shr:1 row_mask:0xf bank_mask:0xf bound_ctrl:0
v_mov_b32_dpp v23, v19 row_shr:1 row_mask:0xf bank_mask:0xf bound_ctrl:0
v_mfma_f32_16x16x32_bf16 v[12:15], v[72:75], v[16:19], v[12:15]
v_mfma_f32_16x16x32_bf16 v[12:15], v[76:79], v[16:19], v[12:15]
v_mov_b32_dpp v16, v20 row_shr:1 row_mask:0xf bank_mask:0xf bound_ctrl:0
v_mov_b32_dpp v17, v21 row_shr:1 row_mask:0xf bank_mask:0xf bound_ctrl:0
v_mov_b32_dpp v18, v22 row_shr:1 row_mask:0xf bank_mask:0xf bound_ctrl:0
v_mov_b32_dpp v19, v23 row_shr:1 row_mask:0xf bank_mask:0xf bound_ctrl:0
v_mfma_f32_16x16x32_bf16 v[12:15], v[80:83], v[20:23], v[12:15]
v_mfma_f32_16x16x32_bf16 v[12:15], v[84:87], v[20:23], v[12:15]
v_mfma_f32_16x16x32_bf16 v[12:15], v[88:91], v[16:19], v[12:15]
v_mfma_f32_16x16x32_bf16 v[12:15], v[92:95], v[16:19], v[12:15]
s_cmp_lg_u32 s44, 6
s_cbranch_scc1 L_cx_29
v_mov_b32 v11, 2147418112
s_add_u32 s93, s90, 0
v_cmp_eq_u32 vcc, 0, v10
v_mov_b32 v9, s93
s_nop 0
v_cndmask_b32 v11, v11, v9, vcc
s_add_u32 s93, s90, 448
v_cmp_eq_u32 vcc, 1, v10
v_mov_b32 v9, s93
s_nop 0
v_cndmask_b32 v11, v11, v9, vcc
s_add_u32 s93, s90, 64
v_cmp_eq_u32 vcc, 2, v10
v_mov_b32 v9, s93
s_nop 0
v_cndmask_b32 v11, v11, v9, vcc
s_add_u32 s93, s90, 512
v_cmp_eq_u32 vcc, 3, v10
v_mov_b32 v9, s93
s_nop 0
v_cndmask_b32 v11, v11, v9, vcc
s_add_u32 s93, s91, 0
v_cmp_eq_u32 vcc, 4, v10
v_mov_b32 v9, s93
s_nop 0
v_cndmask_b32 v11, v11, v9, vcc
v_lshrrev_b32 v10, 4, v0
v_lshl_add_u32 v11, v10, 4, v11
s_lshl_b32 s93, s45, 3
s_add_u32 s93, s93, s44
s_mul_i32 s93, s93, 1280
s_add_u32 s93, s93, 0x2f10000
buffer_store_dwordx4 v[12:15], v11, s[24:27], s93 offen sc1
L_cx_29:
s_branch L_csb_28
L_fl_30:
s_lshl_b32 s93, s45, 10
s_lshl_b32 s94, s44, 7
s_add_u32 s93, s93, s94
s_add_u32 s93, s93, 0x2f68000
v_mov_b32 v23, s86
buffer_store_dword v23, off, s[24:27], s93 sc1
s_branch L_flb_31
L_rs_32:
v_lshlrev_b32 v20, 16, v10
v_and_b32 v10, 0xffff0000, v10
v_mul_f32 v19, v20, v20
v_add_f32 v18, v20, v10
v_lshlrev_b32 v20, 16, v11
v_and_b32 v11, 0xffff0000, v11
v_add_f32 v18, v18, v20
v_fmac_f32 v19, v20, v20
v_add_f32 v18, v18, v11
v_lshlrev_b32 v20, 16, v12
v_and_b32 v12, 0xffff0000, v12
v_add_f32 v18, v18, v20
v_fmac_f32 v19, v20, v20
v_add_f32 v18, v18, v12
v_lshlrev_b32 v20, 16, v13
v_and_b32 v13, 0xffff0000, v13
v_add_f32 v18, v18, v20
v_fmac_f32 v19, v20, v20
v_add_f32 v18, v18, v13
v_lshlrev_b32 v20, 16, v14
v_mul_f32 v21, v10, v10
v_and_b32 v14, 0xffff0000, v14
v_add_f32 v18, v18, v20
v_fmac_f32 v21, v11, v11
v_fmac_f32 v19, v20, v20
v_add_f32 v18, v18, v14
v_lshlrev_b32 v20, 16, v15
v_fmac_f32 v21, v12, v12
v_and_b32 v15, 0xffff0000, v15
v_add_f32 v18, v18, v20
v_fmac_f32 v21, v13, v13
v_fmac_f32 v19, v20, v20
v_add_f32 v18, v18, v15
v_lshlrev_b32 v20, 16, v16
v_fmac_f32 v21, v14, v14
v_add_f32 v18, v18, v20
v_fmac_f32 v19, v20, v20
v_fmac_f32 v21, v15, v15
v_and_b32 v16, 0xffff0000, v16
v_lshlrev_b32 v20, 16, v17
v_add_f32 v18, v18, v16
v_fmac_f32 v21, v16, v16
v_and_b32 v17, 0xffff0000, v17
v_add_f32 v18, v18, v20
v_fmac_f32 v19, v20, v20
v_fmac_f32 v21, v17, v17
v_add_f32 v18, v18, v17
v_add_f32 v19, v19, v21
s_nop 0
v_add_f32_dpp v18, v18, v18 quad_perm:[1,0,3,2] row_mask:0xf bank_mask:0xf
v_add_f32_dpp v19, v19, v19 quad_perm:[1,0,3,2] row_mask:0xf bank_mask:0xf
s_nop 0
v_add_f32_dpp v18, v18, v18 quad_perm:[2,3,0,1] row_mask:0xf bank_mask:0xf
v_add_f32_dpp v19, v19, v19 quad_perm:[2,3,0,1] row_mask:0xf bank_mask:0xf
s_nop 0
v_add_f32_dpp v18, v18, v18 row_half_mirror row_mask:0xf bank_mask:0xf
v_add_f32_dpp v19, v19, v19 row_half_mirror row_mask:0xf bank_mask:0xf
s_nop 0
v_add_f32_dpp v18, v18, v18 row_mirror row_mask:0xf bank_mask:0xf
v_add_f32_dpp v19, v19, v19 row_mirror row_mask:0xf bank_mask:0xf
v_mov_b32 v20, v18
v_mov_b32 v21, v19
s_nop 0
v_permlane16_swap_b32 v18, v20
v_permlane16_swap_b32 v19, v21
v_add_f32 v18, v18, v20
v_add_f32 v19, v19, v21
v_mov_b32 v20, v18
v_mov_b32 v21, v19
s_nop 0
v_permlane32_swap_b32 v18, v20
v_permlane32_swap_b32 v19, v21
v_add_f32 v18, v18, v20
v_add_f32 v19, v19, v21
v_mul_f32 v18, 0xba800000, v18
v_mul_f32 v19, 0x3a800000, v19
v_fma_f32 v19, -v18, v18, v19
v_cvt_pk_bf16_f32 v18, v18, v18
v_max_f32 v19, 0, v19
v_lshlrev_b32 v18, 16, v18
v_cvt_pk_bf16_f32 v19, v19, v19
v_lshlrev_b32 v19, 16, v19
v_add_f32 v19, 0x3727c5ac, v19
v_cvt_pk_bf16_f32 v19, v19, v19
v_lshlrev_b32 v19, 16, v19
v_sqrt_f32 v19, v19
s_nop 0
v_cvt_pk_bf16_f32 v19, v19, v19
v_lshlrev_b32 v19, 16, v19
s_lshr_b32 s95, s95, 8
s_add_u32 s95, s95, 0x2f00000
buffer_store_dwordx2 v[18:19], off, s[24:27], s95 sc1
s_branch L_rsb_33
L_rw_34:
s_lshl_b32 s95, s44, 5
s_add_u32 s95, s95, s45
s_lshl_b32 s95, s95, 3
s_add_u32 s95, s95, s43
s_lshl_b32 s95, s95, 11
v_lshlrev_b32 v14, 4, v0
buffer_load_dwordx4 v[10:13], v14, s[8:11], s95 offen
buffer_load_dwordx4 v[14:17], v14, s[8:11], s95 offen offset:1024
s_branch L_rwb_35
L_fs_36:
s_lshl_b32 s93, s44, 12
s_lshl_b32 s94, s45, 7
s_add_u32 s93, s93, s94
s_add_u32 s93, s93, 0x2f60000
v_mov_b32 v23, s86
buffer_store_dword v23, off, s[24:27], s93 sc1
s_branch L_fsb_37
L_cs_38:
v_and_b32 v10, 15, v0
v_mov_b32 v11, s92
v_cmp_eq_u32 vcc, 0, v10
s_nop 1
v_cndmask_b32 v16, 0, v11, vcc
v_mov_b32 v17, v16
v_mov_b32 v18, v16
v_mov_b32 v19, v16
v_mov_b32_dpp v20, v16 row_shr:1 row_mask:0xf bank_mask:0xf bound_ctrl:0
v_mov_b32_dpp v21, v17 row_shr:1 row_mask:0xf bank_mask:0xf bound_ctrl:0
v_mov_b32_dpp v22, v18 row_shr:1 row_mask:0xf bank_mask:0xf bound_ctrl:0
v_mov_b32_dpp v23, v19 row_shr:1 row_mask:0xf bank_mask:0xf bound_ctrl:0
v_mfma_f32_16x16x32_bf16 v[12:15], v[56:59], v[16:19], v[12:15]
v_mfma_f32_16x16x32_bf16 v[12:15], v[60:63], v[16:19], v[12:15]
v_mov_b32_dpp v16, v20 row_shr:1 row_mask:0xf bank_mask:0xf bound_ctrl:0
v_mov_b32_dpp v17, v21 row_shr:1 row_mask:0xf bank_mask:0xf bound_ctrl:0
v_mov_b32_dpp v18, v22 row_shr:1 row_mask:0xf bank_mask:0xf bound_ctrl:0
v_mov_b32_dpp v19, v23 row_shr:1 row_mask:0xf bank_mask:0xf bound_ctrl:0
v_mfma_f32_16x16x32_bf16 v[12:15], v[64:67], v[20:23], v[12:15]
v_mfma_f32_16x16x32_bf16 v[12:15], v[68:71], v[20:23], v[12:15]
v_mov_b32_dpp v20, v16 row_shr:1 row_mask:0xf bank_mask:0xf bound_ctrl:0
v_mov_b32_dpp v21, v17 row_shr:1 row_mask:0xf bank_mask:0xf bound_ctrl:0
v_mov_b32_dpp v22, v18 row_shr:1 row_mask:0xf bank_mask:0xf bound_ctrl:0
v_mov_b32_dpp v23, v19 row_shr:1 row_mask:0xf bank_mask:0xf bound_ctrl:0
v_mfma_f32_16x16x32_bf16 v[12:15], v[72:75], v[16:19], v[12:15]
v_mfma_f32_16x16x32_bf16 v[12:15], v[76:79], v[16:19], v[12:15]
v_mov_b32_dpp v16, v20 row_shr:1 row_mask:0xf bank_mask:0xf bound_ctrl:0
v_mov_b32_dpp v17, v21 row_shr:1 row_mask:0xf bank_mask:0xf bound_ctrl:0
v_mov_b32_dpp v18, v22 row_shr:1 row_mask:0xf bank_mask:0xf bound_ctrl:0
v_mov_b32_dpp v19, v23 row_shr:1 row_mask:0xf bank_mask:0xf bound_ctrl:0
v_mfma_f32_16x16x32_bf16 v[12:15], v[80:83], v[20:23], v[12:15]
v_mfma_f32_16x16x32_bf16 v[12:15], v[84:87], v[20:23], v[12:15]
v_mfma_f32_16x16x32_bf16 v[12:15], v[88:91], v[16:19], v[12:15]
v_mfma_f32_16x16x32_bf16 v[12:15], v[92:95], v[16:19], v[12:15]
v_mov_b32 v11, 2147418112
s_add_u32 s93, s90, 0
v_cmp_eq_u32 vcc, 0, v10
v_mov_b32 v9, s93
s_nop 0
v_cndmask_b32 v11, v11, v9, vcc
s_add_u32 s93, s90, 448
v_cmp_eq_u32 vcc, 1, v10
v_mov_b32 v9, s93
s_nop 0
v_cndmask_b32 v11, v11, v9, vcc
s_add_u32 s93, s90, 64
v_cmp_eq_u32 vcc, 2, v10
v_mov_b32 v9, s93
s_nop 0
v_cndmask_b32 v11, v11, v9, vcc
s_add_u32 s93, s90, 512
v_cmp_eq_u32 vcc, 3, v10
v_mov_b32 v9, s93
s_nop 0
v_cndmask_b32 v11, v11, v9, vcc
s_add_u32 s93, s91, 0
v_cmp_eq_u32 vcc, 4, v10
v_mov_b32 v9, s93
s_nop 0
v_cndmask_b32 v11, v11, v9, vcc
v_lshrrev_b32 v10, 4, v0
v_lshl_add_u32 v11, v10, 4, v11
s_lshl_b32 s93, s45, 3
s_add_u32 s93, s93, s44
s_mul_i32 s93, s93, 1280
s_add_u32 s93, s93, 0x2f10000
buffer_store_dwordx4 v[12:15], v11, s[24:27], s93 offen sc1
L_cx_40:
s_branch L_csb_39
L_cs_41:
v_and_b32 v10, 15, v0
v_mov_b32 v11, s92
v_cmp_eq_u32 vcc, 0, v10
s_nop 1
v_cndmask_b32 v16, 0, v11, vcc
v_mov_b32 v17, v16
v_mov_b32 v18, v16
v_mov_b32 v19, v16
v_mov_b32_dpp v20, v16 row_shr:1 row_mask:0xf bank_mask:0xf bound_ctrl:0
v_mov_b32_dpp v21, v17 row_shr:1 row_mask:0xf bank_mask:0xf bound_ctrl:0
v_mov_b32_dpp v22, v18 row_shr:1 row_mask:0xf bank_mask:0xf bound_ctrl:0
v_mov_b32_dpp v23, v19 row_shr:1 row_mask:0xf bank_mask:0xf bound_ctrl:0
v_mfma_f32_16x16x32_bf16 v[12:15], v[56:59], v[16:19], 0
v_mfma_f32_16x16x32_bf16 v[12:15], v[60:63], v[16:19], v[12:15]
v_mov_b32_dpp v16, v20 row_shr:1 row_mask:0xf bank_mask:0xf bound_ctrl:0
v_mov_b32_dpp v17, v21 row_shr:1 row_mask:0xf bank_mask:0xf bound_ctrl:0
v_mov_b32_dpp v18, v22 row_shr:1 row_mask:0xf bank_mask:0xf bound_ctrl:0
v_mov_b32_dpp v19, v23 row_shr:1 row_mask:0xf bank_mask:0xf bound_ctrl:0
v_mfma_f32_16x16x32_bf16 v[12:15], v[64:67], v[20:23], v[12:15]
v_mfma_f32_16x16x32_bf16 v[12:15], v[68:71], v[20:23], v[12:15]
v_mov_b32_dpp v20, v16 row_shr:1 row_mask:0xf bank_mask:0xf bound_ctrl:0
v_mov_b32_dpp v21, v17 row_shr:1 row_mask:0xf bank_mask:0xf bound_ctrl:0
v_mov_b32_dpp v22, v18 row_shr:1 row_mask:0xf bank_mask:0xf bound_ctrl:0
v_mov_b32_dpp v23, v19 row_shr:1 row_mask:0xf bank_mask:0xf bound_ctrl:0
v_mfma_f32_16x16x32_bf16 v[12:15], v[72:75], v[16:19], v[12:15]
v_mfma_f32_16x16x32_bf16 v[12:15], v[76:79], v[16:19], v[12:15]
v_mov_b32_dpp v16, v20 row_shr:1 row_mask:0xf bank_mask:0xf bound_ctrl:0
v_mov_b32_dpp v17, v21 row_shr:1 row_mask:0xf bank_mask:0xf bound_ctrl:0
v_mov_b32_dpp v18, v22 row_shr:1 row_mask:0xf bank_mask:0xf bound_ctrl:0
v_mov_b32_dpp v19, v23 row_shr:1 row_mask:0xf bank_mask:0xf bound_ctrl:0
v_mfma_f32_16x16x32_bf16 v[12:15], v[80:83], v[20:23], v[12:15]
v_mfma_f32_16x16x32_bf16 v[12:15], v[84:87], v[20:23], v[12:15]
v_mfma_f32_16x16x32_bf16 v[12:15], v[88:91], v[16:19], v[12:15]
v_mfma_f32_16x16x32_bf16 v[12:15], v[92:95], v[16:19], v[12:15]
s_branch L_csb_42
L_fl_43:
s_lshl_b32 s93, s45, 10
s_lshl_b32 s94, s44, 7
s_add_u32 s93, s93, s94
s_add_u32 s93, s93, 0x2f68000
v_mov_b32 v23, s86
buffer_store_dword v23, off, s[24:27], s93 sc1
s_branch L_flb_44
L_li_45:
v_cmp_gt_u32 vcc, 32, v0
v_lshlrev_b32 v10, 7, v0
s_lshl_b32 s93, s44, 12
v_add_u32 v11, s93, v10
s_lshl_b32 s93, s45, 10
s_add_u32 s93, s93, 28672
v_min_u32 v10, 4864, v10
v_add_u32 v10, s93, v10
v_cndmask_b32 v7, v10, v11, vcc
s_mov_b32 s29, 0x2f60000
buffer_load_dword v8, v7, s[24:27], s29 offen sc1
s_branch L_lib_46
L_cs_47:
v_and_b32 v10, 15, v0
v_mov_b32 v11, s92
v_cmp_eq_u32 vcc, 0, v10
s_nop 1
v_cndmask_b32 v16, 0, v11, vcc
v_mov_b32 v17, v16
v_mov_b32 v18, v16
v_mov_b32 v19, v16
v_mov_b32_dpp v20, v16 row_shr:1 row_mask:0xf bank_mask:0xf bound_ctrl:0
v_mov_b32_dpp v21, v17 row_shr:1 row_mask:0xf bank_mask:0xf bound_ctrl:0
v_mov_b32_dpp v22, v18 row_shr:1 row_mask:0xf bank_mask:0xf bound_ctrl:0
v_mov_b32_dpp v23, v19 row_shr:1 row_mask:0xf bank_mask:0xf bound_ctrl:0
v_mfma_f32_16x16x32_bf16 v[12:15], v[56:59], v[16:19], v[12:15]
v_mfma_f32_16x16x32_bf16 v[12:15], v[60:63], v[16:19], v[12:15]
v_mov_b32_dpp v16, v20 row_shr:1 row_mask:0xf bank_mask:0xf bound_ctrl:0
v_mov_b32_dpp v17, v21 row_shr:1 row_mask:0xf bank_mask:0xf bound_ctrl:0
v_mov_b32_dpp v18, v22 row_shr:1 row_mask:0xf bank_mask:0xf bound_ctrl:0
v_mov_b32_dpp v19, v23 row_shr:1 row_mask:0xf bank_mask:0xf bound_ctrl:0
v_mfma_f32_16x16x32_bf16 v[12:15], v[64:67], v[20:23], v[12:15]
v_mfma_f32_16x16x32_bf16 v[12:15], v[68:71], v[20:23], v[12:15]
v_mov_b32_dpp v20, v16 row_shr:1 row_mask:0xf bank_mask:0xf bound_ctrl:0
v_mov_b32_dpp v21, v17 row_shr:1 row_mask:0xf bank_mask:0xf bound_ctrl:0
v_mov_b32_dpp v22, v18 row_shr:1 row_mask:0xf bank_mask:0xf bound_ctrl:0
v_mov_b32_dpp v23, v19 row_shr:1 row_mask:0xf bank_mask:0xf bound_ctrl:0
v_mfma_f32_16x16x32_bf16 v[12:15], v[72:75], v[16:19], v[12:15]
v_mfma_f32_16x16x32_bf16 v[12:15], v[76:79], v[16:19], v[12:15]
v_mov_b32_dpp v16, v20 row_shr:1 row_mask:0xf bank_mask:0xf bound_ctrl:0
v_mov_b32_dpp v17, v21 row_shr:1 row_mask:0xf bank_mask:0xf bound_ctrl:0
v_mov_b32_dpp v18, v22 row_shr:1 row_mask:0xf bank_mask:0xf bound_ctrl:0
v_mov_b32_dpp v19, v23 row_shr:1 row_mask:0xf bank_mask:0xf bound_ctrl:0
v_mfma_f32_16x16x32_bf16 v[12:15], v[80:83], v[20:23], v[12:15]
v_mfma_f32_16x16x32_bf16 v[12:15], v[84:87], v[20:23], v[12:15]
v_mfma_f32_16x16x32_bf16 v[12:15], v[88:91], v[16:19], v[12:15]
v_mfma_f32_16x16x32_bf16 v[12:15], v[92:95], v[16:19], v[12:15]
s_branch L_csb_48
L_lc_49:
s_waitcnt vmcnt(0)
v_cmp_ne_u32 vcc, s86, v8
s_nop 1
s_cbranch_vccz L_lok_51
s_mov_b32 s94, 0
L_pln_52:
buffer_load_dword v8, v7, s[24:27], s29 offen sc1
s_waitcnt vmcnt(0)
v_cmp_ne_u32 vcc, s86, v8
s_nop 1
s_cbranch_vccz L_plnok_53
s_add_u32 s94, s94, 1
s_cmp_lt_u32 s94, 0x80000
s_cbranch_scc1 L_pln_52
L_plnok_53:
L_lok_51:
s_branch L_lcb_50
L_pc_54:
s_mul_i32 s93, s45, 10240
s_add_u32 s93, s93, 0x2f10000
buffer_load_dwordx2 v[10:11], v9, s[24:27], s93 offen offset:0 sc1
buffer_load_dwordx2 v[12:13], v9, s[24:27], s93 offen offset:1280 sc1
buffer_load_dwordx2 v[14:15], v9, s[24:27], s93 offen offset:2560 sc1
s_add_u32 s93, s93, 3840
buffer_load_dwordx2 v[16:17], v9, s[24:27], s93 offen offset:0 sc1
buffer_load_dwordx2 v[18:19], v9, s[24:27], s93 offen offset:1280 sc1
buffer_load_dwordx2 v[20:21], v9, s[24:27], s93 offen offset:2560 sc1
s_add_u32 s93, s93, 3840
buffer_load_dwordx2 v[22:23], v9, s[24:27], s93 offen offset:0 sc1
s_branch L_pcb_55
L_cs_56:
v_and_b32 v10, 15, v0
v_mov_b32 v11, s92
v_cmp_eq_u32 vcc, 0, v10
s_nop 1
v_cndmask_b32 v16, 0, v11, vcc
v_mov_b32 v17, v16
v_mov_b32 v18, v16
v_mov_b32 v19, v16
v_mov_b32_dpp v20, v16 row_shr:1 row_mask:0xf bank_mask:0xf bound_ctrl:0
v_mov_b32_dpp v21, v17 row_shr:1 row_mask:0xf bank_mask:0xf bound_ctrl:0
v_mov_b32_dpp v22, v18 row_shr:1 row_mask:0xf bank_mask:0xf bound_ctrl:0
v_mov_b32_dpp v23, v19 row_shr:1 row_mask:0xf bank_mask:0xf bound_ctrl:0
v_mfma_f32_16x16x32_bf16 v[12:15], v[56:59], v[16:19], v[12:15]
v_mfma_f32_16x16x32_bf16 v[12:15], v[60:63], v[16:19], v[12:15]
v_mov_b32_dpp v16, v20 row_shr:1 row_mask:0xf bank_mask:0xf bound_ctrl:0
v_mov_b32_dpp v17, v21 row_shr:1 row_mask:0xf bank_mask:0xf bound_ctrl:0
v_mov_b32_dpp v18, v22 row_shr:1 row_mask:0xf bank_mask:0xf bound_ctrl:0
v_mov_b32_dpp v19, v23 row_shr:1 row_mask:0xf bank_mask:0xf bound_ctrl:0
v_mfma_f32_16x16x32_bf16 v[12:15], v[64:67], v[20:23], v[12:15]
v_mfma_f32_16x16x32_bf16 v[12:15], v[68:71], v[20:23], v[12:15]
v_mov_b32_dpp v20, v16 row_shr:1 row_mask:0xf bank_mask:0xf bound_ctrl:0
v_mov_b32_dpp v21, v17 row_shr:1 row_mask:0xf bank_mask:0xf bound_ctrl:0
v_mov_b32_dpp v22, v18 row_shr:1 row_mask:0xf bank_mask:0xf bound_ctrl:0
v_mov_b32_dpp v23, v19 row_shr:1 row_mask:0xf bank_mask:0xf bound_ctrl:0
v_mfma_f32_16x16x32_bf16 v[12:15], v[72:75], v[16:19], v[12:15]
v_mfma_f32_16x16x32_bf16 v[12:15], v[76:79], v[16:19], v[12:15]
v_mov_b32_dpp v16, v20 row_shr:1 row_mask:0xf bank_mask:0xf bound_ctrl:0
v_mov_b32_dpp v17, v21 row_shr:1 row_mask:0xf bank_mask:0xf bound_ctrl:0
v_mov_b32_dpp v18, v22 row_shr:1 row_mask:0xf bank_mask:0xf bound_ctrl:0
v_mov_b32_dpp v19, v23 row_shr:1 row_mask:0xf bank_mask:0xf bound_ctrl:0
v_mfma_f32_16x16x32_bf16 v[12:15], v[80:83], v[20:23], v[12:15]
v_mfma_f32_16x16x32_bf16 v[12:15], v[84:87], v[20:23], v[12:15]
v_mfma_f32_16x16x32_bf16 v[12:15], v[88:91], v[16:19], v[12:15]
v_mfma_f32_16x16x32_bf16 v[12:15], v[92:95], v[16:19], v[12:15]
v_mov_b32 v11, 5184
s_add_u32 s93, s90, 0
v_cmp_eq_u32 vcc, 0, v10
v_mov_b32 v9, s93
s_nop 0
v_cndmask_b32 v11, v11, v9, vcc
s_add_u32 s93, s90, 448
v_cmp_eq_u32 vcc, 1, v10
v_mov_b32 v9, s93
s_nop 0
v_cndmask_b32 v11, v11, v9, vcc
s_add_u32 s93, s90, 64
v_cmp_eq_u32 vcc, 2, v10
v_mov_b32 v9, s93
s_nop 0
v_cndmask_b32 v11, v11, v9, vcc
s_add_u32 s93, s90, 512
v_cmp_eq_u32 vcc, 3, v10
v_mov_b32 v9, s93
s_nop 0
v_cndmask_b32 v11, v11, v9, vcc
s_add_u32 s93, s91, 0
v_cmp_eq_u32 vcc, 4, v10
v_mov_b32 v9, s93
s_nop 0
v_cndmask_b32 v11, v11, v9, vcc
v_lshrrev_b32 v10, 4, v0
v_lshl_add_u32 v11, v10, 4, v11
v_add_u32 v11, 147456, v11
ds_write_b128 v11, v[12:15]
L_cx_58:
s_branch L_csb_57
L_ps_59:
s_waitcnt vmcnt(0)
v_add_f32 v10, v10, v12
v_add_f32 v11, v11, v13
v_add_f32 v14, v14, v16
v_add_f32 v15, v15, v17
v_add_f32 v18, v18, v20
v_add_f32 v19, v19, v21
v_add_f32 v22, v22, v6
v_add_f32 v23, v23, v7
v_add_f32 v10, v10, v14
v_add_f32 v11, v11, v15
v_add_f32 v18, v18, v22
v_add_f32 v19, v19, v23
v_add_f32 v10, v10, v18
v_add_f32 v11, v11, v19
v_add_u32 v9, 151296, v9
ds_write_b64 v9, v[10:11]
s_branch L_psb_60
L_kv_62:
s_cmp_eq_u32 s44, 0
s_cselect_b32 s14, 0, s26
s_cbranch_scc1 L_kvok_64
s_waitcnt vmcnt(0)
v_cmp_ne_u32 vcc, s86, v185
v_mov_b32 v45, 0
s_nop 0
s_cbranch_vccz L_kvok_64
s_mov_b32 s94, 0
L_pkv_65:
buffer_load_dword v185, v45, s[24:27], s35 offen sc1
s_waitcnt vmcnt(0)
v_cmp_ne_u32 vcc, s86, v185
s_nop 1
s_cbranch_vccz L_pkvok_66
s_add_u32 s94, s94, 1
s_cmp_lt_u32 s94, 0x80000
s_cbranch_scc1 L_pkv_65
L_pkvok_66:
L_kvok_64:
v_lshlrev_b32 v45, 4, v0
s_lshl_b32 s33, s43, 12
s_lshl_b32 s31, s45, 7
s_lshl_b32 s32, s44, 4
s_add_u32 s31, s31, s32
s_lshl_b32 s31, s31, 10
s_add_u32 s31, s31, s33
s_add_u32 s31, s31, 0x15fc000
s_lshr_b32 s34, s43, 1
s_lshl_b32 s32, s45, 1
s_add_u32 s32, s32, s34
s_lshl_b32 s32, s32, 16
s_lshl_b32 s36, s44, 13
s_add_u32 s32, s32, s36
s_and_b32 s36, s33, 4096
s_add_u32 s32, s32, s36
s_add_u32 s32, s32, 0x19fe000
s_lshl_b32 s34, s34, 14
s_add_u32 s34, s34, s36
s_add_u32 m0, s33, 65536
s_nop 0
buffer_load_dwordx4 v45, s[12:15], s31 offen offset:0 sc1 lds
buffer_load_dwordx4 v45, s[12:15], s31 offen offset:1024 sc1 lds
buffer_load_dwordx4 v45, s[12:15], s31 offen offset:2048 sc1 lds
buffer_load_dwordx4 v45, s[12:15], s31 offen offset:3072 sc1 lds
s_add_u32 m0, s34, 98304
s_nop 0
buffer_load_dwordx4 v45, s[12:15], s32 offen offset:0 sc1 lds
buffer_load_dwordx4 v45, s[12:15], s32 offen offset:1024 sc1 lds
buffer_load_dwordx4 v45, s[12:15], s32 offen offset:2048 sc1 lds
buffer_load_dwordx4 v45, s[12:15], s32 offen offset:3072 sc1 lds
s_branch L_kvb_63
L_nw_68:
s_waitcnt vmcnt(2)
s_branch L_nwb_69
L_v1_4:
s_cmp_eq_u32 s41, 0
s_cselect_b32 s93, 6, 0
v_sub_u32 v5, v4, v14
v_add_u32 v4, v4, v14
s_add_u32 s90, s93, 6
s_lshl_b32 s90, s90, 6
s_lshl_b32 s93, s93, 5
s_add_u32 s93, s93, 65536
v_add_u32 v3, s93, v3
s_waitcnt vmcnt(4)
s_barrier
ds_read_b128 v[24:27], v1 offset:0
ds_read_b128 v[28:31], v2 offset:0
ds_read_b128 v[36:39], v2 offset:2048
ds_read_b128 v[32:35], v1 offset:2048
ds_read_b64_tr_b16 v[60:61], v3 offset:7168
ds_read_b64_tr_b16 v[62:63], v3 offset:8960
ds_read_b64_tr_b16 v[56:57], v3 offset:0
ds_read_b64_tr_b16 v[58:59], v3 offset:1792
ds_read_b64_tr_b16 v[68:69], v3 offset:21504
ds_read_b64_tr_b16 v[70:71], v3 offset:23296
ds_read_b64_tr_b16 v[64:65], v3 offset:14336
ds_read_b64_tr_b16 v[66:67], v3 offset:16128
ds_read_b64_tr_b16 v[76:77], v4 offset:6208
ds_read_b64_tr_b16 v[78:79], v4 offset:7744
ds_read_b64_tr_b16 v[72:73], v4 offset:64
ds_read_b64_tr_b16 v[74:75], v4 offset:1600
ds_read_b64_tr_b16 v[84:85], v5 offset:6240
ds_read_b64_tr_b16 v[86:87], v5 offset:7776
ds_read_b64_tr_b16 v[80:81], v5 offset:96
ds_read_b64_tr_b16 v[82:83], v5 offset:1632
ds_read_b64_tr_b16 v[92:93], v4 offset:6144
s_waitcnt lgkmcnt(13)
v_mfma_f32_16x16x32_bf16 v[96:99], v[56:59], v[24:27], 0
ds_read_b64_tr_b16 v[94:95], v4 offset:7680
v_mfma_f32_16x16x32_bf16 v[96:99], v[60:63], v[28:31], v[96:99]
ds_read_b64_tr_b16 v[88:89], v4 offset:0
s_add_u32 m0, s35, 40960
v_mfma_f32_16x16x32_bf16 v[116:119], v[60:63], v[36:39], 0
ds_read_b64_tr_b16 v[90:91], v4 offset:1536
buffer_load_dwordx4 v7, s[12:15], s29 offen lds
v_mfma_f32_16x16x32_bf16 v[116:119], v[56:59], v[32:35], v[116:119]
ds_read_b128 v[40:43], v1 offset:4096
s_waitcnt lgkmcnt(13)
v_mfma_f32_16x16x32_bf16 v[120:123], v[64:67], v[32:35], 0
ds_read_b128 v[44:47], v2 offset:4096
s_add_u32 s41, s29, s32
v_mfma_f32_16x16x32_bf16 v[120:123], v[68:71], v[36:39], v[120:123]
ds_read_b128 v[52:55], v2 offset:6144
s_add_u32 m0, s36, 40960
v_mfma_f32_16x16x32_bf16 v[100:103], v[68:71], v[28:31], 0
ds_read_b128 v[48:51], v1 offset:6144
buffer_load_dwordx4 v7, s[12:15], s41 offen lds
v_mfma_f32_16x16x32_bf16 v[100:103], v[64:67], v[24:27], v[100:103]
s_waitcnt lgkmcnt(12)
v_mfma_f32_16x16x32_bf16 v[104:107], v[72:75], v[24:27], 0
s_add_u32 s41, s29, s33
v_mfma_f32_16x16x32_bf16 v[104:107], v[76:79], v[28:31], v[104:107]
s_add_u32 m0, s37, 40960
v_mfma_f32_16x16x32_bf16 v[124:127], v[76:79], v[36:39], 0
buffer_load_dwordx4 v7, s[16:19], s41 offen lds
v_mfma_f32_16x16x32_bf16 v[124:127], v[72:75], v[32:35], v[124:127]
s_waitcnt lgkmcnt(8)
v_mfma_f32_16x16x32_bf16 v[128:131], v[80:83], v[32:35], 0
s_add_u32 s41, s29, s34
v_mfma_f32_16x16x32_bf16 v[128:131], v[84:87], v[36:39], v[128:131]
s_add_u32 m0, s38, 40960
v_mfma_f32_16x16x32_bf16 v[108:111], v[84:87], v[28:31], 0
buffer_load_dwordx4 v7, s[16:19], s41 offen lds
v_mfma_f32_16x16x32_bf16 v[108:111], v[80:83], v[24:27], v[108:111]
s_waitcnt lgkmcnt(4)
v_mfma_f32_16x16x32_bf16 v[112:115], v[88:91], v[24:27], 0
v_mfma_f32_16x16x32_bf16 v[112:115], v[92:95], v[28:31], v[112:115]
v_mfma_f32_16x16x32_bf16 v[132:135], v[92:95], v[36:39], 0
s_add_u32 m0, s39, 40960
v_mfma_f32_16x16x32_bf16 v[132:135], v[88:91], v[32:35], v[132:135]
buffer_load_dwordx4 v8, s[20:23], s30 offen lds
s_waitcnt lgkmcnt(0)
s_barrier
v_mfma_f32_16x16x32_bf16 v[136:139], v[56:59], v[40:43], 0
ds_read_b128 v[24:27], v1 offset:8192
v_mfma_f32_16x16x32_bf16 v[136:139], v[60:63], v[44:47], v[136:139]
ds_read_b128 v[28:31], v2 offset:8192
v_mfma_f32_16x16x32_bf16 v[156:159], v[60:63], v[52:55], 0
ds_read_b128 v[36:39], v2 offset:10240
v_mfma_f32_16x16x32_bf16 v[156:159], v[56:59], v[48:51], v[156:159]
ds_read_b128 v[32:35], v1 offset:10240
v_mfma_f32_16x16x32_bf16 v[160:163], v[64:67], v[48:51], 0
s_cmp_eq_u32 s43, 0
s_cbranch_scc1 L_nl_70
L_nlb_71:
v_mfma_f32_16x16x32_bf16 v[160:163], v[68:71], v[52:55], v[160:163]
v_mfma_f32_16x16x32_bf16 v[140:143], v[68:71], v[44:47], 0
v_mfma_f32_16x16x32_bf16 v[140:143], v[64:67], v[40:43], v[140:143]
v_mfma_f32_16x16x32_bf16 v[144:147], v[72:75], v[40:43], 0
v_mfma_f32_16x16x32_bf16 v[144:147], v[76:79], v[44:47], v[144:147]
s_add_u32 s28, s28, 128
s_add_u32 s29, s29, s31
s_add_u32 s30, s30, 393216
v_mfma_f32_16x16x32_bf16 v[164:167], v[76:79], v[52:55], 0
v_mfma_f32_16x16x32_bf16 v[164:167], v[72:75], v[48:51], v[164:167]
v_mfma_f32_16x16x32_bf16 v[168:171], v[80:83], v[48:51], 0
v_mfma_f32_16x16x32_bf16 v[168:171], v[84:87], v[52:55], v[168:171]
v_mfma_f32_16x16x32_bf16 v[148:151], v[84:87], v[44:47], 0
s_add_u32 m0, s40, 0
v_mfma_f32_16x16x32_bf16 v[148:151], v[80:83], v[40:43], v[148:151]
buffer_load_dwordx4 v6, s[8:11], s28 offen lds
v_mfma_f32_16x16x32_bf16 v[152:155], v[88:91], v[40:43], 0
v_mfma_f32_16x16x32_bf16 v[152:155], v[92:95], v[44:47], v[152:155]
v_mfma_f32_16x16x32_bf16 v[172:175], v[92:95], v[52:55], 0
v_mfma_f32_16x16x32_bf16 v[172:175], v[88:91], v[48:51], v[172:175]
s_waitcnt lgkmcnt(3)
v_mfma_f32_16x16x32_bf16 v[176:179], v[56:59], v[24:27], 0
ds_read_b128 v[40:43], v1 offset:12288
s_add_u32 s41, s28, 262144
s_waitcnt lgkmcnt(3)
v_mfma_f32_16x16x32_bf16 v[176:179], v[60:63], v[28:31], v[176:179]
ds_read_b128 v[44:47], v2 offset:12288
s_add_u32 m0, s40, 16384
s_waitcnt lgkmcnt(3)
v_mfma_f32_16x16x32_bf16 v[196:199], v[60:63], v[36:39], 0
ds_read_b128 v[52:55], v2 offset:14336
buffer_load_dwordx4 v6, s[8:11], s41 offen lds
s_waitcnt lgkmcnt(3)
v_mfma_f32_16x16x32_bf16 v[196:199], v[56:59], v[32:35], v[196:199]
ds_read_b128 v[48:51], v1 offset:14336
v_mfma_f32_16x16x32_bf16 v[200:203], v[64:67], v[32:35], 0
v_mfma_f32_16x16x32_bf16 v[200:203], v[68:71], v[36:39], v[200:203]
s_mov_b32 m0, s35
v_mfma_f32_16x16x32_bf16 v[180:183], v[68:71], v[28:31], 0
buffer_load_dwordx4 v7, s[12:15], s29 offen lds
v_mfma_f32_16x16x32_bf16 v[180:183], v[64:67], v[24:27], v[180:183]
v_mfma_f32_16x16x32_bf16 v[184:187], v[72:75], v[24:27], 0
v_mfma_f32_16x16x32_bf16 v[184:187], v[76:79], v[28:31], v[184:187]
v_mfma_f32_16x16x32_bf16 v[204:207], v[76:79], v[36:39], 0
s_add_u32 s41, s29, s32
v_mfma_f32_16x16x32_bf16 v[204:207], v[72:75], v[32:35], v[204:207]
s_mov_b32 m0, s36
v_mfma_f32_16x16x32_bf16 v[208:211], v[80:83], v[32:35], 0
buffer_load_dwordx4 v7, s[12:15], s41 offen lds
v_mfma_f32_16x16x32_bf16 v[208:211], v[84:87], v[36:39], v[208:211]
v_mfma_f32_16x16x32_bf16 v[188:191], v[84:87], v[28:31], 0
v_mfma_f32_16x16x32_bf16 v[188:191], v[80:83], v[24:27], v[188:191]
v_mfma_f32_16x16x32_bf16 v[192:195], v[88:91], v[24:27], 0
s_add_u32 s41, s29, s33
v_mfma_f32_16x16x32_bf16 v[192:195], v[92:95], v[28:31], v[192:195]
s_mov_b32 m0, s37
v_mfma_f32_16x16x32_bf16 v[212:215], v[92:95], v[36:39], 0
buffer_load_dwordx4 v7, s[16:19], s41 offen lds
v_mfma_f32_16x16x32_bf16 v[212:215], v[88:91], v[32:35], v[212:215]
s_cmp_eq_u32 s87, 0
s_cbranch_scc1 L_cs_72
L_csb_73:
s_waitcnt vmcnt(5) lgkmcnt(0)
s_barrier
v_mfma_f32_16x16x32_bf16 v[216:219], v[56:59], v[40:43], 0
ds_read_b128 v[24:27], v1 offset:32768
v_mfma_f32_16x16x32_bf16 v[216:219], v[60:63], v[44:47], v[216:219]
ds_read_b128 v[28:31], v2 offset:32768
v_mfma_f32_16x16x32_bf16 v[236:239], v[60:63], v[52:55], 0
ds_read_b128 v[36:39], v2 offset:34816
v_mfma_f32_16x16x32_bf16 v[236:239], v[56:59], v[48:51], v[236:239]
ds_read_b128 v[32:35], v1 offset:34816
ds_read_b64_tr_b16 v[60:61], v3 offset:48128
v_mfma_f32_16x16x32_bf16 v[240:243], v[64:67], v[48:51], 0
ds_read_b64_tr_b16 v[62:63], v3 offset:49920
s_add_u32 s41, s29, s34
v_mfma_f32_16x16x32_bf16 v[240:243], v[68:71], v[52:55], v[240:243]
ds_read_b64_tr_b16 v[56:57], v3 offset:40960
s_mov_b32 m0, s38
v_mfma_f32_16x16x32_bf16 v[220:223], v[68:71], v[44:47], 0
ds_read_b64_tr_b16 v[58:59], v3 offset:42752
buffer_load_dwordx4 v7, s[16:19], s41 offen lds
v_mfma_f32_16x16x32_bf16 v[220:223], v[64:67], v[40:43], v[220:223]
ds_read_b64_tr_b16 v[68:69], v3 offset:62464
v_mfma_f32_16x16x32_bf16 v[224:227], v[72:75], v[40:43], 0
ds_read_b64_tr_b16 v[70:71], v3 offset:64256
v_mfma_f32_16x16x32_bf16 v[224:227], v[76:79], v[44:47], v[224:227]
ds_read_b64_tr_b16 v[64:65], v3 offset:55296
v_mfma_f32_16x16x32_bf16 v[244:247], v[76:79], v[52:55], 0
ds_read_b64_tr_b16 v[66:67], v3 offset:57088
v_mfma_f32_16x16x32_bf16 v[244:247], v[72:75], v[48:51], v[244:247]
ds_read_b64_tr_b16 v[76:77], v4 offset:47168
v_mfma_f32_16x16x32_bf16 v[248:251], v[80:83], v[48:51], 0
ds_read_b64_tr_b16 v[78:79], v4 offset:48704
v_mfma_f32_16x16x32_bf16 v[248:251], v[84:87], v[52:55], v[248:251]
ds_read_b64_tr_b16 v[72:73], v4 offset:41024
v_mfma_f32_16x16x32_bf16 v[228:231], v[84:87], v[44:47], 0
ds_read_b64_tr_b16 v[74:75], v4 offset:42560
v_mfma_f32_16x16x32_bf16 v[228:231], v[80:83], v[40:43], v[228:231]
ds_read_b64_tr_b16 v[84:85], v5 offset:47200
v_mfma_f32_16x16x32_bf16 v[232:235], v[88:91], v[40:43], 0
ds_read_b64_tr_b16 v[86:87], v5 offset:48736
v_mfma_f32_16x16x32_bf16 v[232:235], v[92:95], v[44:47], v[232:235]
ds_read_b64_tr_b16 v[80:81], v5 offset:41056
v_mfma_f32_16x16x32_bf16 v[252:255], v[92:95], v[52:55], 0
ds_read_b64_tr_b16 v[82:83], v5 offset:42592
v_mfma_f32_16x16x32_bf16 v[252:255], v[88:91], v[48:51], v[252:255]
ds_read_b64_tr_b16 v[92:93], v4 offset:47104
s_waitcnt lgkmcnt(13)
v_mfma_f32_16x16x32_bf16 v[96:99], v[56:59], v[24:27], v[96:99]
ds_read_b64_tr_b16 v[94:95], v4 offset:48640
v_mfma_f32_16x16x32_bf16 v[96:99], v[60:63], v[28:31], v[96:99]
ds_read_b64_tr_b16 v[88:89], v4 offset:40960
v_mfma_f32_16x16x32_bf16 v[116:119], v[60:63], v[36:39], v[116:119]
ds_read_b64_tr_b16 v[90:91], v4 offset:42496
v_mfma_f32_16x16x32_bf16 v[116:119], v[56:59], v[32:35], v[116:119]
ds_read_b128 v[40:43], v1 offset:36864
s_mov_b32 m0, s39
s_waitcnt lgkmcnt(13)
v_mfma_f32_16x16x32_bf16 v[120:123], v[64:67], v[32:35], v[120:123]
ds_read_b128 v[44:47], v2 offset:36864
buffer_load_dwordx4 v8, s[20:23], s30 offen lds
v_mfma_f32_16x16x32_bf16 v[120:123], v[68:71], v[36:39], v[120:123]
ds_read_b128 v[52:55], v2 offset:38912
v_mfma_f32_16x16x32_bf16 v[100:103], v[68:71], v[28:31], v[100:103]
ds_read_b128 v[48:51], v1 offset:38912
v_mfma_f32_16x16x32_bf16 v[100:103], v[64:67], v[24:27], v[100:103]
s_add_u32 s41, s28, 131072
s_waitcnt lgkmcnt(12)
v_mfma_f32_16x16x32_bf16 v[104:107], v[72:75], v[24:27], v[104:107]
s_add_u32 m0, s40, 8192
v_mfma_f32_16x16x32_bf16 v[104:107], v[76:79], v[28:31], v[104:107]
buffer_load_dwordx4 v6, s[8:11], s41 offen lds
v_mfma_f32_16x16x32_bf16 v[124:127], v[76:79], v[36:39], v[124:127]
v_mfma_f32_16x16x32_bf16 v[124:127], v[72:75], v[32:35], v[124:127]
s_waitcnt lgkmcnt(8)
v_mfma_f32_16x16x32_bf16 v[128:131], v[80:83], v[32:35], v[128:131]
s_add_u32 s41, s28, 393216
v_mfma_f32_16x16x32_bf16 v[128:131], v[84:87], v[36:39], v[128:131]
s_add_u32 m0, s40, 24576
v_mfma_f32_16x16x32_bf16 v[108:111], v[84:87], v[28:31], v[108:111]
buffer_load_dwordx4 v6, s[8:11], s41 offen lds
v_mfma_f32_16x16x32_bf16 v[108:111], v[80:83], v[24:27], v[108:111]
s_waitcnt lgkmcnt(4)
v_mfma_f32_16x16x32_bf16 v[112:115], v[88:91], v[24:27], v[112:115]
v_mfma_f32_16x16x32_bf16 v[112:115], v[92:95], v[28:31], v[112:115]
v_mfma_f32_16x16x32_bf16 v[132:135], v[92:95], v[36:39], v[132:135]
v_mfma_f32_16x16x32_bf16 v[132:135], v[88:91], v[32:35], v[132:135]
s_waitcnt lgkmcnt(0)
s_barrier
v_mfma_f32_16x16x32_bf16 v[136:139], v[56:59], v[40:43], v[136:139]
ds_read_b128 v[24:27], v1 offset:40960
s_add_u32 s28, s28, 128
v_mfma_f32_16x16x32_bf16 v[136:139], v[60:63], v[44:47], v[136:139]
ds_read_b128 v[28:31], v2 offset:40960
s_add_u32 s29, s29, s31
v_mfma_f32_16x16x32_bf16 v[156:159], v[60:63], v[52:55], v[156:159]
ds_read_b128 v[36:39], v2 offset:43008
s_add_u32 s30, s30, 393216
v_mfma_f32_16x16x32_bf16 v[156:159], v[56:59], v[48:51], v[156:159]
ds_read_b128 v[32:35], v1 offset:43008
v_mfma_f32_16x16x32_bf16 v[160:163], v[64:67], v[48:51], v[160:163]
s_add_u32 m0, s40, 32768
v_mfma_f32_16x16x32_bf16 v[160:163], v[68:71], v[52:55], v[160:163]
buffer_load_dwordx4 v6, s[8:11], s28 offen lds
v_mfma_f32_16x16x32_bf16 v[140:143], v[68:71], v[44:47], v[140:143]
v_mfma_f32_16x16x32_bf16 v[140:143], v[64:67], v[40:43], v[140:143]
v_mfma_f32_16x16x32_bf16 v[144:147], v[72:75], v[40:43], v[144:147]
s_cmp_eq_u32 s43, 5
s_cmov_b32 s98, 28672
s_cmov_b32 s101, 8192
v_mfma_f32_16x16x32_bf16 v[144:147], v[76:79], v[44:47], v[144:147]
s_add_u32 s41, s28, 262144
v_mfma_f32_16x16x32_bf16 v[164:167], v[76:79], v[52:55], v[164:167]
s_add_u32 m0, s40, 49152
v_mfma_f32_16x16x32_bf16 v[164:167], v[72:75], v[48:51], v[164:167]
buffer_load_dwordx4 v6, s[8:11], s41 offen lds
v_mfma_f32_16x16x32_bf16 v[168:171], v[80:83], v[48:51], v[168:171]
v_mfma_f32_16x16x32_bf16 v[168:171], v[84:87], v[52:55], v[168:171]
v_mfma_f32_16x16x32_bf16 v[148:151], v[84:87], v[44:47], v[148:151]
v_mfma_f32_16x16x32_bf16 v[148:151], v[80:83], v[40:43], v[148:151]
v_mfma_f32_16x16x32_bf16 v[152:155], v[88:91], v[40:43], v[152:155]
s_add_u32 m0, s35, 40960
v_mfma_f32_16x16x32_bf16 v[152:155], v[92:95], v[44:47], v[152:155]
buffer_load_dwordx4 v7, s[12:15], s29 offen lds
v_mfma_f32_16x16x32_bf16 v[172:175], v[92:95], v[52:55], v[172:175]
v_mfma_f32_16x16x32_bf16 v[172:175], v[88:91], v[48:51], v[172:175]
s_waitcnt lgkmcnt(3)
v_mfma_f32_16x16x32_bf16 v[176:179], v[56:59], v[24:27], v[176:179]
ds_read_b128 v[40:43], v1 offset:45056
s_waitcnt lgkmcnt(3)
v_mfma_f32_16x16x32_bf16 v[176:179], v[60:63], v[28:31], v[176:179]
ds_read_b128 v[44:47], v2 offset:45056
s_waitcnt lgkmcnt(3)
v_mfma_f32_16x16x32_bf16 v[196:199], v[60:63], v[36:39], v[196:199]
ds_read_b128 v[52:55], v2 offset:47104
s_waitcnt lgkmcnt(3)
v_mfma_f32_16x16x32_bf16 v[196:199], v[56:59], v[32:35], v[196:199]
ds_read_b128 v[48:51], v1 offset:47104
v_mfma_f32_16x16x32_bf16 v[200:203], v[64:67], v[32:35], v[200:203]
s_add_u32 s41, s29, s32
v_mfma_f32_16x16x32_bf16 v[200:203], v[68:71], v[36:39], v[200:203]
s_add_u32 m0, s36, 40960
v_mfma_f32_16x16x32_bf16 v[180:183], v[68:71], v[28:31], v[180:183]
buffer_load_dwordx4 v7, s[12:15], s41 offen lds
v_mfma_f32_16x16x32_bf16 v[180:183], v[64:67], v[24:27], v[180:183]
s_add_u32 s41, s29, s33
v_mfma_f32_16x16x32_bf16 v[184:187], v[72:75], v[24:27], v[184:187]
s_add_u32 m0, s37, 40960
v_mfma_f32_16x16x32_bf16 v[184:187], v[76:79], v[28:31], v[184:187]
buffer_load_dwordx4 v7, s[16:19], s41 offen lds
v_mfma_f32_16x16x32_bf16 v[204:207], v[76:79], v[36:39], v[204:207]
v_mfma_f32_16x16x32_bf16 v[204:207], v[72:75], v[32:35], v[204:207]
v_mfma_f32_16x16x32_bf16 v[208:211], v[80:83], v[32:35], v[208:211]
v_mfma_f32_16x16x32_bf16 v[208:211], v[84:87], v[36:39], v[208:211]
v_mfma_f32_16x16x32_bf16 v[188:191], v[84:87], v[28:31], v[188:191]
v_mfma_f32_16x16x32_bf16 v[188:191], v[80:83], v[24:27], v[188:191]
v_mfma_f32_16x16x32_bf16 v[192:195], v[88:91], v[24:27], v[192:195]
v_mfma_f32_16x16x32_bf16 v[192:195], v[92:95], v[28:31], v[192:195]
v_mfma_f32_16x16x32_bf16 v[212:215], v[92:95], v[36:39], v[212:215]
v_mfma_f32_16x16x32_bf16 v[212:215], v[88:91], v[32:35], v[212:215]
s_cmp_lt_u32 s100, s98
s_cbranch_scc1 L_pf_75
L_pfb_76:
s_cmp_eq_u32 s50, 1
s_cbranch_scc1 L_cs_77
L_csb_78:
s_waitcnt vmcnt(7) lgkmcnt(0)
s_barrier
v_mfma_f32_16x16x32_bf16 v[216:219], v[56:59], v[40:43], v[216:219]
ds_read_b128 v[24:27], v1 offset:0
v_mfma_f32_16x16x32_bf16 v[216:219], v[60:63], v[44:47], v[216:219]
ds_read_b128 v[28:31], v2 offset:0
s_cmp_eq_u32 s43, 0
s_cbranch_scc1 L_nc_80
L_ncb_81:
v_mfma_f32_16x16x32_bf16 v[236:239], v[60:63], v[52:55], v[236:239]
ds_read_b128 v[36:39], v2 offset:2048
s_add_u32 s42, s42, 1
v_mfma_f32_16x16x32_bf16 v[236:239], v[56:59], v[48:51], v[236:239]
ds_read_b128 v[32:35], v1 offset:2048
ds_read_b64_tr_b16 v[60:61], v3 offset:7168
v_mfma_f32_16x16x32_bf16 v[240:243], v[64:67], v[48:51], v[240:243]
ds_read_b64_tr_b16 v[62:63], v3 offset:8960
s_add_u32 s41, s29, s34
v_mfma_f32_16x16x32_bf16 v[240:243], v[68:71], v[52:55], v[240:243]
ds_read_b64_tr_b16 v[56:57], v3 offset:0
s_add_u32 m0, s38, 40960
v_mfma_f32_16x16x32_bf16 v[220:223], v[68:71], v[44:47], v[220:223]
ds_read_b64_tr_b16 v[58:59], v3 offset:1792
buffer_load_dwordx4 v7, s[16:19], s41 offen lds
v_mfma_f32_16x16x32_bf16 v[220:223], v[64:67], v[40:43], v[220:223]
ds_read_b64_tr_b16 v[68:69], v3 offset:21504
v_mfma_f32_16x16x32_bf16 v[224:227], v[72:75], v[40:43], v[224:227]
ds_read_b64_tr_b16 v[70:71], v3 offset:23296
v_mfma_f32_16x16x32_bf16 v[224:227], v[76:79], v[44:47], v[224:227]
ds_read_b64_tr_b16 v[64:65], v3 offset:14336
v_mfma_f32_16x16x32_bf16 v[244:247], v[76:79], v[52:55], v[244:247]
ds_read_b64_tr_b16 v[66:67], v3 offset:16128
v_mfma_f32_16x16x32_bf16 v[244:247], v[72:75], v[48:51], v[244:247]
ds_read_b64_tr_b16 v[76:77], v4 offset:6208
v_mfma_f32_16x16x32_bf16 v[248:251], v[80:83], v[48:51], v[248:251]
ds_read_b64_tr_b16 v[78:79], v4 offset:7744
v_mfma_f32_16x16x32_bf16 v[248:251], v[84:87], v[52:55], v[248:251]
ds_read_b64_tr_b16 v[72:73], v4 offset:64
v_mfma_f32_16x16x32_bf16 v[228:231], v[84:87], v[44:47], v[228:231]
ds_read_b64_tr_b16 v[74:75], v4 offset:1600
v_mfma_f32_16x16x32_bf16 v[228:231], v[80:83], v[40:43], v[228:231]
ds_read_b64_tr_b16 v[84:85], v5 offset:6240
v_mfma_f32_16x16x32_bf16 v[232:235], v[88:91], v[40:43], v[232:235]
ds_read_b64_tr_b16 v[86:87], v5 offset:7776
v_mfma_f32_16x16x32_bf16 v[232:235], v[92:95], v[44:47], v[232:235]
ds_read_b64_tr_b16 v[80:81], v5 offset:96
v_mfma_f32_16x16x32_bf16 v[252:255], v[92:95], v[52:55], v[252:255]
ds_read_b64_tr_b16 v[82:83], v5 offset:1632
v_mfma_f32_16x16x32_bf16 v[252:255], v[88:91], v[48:51], v[252:255]
ds_read_b64_tr_b16 v[92:93], v4 offset:6144
.p2align 6
L_loop_84:
s_waitcnt lgkmcnt(13)
v_mfma_f32_16x16x32_bf16 v[96:99], v[56:59], v[24:27], v[96:99]
ds_read_b64_tr_b16 v[94:95], v4 offset:7680
v_mfma_f32_16x16x32_bf16 v[96:99], v[60:63], v[28:31], v[96:99]
ds_read_b64_tr_b16 v[88:89], v4 offset:0
v_mfma_f32_16x16x32_bf16 v[116:119], v[60:63], v[36:39], v[116:119]
ds_read_b64_tr_b16 v[90:91], v4 offset:1536
v_mfma_f32_16x16x32_bf16 v[116:119], v[56:59], v[32:35], v[116:119]
ds_read_b128 v[40:43], v1 offset:4096
s_add_u32 m0, s39, 40960
s_waitcnt lgkmcnt(13)
v_mfma_f32_16x16x32_bf16 v[120:123], v[64:67], v[32:35], v[120:123]
ds_read_b128 v[44:47], v2 offset:4096
buffer_load_dwordx4 v8, s[20:23], s30 offen lds
v_mfma_f32_16x16x32_bf16 v[120:123], v[68:71], v[36:39], v[120:123]
ds_read_b128 v[52:55], v2 offset:6144
v_mfma_f32_16x16x32_bf16 v[100:103], v[68:71], v[28:31], v[100:103]
ds_read_b128 v[48:51], v1 offset:6144
v_mfma_f32_16x16x32_bf16 v[100:103], v[64:67], v[24:27], v[100:103]
s_add_u32 s41, s28, 131072
s_waitcnt lgkmcnt(12)
v_mfma_f32_16x16x32_bf16 v[104:107], v[72:75], v[24:27], v[104:107]
s_add_u32 m0, s40, 40960
v_mfma_f32_16x16x32_bf16 v[104:107], v[76:79], v[28:31], v[104:107]
buffer_load_dwordx4 v6, s[8:11], s41 offen lds
v_mfma_f32_16x16x32_bf16 v[124:127], v[76:79], v[36:39], v[124:127]
v_mfma_f32_16x16x32_bf16 v[124:127], v[72:75], v[32:35], v[124:127]
s_waitcnt lgkmcnt(8)
v_mfma_f32_16x16x32_bf16 v[128:131], v[80:83], v[32:35], v[128:131]
s_add_u32 s41, s28, 393216
v_mfma_f32_16x16x32_bf16 v[128:131], v[84:87], v[36:39], v[128:131]
s_add_u32 m0, s40, 57344
v_mfma_f32_16x16x32_bf16 v[108:111], v[84:87], v[28:31], v[108:111]
buffer_load_dwordx4 v6, s[8:11], s41 offen lds
v_mfma_f32_16x16x32_bf16 v[108:111], v[80:83], v[24:27], v[108:111]
s_waitcnt lgkmcnt(4)
v_mfma_f32_16x16x32_bf16 v[112:115], v[88:91], v[24:27], v[112:115]
v_mfma_f32_16x16x32_bf16 v[112:115], v[92:95], v[28:31], v[112:115]
v_mfma_f32_16x16x32_bf16 v[132:135], v[92:95], v[36:39], v[132:135]
v_mfma_f32_16x16x32_bf16 v[132:135], v[88:91], v[32:35], v[132:135]
s_waitcnt vmcnt(9) lgkmcnt(0)
s_barrier
v_mfma_f32_16x16x32_bf16 v[136:139], v[56:59], v[40:43], v[136:139]
ds_read_b128 v[24:27], v1 offset:8192
s_add_u32 s28, s28, 128
v_mfma_f32_16x16x32_bf16 v[136:139], v[60:63], v[44:47], v[136:139]
ds_read_b128 v[28:31], v2 offset:8192
s_add_u32 s29, s29, s31
v_mfma_f32_16x16x32_bf16 v[156:159], v[60:63], v[52:55], v[156:159]
ds_read_b128 v[36:39], v2 offset:10240
s_add_u32 s30, s30, 393216
s_cmp_eq_u32 s49, s42
s_cbranch_scc1 L_rs_85
L_rsb_86:
s_cmp_eq_u32 s48, s42
s_cbranch_scc1 L_rw_87
L_rwb_88:
v_mfma_f32_16x16x32_bf16 v[156:159], v[56:59], v[48:51], v[156:159]
ds_read_b128 v[32:35], v1 offset:10240
v_mfma_f32_16x16x32_bf16 v[160:163], v[64:67], v[48:51], v[160:163]
s_add_u32 m0, s40, 0
v_mfma_f32_16x16x32_bf16 v[160:163], v[68:71], v[52:55], v[160:163]
buffer_load_dwordx4 v6, s[8:11], s28 offen lds
v_mfma_f32_16x16x32_bf16 v[140:143], v[68:71], v[44:47], v[140:143]
v_mfma_f32_16x16x32_bf16 v[140:143], v[64:67], v[40:43], v[140:143]
v_mfma_f32_16x16x32_bf16 v[144:147], v[72:75], v[40:43], v[144:147]
v_mfma_f32_16x16x32_bf16 v[144:147], v[76:79], v[44:47], v[144:147]
s_add_u32 s41, s28, 262144
v_mfma_f32_16x16x32_bf16 v[164:167], v[76:79], v[52:55], v[164:167]
s_add_u32 m0, s40, 16384
v_mfma_f32_16x16x32_bf16 v[164:167], v[72:75], v[48:51], v[164:167]
buffer_load_dwordx4 v6, s[8:11], s41 offen lds
v_mfma_f32_16x16x32_bf16 v[168:171], v[80:83], v[48:51], v[168:171]
v_mfma_f32_16x16x32_bf16 v[168:171], v[84:87], v[52:55], v[168:171]
v_mfma_f32_16x16x32_bf16 v[148:151], v[84:87], v[44:47], v[148:151]
v_mfma_f32_16x16x32_bf16 v[148:151], v[80:83], v[40:43], v[148:151]
v_mfma_f32_16x16x32_bf16 v[152:155], v[88:91], v[40:43], v[152:155]
s_mov_b32 m0, s35
v_mfma_f32_16x16x32_bf16 v[152:155], v[92:95], v[44:47], v[152:155]
buffer_load_dwordx4 v7, s[12:15], s29 offen lds
v_mfma_f32_16x16x32_bf16 v[172:175], v[92:95], v[52:55], v[172:175]
v_mfma_f32_16x16x32_bf16 v[172:175], v[88:91], v[48:51], v[172:175]
s_waitcnt lgkmcnt(3)
v_mfma_f32_16x16x32_bf16 v[176:179], v[56:59], v[24:27], v[176:179]
ds_read_b128 v[40:43], v1 offset:12288
s_waitcnt lgkmcnt(3)
v_mfma_f32_16x16x32_bf16 v[176:179], v[60:63], v[28:31], v[176:179]
ds_read_b128 v[44:47], v2 offset:12288
s_waitcnt lgkmcnt(3)
v_mfma_f32_16x16x32_bf16 v[196:199], v[60:63], v[36:39], v[196:199]
ds_read_b128 v[52:55], v2 offset:14336
s_waitcnt lgkmcnt(3)
v_mfma_f32_16x16x32_bf16 v[196:199], v[56:59], v[32:35], v[196:199]
ds_read_b128 v[48:51], v1 offset:14336
v_mfma_f32_16x16x32_bf16 v[200:203], v[64:67], v[32:35], v[200:203]
s_add_u32 s41, s29, s32
v_mfma_f32_16x16x32_bf16 v[200:203], v[68:71], v[36:39], v[200:203]
s_mov_b32 m0, s36
v_mfma_f32_16x16x32_bf16 v[180:183], v[68:71], v[28:31], v[180:183]
buffer_load_dwordx4 v7, s[12:15], s41 offen lds
v_mfma_f32_16x16x32_bf16 v[180:183], v[64:67], v[24:27], v[180:183]
s_add_u32 s41, s29, s33
v_mfma_f32_16x16x32_bf16 v[184:187], v[72:75], v[24:27], v[184:187]
s_mov_b32 m0, s37
v_mfma_f32_16x16x32_bf16 v[184:187], v[76:79], v[28:31], v[184:187]
buffer_load_dwordx4 v7, s[16:19], s41 offen lds
v_mfma_f32_16x16x32_bf16 v[204:207], v[76:79], v[36:39], v[204:207]
v_mfma_f32_16x16x32_bf16 v[204:207], v[72:75], v[32:35], v[204:207]
v_mfma_f32_16x16x32_bf16 v[208:211], v[80:83], v[32:35], v[208:211]
v_mfma_f32_16x16x32_bf16 v[208:211], v[84:87], v[36:39], v[208:211]
v_mfma_f32_16x16x32_bf16 v[188:191], v[84:87], v[28:31], v[188:191]
v_mfma_f32_16x16x32_bf16 v[188:191], v[80:83], v[24:27], v[188:191]
v_mfma_f32_16x16x32_bf16 v[192:195], v[88:91], v[24:27], v[192:195]
v_mfma_f32_16x16x32_bf16 v[192:195], v[92:95], v[28:31], v[192:195]
v_mfma_f32_16x16x32_bf16 v[212:215], v[92:95], v[36:39], v[212:215]
v_mfma_f32_16x16x32_bf16 v[212:215], v[88:91], v[32:35], v[212:215]
s_cmp_lt_u32 s100, s98
s_cbranch_scc1 L_pf_89
L_pfb_90:
s_cmp_eq_u32 s87, s42
s_cbranch_scc1 L_cs_91
L_csb_92:
s_waitcnt vmcnt(7) lgkmcnt(0)
s_barrier
v_mfma_f32_16x16x32_bf16 v[216:219], v[56:59], v[40:43], v[216:219]
ds_read_b128 v[24:27], v1 offset:32768
v_mfma_f32_16x16x32_bf16 v[216:219], v[60:63], v[44:47], v[216:219]
ds_read_b128 v[28:31], v2 offset:32768
s_cmp_eq_u32 s89, s42
s_cbranch_scc1 L_fl_94
L_flb_95:
v_mfma_f32_16x16x32_bf16 v[236:239], v[60:63], v[52:55], v[236:239]
ds_read_b128 v[36:39], v2 offset:34816
s_add_u32 s42, s42, 1
v_mfma_f32_16x16x32_bf16 v[236:239], v[56:59], v[48:51], v[236:239]
ds_read_b128 v[32:35], v1 offset:34816
ds_read_b64_tr_b16 v[60:61], v3 offset:48128
v_mfma_f32_16x16x32_bf16 v[240:243], v[64:67], v[48:51], v[240:243]
ds_read_b64_tr_b16 v[62:63], v3 offset:49920
s_add_u32 s41, s29, s34
v_mfma_f32_16x16x32_bf16 v[240:243], v[68:71], v[52:55], v[240:243]
ds_read_b64_tr_b16 v[56:57], v3 offset:40960
s_mov_b32 m0, s38
v_mfma_f32_16x16x32_bf16 v[220:223], v[68:71], v[44:47], v[220:223]
ds_read_b64_tr_b16 v[58:59], v3 offset:42752
buffer_load_dwordx4 v7, s[16:19], s41 offen lds
v_mfma_f32_16x16x32_bf16 v[220:223], v[64:67], v[40:43], v[220:223]
ds_read_b64_tr_b16 v[68:69], v3 offset:62464
v_mfma_f32_16x16x32_bf16 v[224:227], v[72:75], v[40:43], v[224:227]
ds_read_b64_tr_b16 v[70:71], v3 offset:64256
v_mfma_f32_16x16x32_bf16 v[224:227], v[76:79], v[44:47], v[224:227]
ds_read_b64_tr_b16 v[64:65], v3 offset:55296
v_mfma_f32_16x16x32_bf16 v[244:247], v[76:79], v[52:55], v[244:247]
ds_read_b64_tr_b16 v[66:67], v3 offset:57088
v_mfma_f32_16x16x32_bf16 v[244:247], v[72:75], v[48:51], v[244:247]
ds_read_b64_tr_b16 v[76:77], v4 offset:47168
v_mfma_f32_16x16x32_bf16 v[248:251], v[80:83], v[48:51], v[248:251]
ds_read_b64_tr_b16 v[78:79], v4 offset:48704
v_mfma_f32_16x16x32_bf16 v[248:251], v[84:87], v[52:55], v[248:251]
ds_read_b64_tr_b16 v[72:73], v4 offset:41024
v_mfma_f32_16x16x32_bf16 v[228:231], v[84:87], v[44:47], v[228:231]
ds_read_b64_tr_b16 v[74:75], v4 offset:42560
v_mfma_f32_16x16x32_bf16 v[228:231], v[80:83], v[40:43], v[228:231]
ds_read_b64_tr_b16 v[84:85], v5 offset:47200
v_mfma_f32_16x16x32_bf16 v[232:235], v[88:91], v[40:43], v[232:235]
ds_read_b64_tr_b16 v[86:87], v5 offset:48736
v_mfma_f32_16x16x32_bf16 v[232:235], v[92:95], v[44:47], v[232:235]
ds_read_b64_tr_b16 v[80:81], v5 offset:41056
v_mfma_f32_16x16x32_bf16 v[252:255], v[92:95], v[52:55], v[252:255]
ds_read_b64_tr_b16 v[82:83], v5 offset:42592
v_mfma_f32_16x16x32_bf16 v[252:255], v[88:91], v[48:51], v[252:255]
ds_read_b64_tr_b16 v[92:93], v4 offset:47104
s_waitcnt lgkmcnt(13)
v_mfma_f32_16x16x32_bf16 v[96:99], v[56:59], v[24:27], v[96:99]
ds_read_b64_tr_b16 v[94:95], v4 offset:48640
v_mfma_f32_16x16x32_bf16 v[96:99], v[60:63], v[28:31], v[96:99]
ds_read_b64_tr_b16 v[88:89], v4 offset:40960
v_mfma_f32_16x16x32_bf16 v[116:119], v[60:63], v[36:39], v[116:119]
ds_read_b64_tr_b16 v[90:91], v4 offset:42496
v_mfma_f32_16x16x32_bf16 v[116:119], v[56:59], v[32:35], v[116:119]
ds_read_b128 v[40:43], v1 offset:36864
s_mov_b32 m0, s39
s_waitcnt lgkmcnt(13)
v_mfma_f32_16x16x32_bf16 v[120:123], v[64:67], v[32:35], v[120:123]
ds_read_b128 v[44:47], v2 offset:36864
buffer_load_dwordx4 v8, s[20:23], s30 offen lds
v_mfma_f32_16x16x32_bf16 v[120:123], v[68:71], v[36:39], v[120:123]
ds_read_b128 v[52:55], v2 offset:38912
v_mfma_f32_16x16x32_bf16 v[100:103], v[68:71], v[28:31], v[100:103]
ds_read_b128 v[48:51], v1 offset:38912
v_mfma_f32_16x16x32_bf16 v[100:103], v[64:67], v[24:27], v[100:103]
s_add_u32 s41, s28, 131072
s_waitcnt lgkmcnt(12)
v_mfma_f32_16x16x32_bf16 v[104:107], v[72:75], v[24:27], v[104:107]
s_add_u32 m0, s40, 8192
v_mfma_f32_16x16x32_bf16 v[104:107], v[76:79], v[28:31], v[104:107]
buffer_load_dwordx4 v6, s[8:11], s41 offen lds
v_mfma_f32_16x16x32_bf16 v[124:127], v[76:79], v[36:39], v[124:127]
v_mfma_f32_16x16x32_bf16 v[124:127], v[72:75], v[32:35], v[124:127]
s_waitcnt lgkmcnt(8)
v_mfma_f32_16x16x32_bf16 v[128:131], v[80:83], v[32:35], v[128:131]
s_add_u32 s41, s28, 393216
v_mfma_f32_16x16x32_bf16 v[128:131], v[84:87], v[36:39], v[128:131]
s_add_u32 m0, s40, 24576
v_mfma_f32_16x16x32_bf16 v[108:111], v[84:87], v[28:31], v[108:111]
buffer_load_dwordx4 v6, s[8:11], s41 offen lds
v_mfma_f32_16x16x32_bf16 v[108:111], v[80:83], v[24:27], v[108:111]
s_waitcnt lgkmcnt(4)
v_mfma_f32_16x16x32_bf16 v[112:115], v[88:91], v[24:27], v[112:115]
v_mfma_f32_16x16x32_bf16 v[112:115], v[92:95], v[28:31], v[112:115]
v_mfma_f32_16x16x32_bf16 v[132:135], v[92:95], v[36:39], v[132:135]
v_mfma_f32_16x16x32_bf16 v[132:135], v[88:91], v[32:35], v[132:135]
s_waitcnt vmcnt(9) lgkmcnt(0)
s_barrier
v_mfma_f32_16x16x32_bf16 v[136:139], v[56:59], v[40:43], v[136:139]
ds_read_b128 v[24:27], v1 offset:40960
s_add_u32 s28, s28, 128
v_mfma_f32_16x16x32_bf16 v[136:139], v[60:63], v[44:47], v[136:139]
ds_read_b128 v[28:31], v2 offset:40960
s_add_u32 s29, s29, s31
v_mfma_f32_16x16x32_bf16 v[156:159], v[60:63], v[52:55], v[156:159]
ds_read_b128 v[36:39], v2 offset:43008
s_add_u32 s30, s30, 393216
s_cmp_eq_u32 s49, s42
s_cbranch_scc1 L_rs_96
L_rsb_97:
s_cmp_eq_u32 s48, s42
s_cbranch_scc1 L_rw_98
L_rwb_99:
s_cmp_eq_u32 s88, s42
s_cbranch_scc1 L_fs_100
L_fsb_101:
v_mfma_f32_16x16x32_bf16 v[156:159], v[56:59], v[48:51], v[156:159]
ds_read_b128 v[32:35], v1 offset:43008
v_mfma_f32_16x16x32_bf16 v[160:163], v[64:67], v[48:51], v[160:163]
s_add_u32 m0, s40, 32768
v_mfma_f32_16x16x32_bf16 v[160:163], v[68:71], v[52:55], v[160:163]
buffer_load_dwordx4 v6, s[8:11], s28 offen lds
v_mfma_f32_16x16x32_bf16 v[140:143], v[68:71], v[44:47], v[140:143]
v_mfma_f32_16x16x32_bf16 v[140:143], v[64:67], v[40:43], v[140:143]
v_mfma_f32_16x16x32_bf16 v[144:147], v[72:75], v[40:43], v[144:147]
v_mfma_f32_16x16x32_bf16 v[144:147], v[76:79], v[44:47], v[144:147]
s_add_u32 s41, s28, 262144
v_mfma_f32_16x16x32_bf16 v[164:167], v[76:79], v[52:55], v[164:167]
s_add_u32 m0, s40, 49152
v_mfma_f32_16x16x32_bf16 v[164:167], v[72:75], v[48:51], v[164:167]
buffer_load_dwordx4 v6, s[8:11], s41 offen lds
v_mfma_f32_16x16x32_bf16 v[168:171], v[80:83], v[48:51], v[168:171]
v_mfma_f32_16x16x32_bf16 v[168:171], v[84:87], v[52:55], v[168:171]
v_mfma_f32_16x16x32_bf16 v[148:151], v[84:87], v[44:47], v[148:151]
v_mfma_f32_16x16x32_bf16 v[148:151], v[80:83], v[40:43], v[148:151]
v_mfma_f32_16x16x32_bf16 v[152:155], v[88:91], v[40:43], v[152:155]
s_add_u32 m0, s35, 40960
v_mfma_f32_16x16x32_bf16 v[152:155], v[92:95], v[44:47], v[152:155]
buffer_load_dwordx4 v7, s[12:15], s29 offen lds
v_mfma_f32_16x16x32_bf16 v[172:175], v[92:95], v[52:55], v[172:175]
v_mfma_f32_16x16x32_bf16 v[172:175], v[88:91], v[48:51], v[172:175]
s_waitcnt lgkmcnt(3)
v_mfma_f32_16x16x32_bf16 v[176:179], v[56:59], v[24:27], v[176:179]
ds_read_b128 v[40:43], v1 offset:45056
s_waitcnt lgkmcnt(3)
v_mfma_f32_16x16x32_bf16 v[176:179], v[60:63], v[28:31], v[176:179]
ds_read_b128 v[44:47], v2 offset:45056
s_waitcnt lgkmcnt(3)
v_mfma_f32_16x16x32_bf16 v[196:199], v[60:63], v[36:39], v[196:199]
ds_read_b128 v[52:55], v2 offset:47104
s_waitcnt lgkmcnt(3)
v_mfma_f32_16x16x32_bf16 v[196:199], v[56:59], v[32:35], v[196:199]
ds_read_b128 v[48:51], v1 offset:47104
v_mfma_f32_16x16x32_bf16 v[200:203], v[64:67], v[32:35], v[200:203]
s_add_u32 s41, s29, s32
v_mfma_f32_16x16x32_bf16 v[200:203], v[68:71], v[36:39], v[200:203]
s_add_u32 m0, s36, 40960
v_mfma_f32_16x16x32_bf16 v[180:183], v[68:71], v[28:31], v[180:183]
buffer_load_dwordx4 v7, s[12:15], s41 offen lds
v_mfma_f32_16x16x32_bf16 v[180:183], v[64:67], v[24:27], v[180:183]
s_add_u32 s41, s29, s33
v_mfma_f32_16x16x32_bf16 v[184:187], v[72:75], v[24:27], v[184:187]
s_add_u32 m0, s37, 40960
v_mfma_f32_16x16x32_bf16 v[184:187], v[76:79], v[28:31], v[184:187]
buffer_load_dwordx4 v7, s[16:19], s41 offen lds
v_mfma_f32_16x16x32_bf16 v[204:207], v[76:79], v[36:39], v[204:207]
v_mfma_f32_16x16x32_bf16 v[204:207], v[72:75], v[32:35], v[204:207]
v_mfma_f32_16x16x32_bf16 v[208:211], v[80:83], v[32:35], v[208:211]
v_mfma_f32_16x16x32_bf16 v[208:211], v[84:87], v[36:39], v[208:211]
v_mfma_f32_16x16x32_bf16 v[188:191], v[84:87], v[28:31], v[188:191]
v_mfma_f32_16x16x32_bf16 v[188:191], v[80:83], v[24:27], v[188:191]
v_mfma_f32_16x16x32_bf16 v[192:195], v[88:91], v[24:27], v[192:195]
v_mfma_f32_16x16x32_bf16 v[192:195], v[92:95], v[28:31], v[192:195]
v_mfma_f32_16x16x32_bf16 v[212:215], v[92:95], v[36:39], v[212:215]
v_mfma_f32_16x16x32_bf16 v[212:215], v[88:91], v[32:35], v[212:215]
s_cmp_eq_u32 s50, s42
s_cbranch_scc1 L_cs_102
L_csb_103:
s_cmp_eq_u32 s51, s42
s_cbranch_scc1 L_cs_105
L_csb_106:
s_waitcnt vmcnt(7) lgkmcnt(0)
s_barrier
v_mfma_f32_16x16x32_bf16 v[216:219], v[56:59], v[40:43], v[216:219]
ds_read_b128 v[24:27], v1 offset:0
v_mfma_f32_16x16x32_bf16 v[216:219], v[60:63], v[44:47], v[216:219]
ds_read_b128 v[28:31], v2 offset:0
s_cmp_eq_u32 s89, s42
s_cbranch_scc1 L_fl_107
L_flb_108:
v_mfma_f32_16x16x32_bf16 v[236:239], v[60:63], v[52:55], v[236:239]
ds_read_b128 v[36:39], v2 offset:2048
s_add_u32 s42, s42, 1
v_mfma_f32_16x16x32_bf16 v[236:239], v[56:59], v[48:51], v[236:239]
ds_read_b128 v[32:35], v1 offset:2048
ds_read_b64_tr_b16 v[60:61], v3 offset:7168
v_mfma_f32_16x16x32_bf16 v[240:243], v[64:67], v[48:51], v[240:243]
ds_read_b64_tr_b16 v[62:63], v3 offset:8960
s_add_u32 s41, s29, s34
v_mfma_f32_16x16x32_bf16 v[240:243], v[68:71], v[52:55], v[240:243]
ds_read_b64_tr_b16 v[56:57], v3 offset:0
s_add_u32 m0, s38, 40960
v_mfma_f32_16x16x32_bf16 v[220:223], v[68:71], v[44:47], v[220:223]
ds_read_b64_tr_b16 v[58:59], v3 offset:1792
buffer_load_dwordx4 v7, s[16:19], s41 offen lds
v_mfma_f32_16x16x32_bf16 v[220:223], v[64:67], v[40:43], v[220:223]
ds_read_b64_tr_b16 v[68:69], v3 offset:21504
v_mfma_f32_16x16x32_bf16 v[224:227], v[72:75], v[40:43], v[224:227]
ds_read_b64_tr_b16 v[70:71], v3 offset:23296
v_mfma_f32_16x16x32_bf16 v[224:227], v[76:79], v[44:47], v[224:227]
ds_read_b64_tr_b16 v[64:65], v3 offset:14336
v_mfma_f32_16x16x32_bf16 v[244:247], v[76:79], v[52:55], v[244:247]
ds_read_b64_tr_b16 v[66:67], v3 offset:16128
v_mfma_f32_16x16x32_bf16 v[244:247], v[72:75], v[48:51], v[244:247]
ds_read_b64_tr_b16 v[76:77], v4 offset:6208
v_mfma_f32_16x16x32_bf16 v[248:251], v[80:83], v[48:51], v[248:251]
ds_read_b64_tr_b16 v[78:79], v4 offset:7744
v_mfma_f32_16x16x32_bf16 v[248:251], v[84:87], v[52:55], v[248:251]
ds_read_b64_tr_b16 v[72:73], v4 offset:64
v_mfma_f32_16x16x32_bf16 v[228:231], v[84:87], v[44:47], v[228:231]
ds_read_b64_tr_b16 v[74:75], v4 offset:1600
v_mfma_f32_16x16x32_bf16 v[228:231], v[80:83], v[40:43], v[228:231]
ds_read_b64_tr_b16 v[84:85], v5 offset:6240
v_mfma_f32_16x16x32_bf16 v[232:235], v[88:91], v[40:43], v[232:235]
ds_read_b64_tr_b16 v[86:87], v5 offset:7776
v_mfma_f32_16x16x32_bf16 v[232:235], v[92:95], v[44:47], v[232:235]
ds_read_b64_tr_b16 v[80:81], v5 offset:96
v_mfma_f32_16x16x32_bf16 v[252:255], v[92:95], v[52:55], v[252:255]
ds_read_b64_tr_b16 v[82:83], v5 offset:1632
v_mfma_f32_16x16x32_bf16 v[252:255], v[88:91], v[48:51], v[252:255]
ds_read_b64_tr_b16 v[92:93], v4 offset:6144
s_cmp_lg_u32 s42, 14
s_cbranch_scc1 L_loop_84
s_waitcnt lgkmcnt(13)
v_mfma_f32_16x16x32_bf16 v[96:99], v[56:59], v[24:27], v[96:99]
ds_read_b64_tr_b16 v[94:95], v4 offset:7680
v_mfma_f32_16x16x32_bf16 v[96:99], v[60:63], v[28:31], v[96:99]
ds_read_b64_tr_b16 v[88:89], v4 offset:0
v_mfma_f32_16x16x32_bf16 v[116:119], v[60:63], v[36:39], v[116:119]
ds_read_b64_tr_b16 v[90:91], v4 offset:1536
v_mfma_f32_16x16x32_bf16 v[116:119], v[56:59], v[32:35], v[116:119]
ds_read_b128 v[40:43], v1 offset:4096
s_add_u32 m0, s39, 40960
s_waitcnt lgkmcnt(13)
v_mfma_f32_16x16x32_bf16 v[120:123], v[64:67], v[32:35], v[120:123]
ds_read_b128 v[44:47], v2 offset:4096
buffer_load_dwordx4 v8, s[20:23], s30 offen lds
v_mfma_f32_16x16x32_bf16 v[120:123], v[68:71], v[36:39], v[120:123]
ds_read_b128 v[52:55], v2 offset:6144
v_mfma_f32_16x16x32_bf16 v[100:103], v[68:71], v[28:31], v[100:103]
ds_read_b128 v[48:51], v1 offset:6144
v_mfma_f32_16x16x32_bf16 v[100:103], v[64:67], v[24:27], v[100:103]
s_add_u32 s41, s28, 131072
s_waitcnt lgkmcnt(12)
v_mfma_f32_16x16x32_bf16 v[104:107], v[72:75], v[24:27], v[104:107]
s_add_u32 m0, s40, 40960
v_mfma_f32_16x16x32_bf16 v[104:107], v[76:79], v[28:31], v[104:107]
buffer_load_dwordx4 v6, s[8:11], s41 offen lds
v_mfma_f32_16x16x32_bf16 v[124:127], v[76:79], v[36:39], v[124:127]
v_mfma_f32_16x16x32_bf16 v[124:127], v[72:75], v[32:35], v[124:127]
s_waitcnt lgkmcnt(8)
v_mfma_f32_16x16x32_bf16 v[128:131], v[80:83], v[32:35], v[128:131]
s_add_u32 s41, s28, 393216
v_mfma_f32_16x16x32_bf16 v[128:131], v[84:87], v[36:39], v[128:131]
s_add_u32 m0, s40, 57344
v_mfma_f32_16x16x32_bf16 v[108:111], v[84:87], v[28:31], v[108:111]
buffer_load_dwordx4 v6, s[8:11], s41 offen lds
v_mfma_f32_16x16x32_bf16 v[108:111], v[80:83], v[24:27], v[108:111]
s_waitcnt lgkmcnt(4)
v_mfma_f32_16x16x32_bf16 v[112:115], v[88:91], v[24:27], v[112:115]
v_mfma_f32_16x16x32_bf16 v[112:115], v[92:95], v[28:31], v[112:115]
v_mfma_f32_16x16x32_bf16 v[132:135], v[92:95], v[36:39], v[132:135]
v_mfma_f32_16x16x32_bf16 v[132:135], v[88:91], v[32:35], v[132:135]
s_waitcnt vmcnt(9) lgkmcnt(0)
s_barrier
v_mfma_f32_16x16x32_bf16 v[136:139], v[56:59], v[40:43], v[136:139]
ds_read_b128 v[24:27], v1 offset:8192
v_mfma_f32_16x16x32_bf16 v[136:139], v[60:63], v[44:47], v[136:139]
ds_read_b128 v[28:31], v2 offset:8192
v_mfma_f32_16x16x32_bf16 v[156:159], v[60:63], v[52:55], v[156:159]
ds_read_b128 v[36:39], v2 offset:10240
v_mfma_f32_16x16x32_bf16 v[156:159], v[56:59], v[48:51], v[156:159]
ds_read_b128 v[32:35], v1 offset:10240
v_mfma_f32_16x16x32_bf16 v[160:163], v[64:67], v[48:51], v[160:163]
v_mov_b32 v10, 152576
ds_read_b32 v10, v10
v_mfma_f32_16x16x32_bf16 v[160:163], v[68:71], v[52:55], v[160:163]
v_mfma_f32_16x16x32_bf16 v[140:143], v[68:71], v[44:47], v[140:143]
v_mfma_f32_16x16x32_bf16 v[140:143], v[64:67], v[40:43], v[140:143]
v_mfma_f32_16x16x32_bf16 v[144:147], v[72:75], v[40:43], v[144:147]
v_mfma_f32_16x16x32_bf16 v[144:147], v[76:79], v[44:47], v[144:147]
v_mfma_f32_16x16x32_bf16 v[164:167], v[76:79], v[52:55], v[164:167]
v_mfma_f32_16x16x32_bf16 v[164:167], v[72:75], v[48:51], v[164:167]
v_mfma_f32_16x16x32_bf16 v[168:171], v[80:83], v[48:51], v[168:171]
s_waitcnt lgkmcnt(0)
v_readfirstlane_b32 s86, v10
v_mfma_f32_16x16x32_bf16 v[168:171], v[84:87], v[52:55], v[168:171]
v_mfma_f32_16x16x32_bf16 v[148:151], v[84:87], v[44:47], v[148:151]
s_cmp_eq_u32 s43, 0
s_cbranch_scc1 L_li_109
L_lib_110:
v_mfma_f32_16x16x32_bf16 v[148:151], v[80:83], v[40:43], v[148:151]
v_mfma_f32_16x16x32_bf16 v[152:155], v[88:91], v[40:43], v[152:155]
v_mfma_f32_16x16x32_bf16 v[152:155], v[92:95], v[44:47], v[152:155]
v_mfma_f32_16x16x32_bf16 v[172:175], v[92:95], v[52:55], v[172:175]
v_mfma_f32_16x16x32_bf16 v[172:175], v[88:91], v[48:51], v[172:175]
v_mfma_f32_16x16x32_bf16 v[176:179], v[56:59], v[24:27], v[176:179]
ds_read_b128 v[40:43], v1 offset:12288
v_mfma_f32_16x16x32_bf16 v[176:179], v[60:63], v[28:31], v[176:179]
ds_read_b128 v[44:47], v2 offset:12288
v_mfma_f32_16x16x32_bf16 v[196:199], v[60:63], v[36:39], v[196:199]
ds_read_b128 v[52:55], v2 offset:14336
v_mfma_f32_16x16x32_bf16 v[196:199], v[56:59], v[32:35], v[196:199]
ds_read_b128 v[48:51], v1 offset:14336
v_mfma_f32_16x16x32_bf16 v[200:203], v[64:67], v[32:35], v[200:203]
v_mfma_f32_16x16x32_bf16 v[200:203], v[68:71], v[36:39], v[200:203]
v_mfma_f32_16x16x32_bf16 v[180:183], v[68:71], v[28:31], v[180:183]
v_mfma_f32_16x16x32_bf16 v[180:183], v[64:67], v[24:27], v[180:183]
v_mfma_f32_16x16x32_bf16 v[184:187], v[72:75], v[24:27], v[184:187]
v_mfma_f32_16x16x32_bf16 v[184:187], v[76:79], v[28:31], v[184:187]
v_mfma_f32_16x16x32_bf16 v[204:207], v[76:79], v[36:39], v[204:207]
v_mfma_f32_16x16x32_bf16 v[204:207], v[72:75], v[32:35], v[204:207]
v_mfma_f32_16x16x32_bf16 v[208:211], v[80:83], v[32:35], v[208:211]
v_mfma_f32_16x16x32_bf16 v[208:211], v[84:87], v[36:39], v[208:211]
v_mfma_f32_16x16x32_bf16 v[188:191], v[84:87], v[28:31], v[188:191]
v_mfma_f32_16x16x32_bf16 v[188:191], v[80:83], v[24:27], v[188:191]
v_mfma_f32_16x16x32_bf16 v[192:195], v[88:91], v[24:27], v[192:195]
v_mfma_f32_16x16x32_bf16 v[192:195], v[92:95], v[28:31], v[192:195]
v_mfma_f32_16x16x32_bf16 v[212:215], v[92:95], v[36:39], v[212:215]
v_mfma_f32_16x16x32_bf16 v[212:215], v[88:91], v[32:35], v[212:215]
s_cmp_eq_u32 s46, 0
s_cbranch_scc1 L_cs_111
L_csb_112:
s_cmp_eq_u32 s43, 0
s_cbranch_scc1 L_lc_113
L_lcb_114:
s_waitcnt vmcnt(0) lgkmcnt(0)
s_barrier
v_mfma_f32_16x16x32_bf16 v[216:219], v[56:59], v[40:43], v[216:219]
ds_read_b128 v[24:27], v1 offset:32768
v_mfma_f32_16x16x32_bf16 v[216:219], v[60:63], v[44:47], v[216:219]
ds_read_b128 v[28:31], v2 offset:32768
v_mfma_f32_16x16x32_bf16 v[236:239], v[60:63], v[52:55], v[236:239]
ds_read_b128 v[36:39], v2 offset:34816
s_add_u32 s42, s42, 1
v_mfma_f32_16x16x32_bf16 v[236:239], v[56:59], v[48:51], v[236:239]
ds_read_b128 v[32:35], v1 offset:34816
ds_read_b64_tr_b16 v[60:61], v3 offset:48128
s_mul_i32 s93, s47, 320
v_min_u32 v9, 39, v0
v_lshlrev_b32 v9, 3, v9
v_add_u32 v9, s93, v9
v_lshlrev_b32 v6, 4, v0
s_mov_b32 s12, s24
s_mov_b32 s13, s25
s_mov_b32 s15, 0x20000
s_cmp_eq_u32 s46, 1
s_cbranch_scc1 L_pc_118
L_pcb_119:
s_lshl_b32 s94, s43, 10
s_lshl_b32 s93, s44, 11
s_add_u32 s93, s93, s94
s_add_u32 s93, s93, 0x2f00000
s_cmp_lt_u32 s43, 2
s_cselect_b32 s14, s26, 0
s_cselect_b32 m0, s94, 152640
s_nop 0
buffer_load_dwordx4 v6, s[12:15], s93 offen sc1 lds
v_mfma_f32_16x16x32_bf16 v[240:243], v[64:67], v[48:51], v[240:243]
ds_read_b64_tr_b16 v[62:63], v3 offset:49920
v_mfma_f32_16x16x32_bf16 v[240:243], v[68:71], v[52:55], v[240:243]
ds_read_b64_tr_b16 v[56:57], v3 offset:40960
v_mfma_f32_16x16x32_bf16 v[220:223], v[68:71], v[44:47], v[220:223]
ds_read_b64_tr_b16 v[58:59], v3 offset:42752
v_mfma_f32_16x16x32_bf16 v[220:223], v[64:67], v[40:43], v[220:223]
ds_read_b64_tr_b16 v[68:69], v3 offset:62464
v_mfma_f32_16x16x32_bf16 v[224:227], v[72:75], v[40:43], v[224:227]
ds_read_b64_tr_b16 v[70:71], v3 offset:64256
v_mfma_f32_16x16x32_bf16 v[224:227], v[76:79], v[44:47], v[224:227]
ds_read_b64_tr_b16 v[64:65], v3 offset:55296
v_mfma_f32_16x16x32_bf16 v[244:247], v[76:79], v[52:55], v[244:247]
ds_read_b64_tr_b16 v[66:67], v3 offset:57088
v_mfma_f32_16x16x32_bf16 v[244:247], v[72:75], v[48:51], v[244:247]
ds_read_b64_tr_b16 v[76:77], v4 offset:47168
v_mfma_f32_16x16x32_bf16 v[248:251], v[80:83], v[48:51], v[248:251]
ds_read_b64_tr_b16 v[78:79], v4 offset:48704
v_mfma_f32_16x16x32_bf16 v[248:251], v[84:87], v[52:55], v[248:251]
ds_read_b64_tr_b16 v[72:73], v4 offset:41024
v_mfma_f32_16x16x32_bf16 v[228:231], v[84:87], v[44:47], v[228:231]
ds_read_b64_tr_b16 v[74:75], v4 offset:42560
v_mfma_f32_16x16x32_bf16 v[228:231], v[80:83], v[40:43], v[228:231]
ds_read_b64_tr_b16 v[84:85], v5 offset:47200
v_mfma_f32_16x16x32_bf16 v[232:235], v[88:91], v[40:43], v[232:235]
ds_read_b64_tr_b16 v[86:87], v5 offset:48736
v_mfma_f32_16x16x32_bf16 v[232:235], v[92:95], v[44:47], v[232:235]
ds_read_b64_tr_b16 v[80:81], v5 offset:41056
v_mfma_f32_16x16x32_bf16 v[252:255], v[92:95], v[52:55], v[252:255]
ds_read_b64_tr_b16 v[82:83], v5 offset:42592
v_mfma_f32_16x16x32_bf16 v[252:255], v[88:91], v[48:51], v[252:255]
ds_read_b64_tr_b16 v[92:93], v4 offset:47104
s_waitcnt lgkmcnt(13)
v_mfma_f32_16x16x32_bf16 v[96:99], v[56:59], v[24:27], v[96:99]
ds_read_b64_tr_b16 v[94:95], v4 offset:48640
v_mfma_f32_16x16x32_bf16 v[96:99], v[60:63], v[28:31], v[96:99]
ds_read_b64_tr_b16 v[88:89], v4 offset:40960
v_mfma_f32_16x16x32_bf16 v[116:119], v[60:63], v[36:39], v[116:119]
ds_read_b64_tr_b16 v[90:91], v4 offset:42496
v_mfma_f32_16x16x32_bf16 v[116:119], v[56:59], v[32:35], v[116:119]
ds_read_b128 v[40:43], v1 offset:36864
s_waitcnt lgkmcnt(13)
v_mfma_f32_16x16x32_bf16 v[120:123], v[64:67], v[32:35], v[120:123]
ds_read_b128 v[44:47], v2 offset:36864
v_mfma_f32_16x16x32_bf16 v[120:123], v[68:71], v[36:39], v[120:123]
ds_read_b128 v[52:55], v2 offset:38912
v_mfma_f32_16x16x32_bf16 v[100:103], v[68:71], v[28:31], v[100:103]
ds_read_b128 v[48:51], v1 offset:38912
v_mfma_f32_16x16x32_bf16 v[100:103], v[64:67], v[24:27], v[100:103]
s_waitcnt lgkmcnt(12)
v_mfma_f32_16x16x32_bf16 v[104:107], v[72:75], v[24:27], v[104:107]
v_mfma_f32_16x16x32_bf16 v[104:107], v[76:79], v[28:31], v[104:107]
v_mfma_f32_16x16x32_bf16 v[124:127], v[76:79], v[36:39], v[124:127]
v_mfma_f32_16x16x32_bf16 v[124:127], v[72:75], v[32:35], v[124:127]
s_waitcnt lgkmcnt(8)
v_mfma_f32_16x16x32_bf16 v[128:131], v[80:83], v[32:35], v[128:131]
v_mfma_f32_16x16x32_bf16 v[128:131], v[84:87], v[36:39], v[128:131]
v_mfma_f32_16x16x32_bf16 v[108:111], v[84:87], v[28:31], v[108:111]
v_mfma_f32_16x16x32_bf16 v[108:111], v[80:83], v[24:27], v[108:111]
s_waitcnt lgkmcnt(4)
v_mfma_f32_16x16x32_bf16 v[112:115], v[88:91], v[24:27], v[112:115]
v_mfma_f32_16x16x32_bf16 v[112:115], v[92:95], v[28:31], v[112:115]
v_mfma_f32_16x16x32_bf16 v[132:135], v[92:95], v[36:39], v[132:135]
v_mfma_f32_16x16x32_bf16 v[132:135], v[88:91], v[32:35], v[132:135]
s_cmp_eq_u32 s46, 0
s_cbranch_scc1 L_cs_120
L_csb_121:
s_waitcnt lgkmcnt(0)
s_barrier
v_mfma_f32_16x16x32_bf16 v[136:139], v[56:59], v[40:43], v[136:139]
ds_read_b128 v[24:27], v1 offset:40960
v_mfma_f32_16x16x32_bf16 v[136:139], v[60:63], v[44:47], v[136:139]
ds_read_b128 v[28:31], v2 offset:40960
v_mfma_f32_16x16x32_bf16 v[156:159], v[60:63], v[52:55], v[156:159]
ds_read_b128 v[36:39], v2 offset:43008
v_mfma_f32_16x16x32_bf16 v[156:159], v[56:59], v[48:51], v[156:159]
ds_read_b128 v[32:35], v1 offset:43008
v_mfma_f32_16x16x32_bf16 v[160:163], v[64:67], v[48:51], v[160:163]
v_add_u32 v7, 147456, v9
ds_read_b64 v[6:7], v7
v_mfma_f32_16x16x32_bf16 v[160:163], v[68:71], v[52:55], v[160:163]
v_mfma_f32_16x16x32_bf16 v[140:143], v[68:71], v[44:47], v[140:143]
v_mfma_f32_16x16x32_bf16 v[140:143], v[64:67], v[40:43], v[140:143]
v_mfma_f32_16x16x32_bf16 v[144:147], v[72:75], v[40:43], v[144:147]
v_mfma_f32_16x16x32_bf16 v[144:147], v[76:79], v[44:47], v[144:147]
v_mfma_f32_16x16x32_bf16 v[164:167], v[76:79], v[52:55], v[164:167]
v_mfma_f32_16x16x32_bf16 v[164:167], v[72:75], v[48:51], v[164:167]
v_mfma_f32_16x16x32_bf16 v[168:171], v[80:83], v[48:51], v[168:171]
v_mfma_f32_16x16x32_bf16 v[168:171], v[84:87], v[52:55], v[168:171]
v_mfma_f32_16x16x32_bf16 v[148:151], v[84:87], v[44:47], v[148:151]
v_mfma_f32_16x16x32_bf16 v[148:151], v[80:83], v[40:43], v[148:151]
v_mfma_f32_16x16x32_bf16 v[152:155], v[88:91], v[40:43], v[152:155]
v_mfma_f32_16x16x32_bf16 v[152:155], v[92:95], v[44:47], v[152:155]
v_mfma_f32_16x16x32_bf16 v[172:175], v[92:95], v[52:55], v[172:175]
v_mfma_f32_16x16x32_bf16 v[172:175], v[88:91], v[48:51], v[172:175]
s_waitcnt lgkmcnt(4)
v_mfma_f32_16x16x32_bf16 v[176:179], v[56:59], v[24:27], v[176:179]
ds_read_b128 v[40:43], v1 offset:45056
s_waitcnt lgkmcnt(4)
v_mfma_f32_16x16x32_bf16 v[176:179], v[60:63], v[28:31], v[176:179]
ds_read_b128 v[44:47], v2 offset:45056
s_waitcnt lgkmcnt(4)
v_mfma_f32_16x16x32_bf16 v[196:199], v[60:63], v[36:39], v[196:199]
ds_read_b128 v[52:55], v2 offset:47104
s_waitcnt lgkmcnt(4)
v_mfma_f32_16x16x32_bf16 v[196:199], v[56:59], v[32:35], v[196:199]
ds_read_b128 v[48:51], v1 offset:47104
v_mfma_f32_16x16x32_bf16 v[200:203], v[64:67], v[32:35], v[200:203]
v_mfma_f32_16x16x32_bf16 v[200:203], v[68:71], v[36:39], v[200:203]
v_mfma_f32_16x16x32_bf16 v[180:183], v[68:71], v[28:31], v[180:183]
s_waitcnt lgkmcnt(4)
s_cmp_eq_u32 s46, 1
s_cbranch_scc1 L_ps_123
L_psb_124:
v_mfma_f32_16x16x32_bf16 v[180:183], v[64:67], v[24:27], v[180:183]
v_mfma_f32_16x16x32_bf16 v[184:187], v[72:75], v[24:27], v[184:187]
v_mfma_f32_16x16x32_bf16 v[184:187], v[76:79], v[28:31], v[184:187]
v_mfma_f32_16x16x32_bf16 v[204:207], v[76:79], v[36:39], v[204:207]
v_mfma_f32_16x16x32_bf16 v[204:207], v[72:75], v[32:35], v[204:207]
v_mfma_f32_16x16x32_bf16 v[208:211], v[80:83], v[32:35], v[208:211]
v_mfma_f32_16x16x32_bf16 v[208:211], v[84:87], v[36:39], v[208:211]
v_mfma_f32_16x16x32_bf16 v[188:191], v[84:87], v[28:31], v[188:191]
v_mfma_f32_16x16x32_bf16 v[188:191], v[80:83], v[24:27], v[188:191]
v_mfma_f32_16x16x32_bf16 v[192:195], v[88:91], v[24:27], v[192:195]
v_mfma_f32_16x16x32_bf16 v[192:195], v[92:95], v[28:31], v[192:195]
v_mfma_f32_16x16x32_bf16 v[212:215], v[92:95], v[36:39], v[212:215]
v_mfma_f32_16x16x32_bf16 v[212:215], v[88:91], v[32:35], v[212:215]
s_waitcnt vmcnt(0) lgkmcnt(0)
s_barrier
v_mfma_f32_16x16x32_bf16 v[216:219], v[56:59], v[40:43], v[216:219]
v_and_b32 v1, 15, v0
v_lshlrev_b32 v1, 3, v1
s_lshl_b32 s93, s46, 10
v_add_u32 v1, s93, v1
ds_read_b64 v[24:25], v1 offset:0
ds_read_b64 v[26:27], v1 offset:128
ds_read_b64 v[28:29], v1 offset:256
ds_read_b64 v[30:31], v1 offset:384
ds_read_b64 v[32:33], v1 offset:512
ds_read_b64 v[34:35], v1 offset:640
ds_read_b64 v[36:37], v1 offset:768
ds_read_b64 v[38:39], v1 offset:896
v_lshrrev_b32 v22, 4, v0
v_lshlrev_b32 v22, 4, v22
v_add_u32 v22, 151296, v22
v_add_u32 v23, s90, v22
ds_read_b128 v[2:5], v23 offset:0
ds_read_b128 v[6:9], v23 offset:448
ds_read_b128 v[10:13], v22 offset:128
ds_read_b128 v[14:17], v22 offset:192
ds_read_b128 v[18:21], v22 offset:0
v_mfma_f32_16x16x32_bf16 v[216:219], v[60:63], v[44:47], v[216:219]
v_mfma_f32_16x16x32_bf16 v[236:239], v[60:63], v[52:55], v[236:239]
v_mfma_f32_16x16x32_bf16 v[236:239], v[56:59], v[48:51], v[236:239]
v_mfma_f32_16x16x32_bf16 v[240:243], v[64:67], v[48:51], v[240:243]
v_mfma_f32_16x16x32_bf16 v[240:243], v[68:71], v[52:55], v[240:243]
v_mfma_f32_16x16x32_bf16 v[220:223], v[68:71], v[44:47], v[220:223]
v_mfma_f32_16x16x32_bf16 v[220:223], v[64:67], v[40:43], v[220:223]
v_mfma_f32_16x16x32_bf16 v[224:227], v[72:75], v[40:43], v[224:227]
v_mfma_f32_16x16x32_bf16 v[224:227], v[76:79], v[44:47], v[224:227]
v_mfma_f32_16x16x32_bf16 v[244:247], v[76:79], v[52:55], v[244:247]
v_mfma_f32_16x16x32_bf16 v[244:247], v[72:75], v[48:51], v[244:247]
v_mfma_f32_16x16x32_bf16 v[248:251], v[80:83], v[48:51], v[248:251]
v_mfma_f32_16x16x32_bf16 v[248:251], v[84:87], v[52:55], v[248:251]
v_mfma_f32_16x16x32_bf16 v[228:231], v[84:87], v[44:47], v[228:231]
v_mfma_f32_16x16x32_bf16 v[228:231], v[80:83], v[40:43], v[228:231]
v_mfma_f32_16x16x32_bf16 v[232:235], v[88:91], v[40:43], v[232:235]
v_mfma_f32_16x16x32_bf16 v[232:235], v[92:95], v[44:47], v[232:235]
v_mfma_f32_16x16x32_bf16 v[252:255], v[92:95], v[52:55], v[252:255]
v_mfma_f32_16x16x32_bf16 v[252:255], v[88:91], v[48:51], v[252:255]
s_waitcnt lgkmcnt(0)
v_lshlrev_b32 v76, 3, v0
s_lshl_b32 s31, s44, 4
s_lshl_b32 s32, s46, 3
s_add_u32 s31, s31, s32
s_lshr_b32 s33, s45, 1
s_mul_i32 s33, s33, 7
s_and_b32 s34, s45, 1
s_add_u32 s33, s33, 3
s_mul_i32 s42, s31, 144
s_add_u32 s42, s42, s33
s_lshl_b32 s42, s42, 10
s_lshl_b32 s34, s34, 3
s_add_u32 s42, s42, s34
s_mov_b32 s12, s58
s_mov_b32 s13, s59
s_mov_b32 s15, 0x20000
s_cmp_eq_u32 s44, 7
s_cselect_b32 s14, 0, s26
s_lshl_b32 s35, s45, 7
s_add_u32 s35, s35, s31
s_lshl_b32 s35, s35, 10
s_add_u32 s29, s35, 0x1600000
v_lshlrev_b32 v77, 4, v0
s_lshl_b32 s38, s32, 10
s_add_u32 s39, s38, 81920
v_add_u32 v40, s39, v77
s_add_u32 s39, s38, 131072
v_add_u32 v41, s39, v77
v_lshlrev_b32 v43, 4, v0
v_mov_b32 v42, 0x7fff0000
s_add_u32 s42, s42, 1032192
s_setprio 2
v_rcp_f32 v68, v25
v_rcp_f32 v69, v27
v_pk_fma_f32 v[104:105], v[10:11], v[24:25], v[104:105] op_sel_hi:[1,0,1]
v_pk_fma_f32 v[106:107], v[12:13], v[24:25], v[106:107] op_sel_hi:[1,0,1]
v_pk_mul_f32 v[104:105], v[104:105], v[68:69] op_sel:[0,0] op_sel_hi:[1,0]
v_rcp_f32 v70, v29
v_rcp_f32 v71, v31
v_pk_fma_f32 v[124:125], v[10:11], v[26:27], v[124:125] op_sel_hi:[1,0,1]
v_pk_fma_f32 v[108:109], v[14:15], v[24:25], v[108:109] op_sel_hi:[1,0,1]
v_pk_fma_f32 v[110:111], v[16:17], v[24:25], v[110:111] op_sel_hi:[1,0,1]
v_pk_mul_f32 v[106:107], v[106:107], v[68:69] op_sel:[0,0] op_sel_hi:[1,0]
v_pk_fma_f32 v[126:127], v[12:13], v[26:27], v[126:127] op_sel_hi:[1,0,1]
v_cvt_pk_bf16_f32 v104, v104, v105
v_rcp_f32 v72, v33
v_rcp_f32 v73, v35
v_pk_mul_f32 v[124:125], v[124:125], v[68:69] op_sel:[0,1] op_sel_hi:[1,1]
v_pk_fma_f32 v[144:145], v[10:11], v[28:29], v[144:145] op_sel_hi:[1,0,1]
v_pk_mul_f32 v[108:109], v[108:109], v[68:69] op_sel:[0,0] op_sel_hi:[1,0]
v_pk_mul_f32 v[110:111], v[110:111], v[68:69] op_sel:[0,0] op_sel_hi:[1,0]
v_pk_fma_f32 v[128:129], v[14:15], v[26:27], v[128:129] op_sel_hi:[1,0,1]
v_pk_fma_f32 v[130:131], v[16:17], v[26:27], v[130:131] op_sel_hi:[1,0,1]
v_cvt_pk_bf16_f32 v105, v106, v107
v_pk_fma_f32 v[164:165], v[10:11], v[30:31], v[164:165] op_sel_hi:[1,0,1]
v_pk_mul_f32 v[126:127], v[126:127], v[68:69] op_sel:[0,1] op_sel_hi:[1,1]
v_pk_fma_f32 v[146:147], v[12:13], v[28:29], v[146:147] op_sel_hi:[1,0,1]
v_rcp_f32 v74, v37
v_rcp_f32 v75, v39
v_cvt_pk_bf16_f32 v124, v124, v125
v_pk_mul_f32 v[144:145], v[144:145], v[70:71] op_sel:[0,0] op_sel_hi:[1,0]
v_pk_fma_f32 v[184:185], v[10:11], v[32:33], v[184:185] op_sel_hi:[1,0,1]
v_cvt_pk_bf16_f32 v106, v108, v109
v_cvt_pk_bf16_f32 v107, v110, v111
v_pk_fma_f32 v[166:167], v[12:13], v[30:31], v[166:167] op_sel_hi:[1,0,1]
ds_write_b128 v40, v[104:107] offset:0
v_pk_mul_f32 v[128:129], v[128:129], v[68:69] op_sel:[0,1] op_sel_hi:[1,1]
v_pk_mul_f32 v[130:131], v[130:131], v[68:69] op_sel:[0,1] op_sel_hi:[1,1]
v_pk_fma_f32 v[148:149], v[14:15], v[28:29], v[148:149] op_sel_hi:[1,0,1]
v_pk_fma_f32 v[150:151], v[16:17], v[28:29], v[150:151] op_sel_hi:[1,0,1]
v_pk_mul_f32 v[164:165], v[164:165], v[70:71] op_sel:[0,1] op_sel_hi:[1,1]
v_pk_fma_f32 v[204:205], v[10:11], v[34:35], v[204:205] op_sel_hi:[1,0,1]
v_cvt_pk_bf16_f32 v125, v126, v127
v_pk_mul_f32 v[146:147], v[146:147], v[70:71] op_sel:[0,0] op_sel_hi:[1,0]
v_pk_fma_f32 v[186:187], v[12:13], v[32:33], v[186:187] op_sel_hi:[1,0,1]
v_pk_fma_f32 v[168:169], v[14:15], v[30:31], v[168:169] op_sel_hi:[1,0,1]
v_pk_fma_f32 v[170:171], v[16:17], v[30:31], v[170:171] op_sel_hi:[1,0,1]
v_cvt_pk_bf16_f32 v144, v144, v145
v_pk_mul_f32 v[184:185], v[184:185], v[72:73] op_sel:[0,0] op_sel_hi:[1,0]
v_pk_fma_f32 v[224:225], v[10:11], v[36:37], v[224:225] op_sel_hi:[1,0,1]
buffer_store_dwordx4 v[104:107], v77, s[12:15], s29 offen sc1
v_pk_mul_f32 v[166:167], v[166:167], v[70:71] op_sel:[0,1] op_sel_hi:[1,1]
v_pk_fma_f32 v[206:207], v[12:13], v[34:35], v[206:207] op_sel_hi:[1,0,1]
v_cvt_pk_bf16_f32 v126, v128, v129
v_cvt_pk_bf16_f32 v127, v130, v131
v_pk_mul_f32 v[148:149], v[148:149], v[70:71] op_sel:[0,0] op_sel_hi:[1,0]
ds_write_b128 v40, v[124:127] offset:1024
v_pk_mul_f32 v[150:151], v[150:151], v[70:71] op_sel:[0,0] op_sel_hi:[1,0]
v_pk_fma_f32 v[188:189], v[14:15], v[32:33], v[188:189] op_sel_hi:[1,0,1]
v_pk_fma_f32 v[190:191], v[16:17], v[32:33], v[190:191] op_sel_hi:[1,0,1]
v_cvt_pk_bf16_f32 v164, v164, v165
v_pk_mul_f32 v[204:205], v[204:205], v[72:73] op_sel:[0,1] op_sel_hi:[1,1]
v_pk_fma_f32 v[244:245], v[10:11], v[38:39], v[244:245] op_sel_hi:[1,0,1]
v_cvt_pk_bf16_f32 v145, v146, v147
v_pk_mul_f32 v[186:187], v[186:187], v[72:73] op_sel:[0,0] op_sel_hi:[1,0]
v_pk_fma_f32 v[226:227], v[12:13], v[36:37], v[226:227] op_sel_hi:[1,0,1]
s_add_u32 s29, s29, 1024
v_pk_mul_f32 v[168:169], v[168:169], v[70:71] op_sel:[0,1] op_sel_hi:[1,1]
v_pk_mul_f32 v[170:171], v[170:171], v[70:71] op_sel:[0,1] op_sel_hi:[1,1]
v_pk_fma_f32 v[208:209], v[14:15], v[34:35], v[208:209] op_sel_hi:[1,0,1]
v_pk_fma_f32 v[210:211], v[16:17], v[34:35], v[210:211] op_sel_hi:[1,0,1]
v_cvt_pk_bf16_f32 v184, v184, v185
v_pk_mul_f32 v[224:225], v[224:225], v[74:75] op_sel:[0,0] op_sel_hi:[1,0]
v_cvt_pk_bf16_f32 v165, v166, v167
v_pk_mul_f32 v[206:207], v[206:207], v[72:73] op_sel:[0,1] op_sel_hi:[1,1]
v_pk_fma_f32 v[246:247], v[12:13], v[38:39], v[246:247] op_sel_hi:[1,0,1]
buffer_store_dwordx4 v[124:127], v77, s[12:15], s29 offen sc1
v_cvt_pk_bf16_f32 v146, v148, v149
v_cvt_pk_bf16_f32 v147, v150, v151
v_pk_mul_f32 v[188:189], v[188:189], v[72:73] op_sel:[0,0] op_sel_hi:[1,0]
ds_write_b128 v40, v[144:147] offset:2048
v_pk_mul_f32 v[190:191], v[190:191], v[72:73] op_sel:[0,0] op_sel_hi:[1,0]
v_pk_fma_f32 v[228:229], v[14:15], v[36:37], v[228:229] op_sel_hi:[1,0,1]
v_pk_fma_f32 v[230:231], v[16:17], v[36:37], v[230:231] op_sel_hi:[1,0,1]
v_cvt_pk_bf16_f32 v204, v204, v205
v_pk_mul_f32 v[244:245], v[244:245], v[74:75] op_sel:[0,1] op_sel_hi:[1,1]
v_cvt_pk_bf16_f32 v185, v186, v187
v_pk_mul_f32 v[226:227], v[226:227], v[74:75] op_sel:[0,0] op_sel_hi:[1,0]
v_pk_fma_f32 v[112:113], v[18:19], v[24:25], v[112:113] op_sel_hi:[1,0,1]
v_cvt_pk_bf16_f32 v166, v168, v169
v_cvt_pk_bf16_f32 v167, v170, v171
v_pk_mul_f32 v[208:209], v[208:209], v[72:73] op_sel:[0,1] op_sel_hi:[1,1]
ds_write_b128 v40, v[164:167] offset:3072
v_pk_mul_f32 v[210:211], v[210:211], v[72:73] op_sel:[0,1] op_sel_hi:[1,1]
v_pk_fma_f32 v[248:249], v[14:15], v[38:39], v[248:249] op_sel_hi:[1,0,1]
v_pk_fma_f32 v[250:251], v[16:17], v[38:39], v[250:251] op_sel_hi:[1,0,1]
s_add_u32 s29, s29, 1024
v_cvt_pk_bf16_f32 v224, v224, v225
v_cvt_pk_bf16_f32 v205, v206, v207
v_pk_mul_f32 v[246:247], v[246:247], v[74:75] op_sel:[0,1] op_sel_hi:[1,1]
v_pk_fma_f32 v[132:133], v[18:19], v[26:27], v[132:133] op_sel_hi:[1,0,1]
v_cvt_pk_bf16_f32 v186, v188, v189
v_cvt_pk_bf16_f32 v187, v190, v191
v_pk_mul_f32 v[228:229], v[228:229], v[74:75] op_sel:[0,0] op_sel_hi:[1,0]
ds_write_b128 v40, v[184:187] offset:4096
v_pk_mul_f32 v[230:231], v[230:231], v[74:75] op_sel:[0,0] op_sel_hi:[1,0]
v_pk_fma_f32 v[114:115], v[20:21], v[24:25], v[114:115] op_sel_hi:[1,0,1]
buffer_store_dwordx4 v[144:147], v77, s[12:15], s29 offen sc1
v_cvt_pk_bf16_f32 v244, v244, v245
v_cvt_pk_bf16_f32 v225, v226, v227
v_pk_mul_f32 v[112:113], v[112:113], v[68:69] op_sel:[0,0] op_sel_hi:[1,0]
v_pk_fma_f32 v[152:153], v[18:19], v[28:29], v[152:153] op_sel_hi:[1,0,1]
v_cvt_pk_bf16_f32 v206, v208, v209
v_cvt_pk_bf16_f32 v207, v210, v211
v_pk_mul_f32 v[248:249], v[248:249], v[74:75] op_sel:[0,1] op_sel_hi:[1,1]
ds_write_b128 v40, v[204:207] offset:5120
v_pk_mul_f32 v[250:251], v[250:251], v[74:75] op_sel:[0,1] op_sel_hi:[1,1]
v_pk_fma_f32 v[134:135], v[20:21], v[26:27], v[134:135] op_sel_hi:[1,0,1]
s_add_u32 s29, s29, 1024
v_cvt_pk_bf16_f32 v245, v246, v247
v_pk_mul_f32 v[132:133], v[132:133], v[68:69] op_sel:[0,1] op_sel_hi:[1,1]
v_pk_fma_f32 v[172:173], v[18:19], v[30:31], v[172:173] op_sel_hi:[1,0,1]
v_cvt_pk_bf16_f32 v226, v228, v229
v_cvt_pk_bf16_f32 v227, v230, v231
v_pk_mul_f32 v[114:115], v[114:115], v[68:69] op_sel:[0,0] op_sel_hi:[1,0]
ds_write_b128 v40, v[224:227] offset:6144
v_pk_fma_f32 v[154:155], v[20:21], v[28:29], v[154:155] op_sel_hi:[1,0,1]
buffer_store_dwordx4 v[164:167], v77, s[12:15], s29 offen sc1
v_cvt_pk_bf16_f32 v112, v112, v113
v_pk_mul_f32 v[152:153], v[152:153], v[70:71] op_sel:[0,0] op_sel_hi:[1,0]
v_pk_fma_f32 v[192:193], v[18:19], v[32:33], v[192:193] op_sel_hi:[1,0,1]
v_cvt_pk_bf16_f32 v246, v248, v249
v_cvt_pk_bf16_f32 v247, v250, v251
v_pk_mul_f32 v[134:135], v[134:135], v[68:69] op_sel:[0,1] op_sel_hi:[1,1]
ds_write_b128 v40, v[244:247] offset:7168
v_pk_fma_f32 v[174:175], v[20:21], v[30:31], v[174:175] op_sel_hi:[1,0,1]
v_cvt_pk_bf16_f32 v132, v132, v133
v_pk_mul_f32 v[172:173], v[172:173], v[70:71] op_sel:[0,1] op_sel_hi:[1,1]
v_pk_fma_f32 v[212:213], v[18:19], v[34:35], v[212:213] op_sel_hi:[1,0,1]
s_add_u32 s29, s29, 1024
v_cvt_pk_bf16_f32 v113, v114, v115
v_pk_mul_f32 v[154:155], v[154:155], v[70:71] op_sel:[0,0] op_sel_hi:[1,0]
ds_write_b64 v41, v[112:113] offset:0
v_pk_fma_f32 v[194:195], v[20:21], v[32:33], v[194:195] op_sel_hi:[1,0,1]
v_cvt_pk_bf16_f32 v152, v152, v153
v_pk_mul_f32 v[192:193], v[192:193], v[72:73] op_sel:[0,0] op_sel_hi:[1,0]
v_pk_fma_f32 v[232:233], v[18:19], v[36:37], v[232:233] op_sel_hi:[1,0,1]
buffer_store_dwordx4 v[184:187], v77, s[12:15], s29 offen sc1
v_cvt_pk_bf16_f32 v133, v134, v135
v_pk_mul_f32 v[174:175], v[174:175], v[70:71] op_sel:[0,1] op_sel_hi:[1,1]
ds_write_b64 v41, v[132:133] offset:1024
v_pk_fma_f32 v[214:215], v[20:21], v[34:35], v[214:215] op_sel_hi:[1,0,1]
v_cvt_pk_bf16_f32 v172, v172, v173
v_pk_mul_f32 v[212:213], v[212:213], v[72:73] op_sel:[0,1] op_sel_hi:[1,1]
v_pk_fma_f32 v[252:253], v[18:19], v[38:39], v[252:253] op_sel_hi:[1,0,1]
v_cvt_pk_bf16_f32 v153, v154, v155
v_pk_mul_f32 v[194:195], v[194:195], v[72:73] op_sel:[0,0] op_sel_hi:[1,0]
ds_write_b64 v41, v[152:153] offset:2048
v_pk_fma_f32 v[234:235], v[20:21], v[36:37], v[234:235] op_sel_hi:[1,0,1]
s_add_u32 s29, s29, 1024
v_cvt_pk_bf16_f32 v192, v192, v193
v_pk_mul_f32 v[232:233], v[232:233], v[74:75] op_sel:[0,0] op_sel_hi:[1,0]
v_cvt_pk_bf16_f32 v173, v174, v175
v_pk_mul_f32 v[214:215], v[214:215], v[72:73] op_sel:[0,1] op_sel_hi:[1,1]
ds_write_b64 v41, v[172:173] offset:3072
v_pk_fma_f32 v[254:255], v[20:21], v[38:39], v[254:255] op_sel_hi:[1,0,1]
buffer_store_dwordx4 v[204:207], v77, s[12:15], s29 offen sc1
v_cvt_pk_bf16_f32 v212, v212, v213
v_pk_mul_f32 v[252:253], v[252:253], v[74:75] op_sel:[0,1] op_sel_hi:[1,1]
v_cvt_pk_bf16_f32 v193, v194, v195
v_pk_mul_f32 v[234:235], v[234:235], v[74:75] op_sel:[0,0] op_sel_hi:[1,0]
ds_write_b64 v41, v[192:193] offset:4096
s_add_u32 s29, s29, 1024
v_cvt_pk_bf16_f32 v232, v232, v233
v_cvt_pk_bf16_f32 v213, v214, v215
v_pk_mul_f32 v[254:255], v[254:255], v[74:75] op_sel:[0,1] op_sel_hi:[1,1]
ds_write_b64 v41, v[212:213] offset:5120
buffer_store_dwordx4 v[224:227], v77, s[12:15], s29 offen sc1
v_cvt_pk_bf16_f32 v252, v252, v253
v_cvt_pk_bf16_f32 v233, v234, v235
s_add_u32 s29, s29, 1024
v_cvt_pk_bf16_f32 v253, v254, v255
ds_write_b64 v41, v[232:233] offset:6144
buffer_store_dwordx4 v[244:247], v77, s[12:15], s29 offen sc1
ds_write_b64 v41, v[252:253] offset:7168
s_add_u32 s29, s29, 1024
s_setprio 0
v_mul_f32 v65, v75, v75
v_mul_f32 v64, 0xc0135761, v75
v_mul_f32 v65, 0x3d372713, v65
v_pk_fma_f32 v[236:237], v[2:3], v[38:39], v[236:237] op_sel_hi:[1,0,1]
v_pk_fma_f32 v[238:239], v[4:5], v[38:39], v[238:239] op_sel_hi:[1,0,1]
v_mul_f32 v65, v65, v64
v_pk_mul_f32 v[88:89], v[236:237], v[236:237]
v_pk_mul_f32 v[90:91], v[238:239], v[238:239]
v_pk_fma_f32 v[88:89], v[88:89], v[64:65], v[64:65] op_sel:[0,1,0] op_sel_hi:[1,1,0]
v_pk_fma_f32 v[90:91], v[90:91], v[64:65], v[64:65] op_sel:[0,1,0] op_sel_hi:[1,1,0]
v_pk_mul_f32 v[88:89], v[88:89], v[236:237]
v_pk_mul_f32 v[90:91], v[90:91], v[238:239]
v_exp_f32 v88, v88
v_exp_f32 v89, v89
v_exp_f32 v90, v90
v_exp_f32 v91, v91
v_mul_f32 v66, v39, v39
v_pk_fma_f32 v[240:241], v[6:7], v[38:39], v[240:241] op_sel_hi:[1,0,1]
v_pk_fma_f32 v[88:89], v[88:89], v[66:67], v[66:67] op_sel_hi:[1,0,0]
v_pk_fma_f32 v[90:91], v[90:91], v[66:67], v[66:67] op_sel_hi:[1,0,0]
v_pk_fma_f32 v[242:243], v[8:9], v[38:39], v[242:243] op_sel_hi:[1,0,1]
v_rcp_f32 v88, v88
v_rcp_f32 v89, v89
v_rcp_f32 v90, v90
v_rcp_f32 v91, v91
v_mul_f32 v61, v74, v74
v_mul_f32 v65, v73, v73
v_pk_mul_f32 v[236:237], v[236:237], v[240:241]
v_pk_mul_f32 v[238:239], v[238:239], v[242:243]
v_mul_f32 v60, 0xc0135761, v74
v_mul_f32 v61, 0x3d372713, v61
v_pk_fma_f32 v[216:217], v[2:3], v[36:37], v[216:217] op_sel_hi:[1,0,1]
v_pk_fma_f32 v[218:219], v[4:5], v[36:37], v[218:219] op_sel_hi:[1,0,1]
v_mul_f32 v64, 0xc0135761, v73
v_mul_f32 v65, 0x3d372713, v65
v_pk_fma_f32 v[196:197], v[2:3], v[34:35], v[196:197] op_sel_hi:[1,0,1]
v_pk_fma_f32 v[198:199], v[4:5], v[34:35], v[198:199] op_sel_hi:[1,0,1]
v_pk_mul_f32 v[236:237], v[236:237], v[88:89]
v_pk_mul_f32 v[238:239], v[238:239], v[90:91]
v_mul_f32 v61, v61, v60
v_pk_mul_f32 v[80:81], v[216:217], v[216:217]
v_pk_mul_f32 v[82:83], v[218:219], v[218:219]
v_mul_f32 v65, v65, v64
v_pk_mul_f32 v[88:89], v[196:197], v[196:197]
v_pk_mul_f32 v[90:91], v[198:199], v[198:199]
v_pk_fma_f32 v[80:81], v[80:81], v[60:61], v[60:61] op_sel:[0,1,0] op_sel_hi:[1,1,0]
v_pk_fma_f32 v[82:83], v[82:83], v[60:61], v[60:61] op_sel:[0,1,0] op_sel_hi:[1,1,0]
v_pk_fma_f32 v[88:89], v[88:89], v[64:65], v[64:65] op_sel:[0,1,0] op_sel_hi:[1,1,0]
v_pk_fma_f32 v[90:91], v[90:91], v[64:65], v[64:65] op_sel:[0,1,0] op_sel_hi:[1,1,0]
v_pk_mul_f32 v[80:81], v[80:81], v[216:217]
v_pk_mul_f32 v[82:83], v[82:83], v[218:219]
v_pk_mul_f32 v[88:89], v[88:89], v[196:197]
v_pk_mul_f32 v[90:91], v[90:91], v[198:199]
v_exp_f32 v80, v80
v_exp_f32 v81, v81
v_exp_f32 v82, v82
v_exp_f32 v83, v83
v_exp_f32 v88, v88
v_exp_f32 v89, v89
v_exp_f32 v90, v90
v_exp_f32 v91, v91
v_mul_f32 v62, v37, v37
v_mul_f32 v66, v35, v35
v_pk_fma_f32 v[80:81], v[80:81], v[62:63], v[62:63] op_sel_hi:[1,0,0]
v_pk_fma_f32 v[82:83], v[82:83], v[62:63], v[62:63] op_sel_hi:[1,0,0]
v_pk_fma_f32 v[88:89], v[88:89], v[66:67], v[66:67] op_sel_hi:[1,0,0]
v_pk_fma_f32 v[90:91], v[90:91], v[66:67], v[66:67] op_sel_hi:[1,0,0]
v_pk_fma_f32 v[220:221], v[6:7], v[36:37], v[220:221] op_sel_hi:[1,0,1]
v_pk_fma_f32 v[222:223], v[8:9], v[36:37], v[222:223] op_sel_hi:[1,0,1]
v_rcp_f32 v80, v80
v_rcp_f32 v81, v81
v_rcp_f32 v82, v82
v_rcp_f32 v83, v83
v_pk_fma_f32 v[200:201], v[6:7], v[34:35], v[200:201] op_sel_hi:[1,0,1]
v_pk_fma_f32 v[202:203], v[8:9], v[34:35], v[202:203] op_sel_hi:[1,0,1]
v_rcp_f32 v88, v88
v_rcp_f32 v89, v89
v_rcp_f32 v90, v90
v_rcp_f32 v91, v91
v_pk_mul_f32 v[216:217], v[216:217], v[220:221]
v_pk_mul_f32 v[218:219], v[218:219], v[222:223]
v_pk_mul_f32 v[196:197], v[196:197], v[200:201]
v_pk_mul_f32 v[198:199], v[198:199], v[202:203]
v_pk_mul_f32 v[216:217], v[216:217], v[80:81]
v_pk_mul_f32 v[218:219], v[218:219], v[82:83]
v_pk_mul_f32 v[196:197], v[196:197], v[88:89]
v_pk_mul_f32 v[198:199], v[198:199], v[90:91]
v_cvt_pk_bf16_f32 v252, v236, v237
v_cvt_pk_bf16_f32 v253, v238, v239
v_cvt_pk_bf16_f32 v248, v216, v217
v_cvt_pk_bf16_f32 v249, v218, v219
v_cvt_pk_bf16_f32 v244, v196, v197
v_cvt_pk_bf16_f32 v245, v198, v199
s_waitcnt vmcnt(0) lgkmcnt(0)
s_barrier
s_cmp_lg_u32 s43, 0
s_cbranch_scc1 L_wf_125
s_lshl_b32 s93, s44, 12
s_lshl_b32 s94, s45, 7
s_add_u32 s93, s93, s94
s_add_u32 s93, s93, 0x2f70000
v_mov_b32 v40, s86
buffer_store_dword v40, off, s[24:27], s93 sc1
L_wf_125:
v_mul_f32 v61, v72, v72
v_mul_f32 v65, v71, v71
v_mul_f32 v60, 0xc0135761, v72
v_mul_f32 v61, 0x3d372713, v61
v_pk_fma_f32 v[176:177], v[2:3], v[32:33], v[176:177] op_sel_hi:[1,0,1]
v_pk_fma_f32 v[178:179], v[4:5], v[32:33], v[178:179] op_sel_hi:[1,0,1]
v_mul_f32 v64, 0xc0135761, v71
v_mul_f32 v65, 0x3d372713, v65
v_pk_fma_f32 v[156:157], v[2:3], v[30:31], v[156:157] op_sel_hi:[1,0,1]
v_pk_fma_f32 v[158:159], v[4:5], v[30:31], v[158:159] op_sel_hi:[1,0,1]
v_mul_f32 v61, v61, v60
v_pk_mul_f32 v[80:81], v[176:177], v[176:177]
v_pk_mul_f32 v[82:83], v[178:179], v[178:179]
v_mul_f32 v65, v65, v64
v_pk_mul_f32 v[88:89], v[156:157], v[156:157]
v_pk_mul_f32 v[90:91], v[158:159], v[158:159]
v_pk_fma_f32 v[80:81], v[80:81], v[60:61], v[60:61] op_sel:[0,1,0] op_sel_hi:[1,1,0]
v_pk_fma_f32 v[82:83], v[82:83], v[60:61], v[60:61] op_sel:[0,1,0] op_sel_hi:[1,1,0]
v_pk_fma_f32 v[88:89], v[88:89], v[64:65], v[64:65] op_sel:[0,1,0] op_sel_hi:[1,1,0]
v_pk_fma_f32 v[90:91], v[90:91], v[64:65], v[64:65] op_sel:[0,1,0] op_sel_hi:[1,1,0]
v_pk_mul_f32 v[80:81], v[80:81], v[176:177]
v_pk_mul_f32 v[82:83], v[82:83], v[178:179]
v_pk_mul_f32 v[88:89], v[88:89], v[156:157]
v_pk_mul_f32 v[90:91], v[90:91], v[158:159]
v_exp_f32 v80, v80
v_exp_f32 v81, v81
v_exp_f32 v82, v82
v_exp_f32 v83, v83
v_exp_f32 v88, v88
v_exp_f32 v89, v89
v_exp_f32 v90, v90
v_exp_f32 v91, v91
v_mul_f32 v62, v33, v33
v_mul_f32 v66, v31, v31
v_pk_fma_f32 v[80:81], v[80:81], v[62:63], v[62:63] op_sel_hi:[1,0,0]
v_pk_fma_f32 v[82:83], v[82:83], v[62:63], v[62:63] op_sel_hi:[1,0,0]
v_pk_fma_f32 v[88:89], v[88:89], v[66:67], v[66:67] op_sel_hi:[1,0,0]
v_pk_fma_f32 v[90:91], v[90:91], v[66:67], v[66:67] op_sel_hi:[1,0,0]
v_pk_fma_f32 v[180:181], v[6:7], v[32:33], v[180:181] op_sel_hi:[1,0,1]
v_pk_fma_f32 v[182:183], v[8:9], v[32:33], v[182:183] op_sel_hi:[1,0,1]
v_rcp_f32 v80, v80
v_rcp_f32 v81, v81
v_rcp_f32 v82, v82
v_rcp_f32 v83, v83
v_pk_fma_f32 v[160:161], v[6:7], v[30:31], v[160:161] op_sel_hi:[1,0,1]
v_pk_fma_f32 v[162:163], v[8:9], v[30:31], v[162:163] op_sel_hi:[1,0,1]
v_rcp_f32 v88, v88
v_rcp_f32 v89, v89
v_rcp_f32 v90, v90
v_rcp_f32 v91, v91
v_pk_mul_f32 v[176:177], v[176:177], v[180:181]
v_pk_mul_f32 v[178:179], v[178:179], v[182:183]
v_pk_mul_f32 v[156:157], v[156:157], v[160:161]
v_pk_mul_f32 v[158:159], v[158:159], v[162:163]
v_pk_mul_f32 v[176:177], v[176:177], v[80:81]
v_pk_mul_f32 v[178:179], v[178:179], v[82:83]
v_pk_mul_f32 v[156:157], v[156:157], v[88:89]
v_pk_mul_f32 v[158:159], v[158:159], v[90:91]
v_cvt_pk_bf16_f32 v240, v176, v177
v_cvt_pk_bf16_f32 v241, v178, v179
v_cvt_pk_bf16_f32 v236, v156, v157
v_cvt_pk_bf16_f32 v237, v158, v159
s_lshl_b32 s35, s44, 12
s_lshl_b32 s94, s45, 7
s_add_u32 s35, s35, s94
s_add_u32 s35, s35, 0x2f6f000
buffer_load_dword v185, off, s[24:27], s35 sc1
v_mul_f32 v61, v70, v70
v_mul_f32 v65, v69, v69
v_mul_f32 v60, 0xc0135761, v70
v_mul_f32 v61, 0x3d372713, v61
v_pk_fma_f32 v[136:137], v[2:3], v[28:29], v[136:137] op_sel_hi:[1,0,1]
v_pk_fma_f32 v[138:139], v[4:5], v[28:29], v[138:139] op_sel_hi:[1,0,1]
v_mul_f32 v64, 0xc0135761, v69
v_mul_f32 v65, 0x3d372713, v65
v_pk_fma_f32 v[116:117], v[2:3], v[26:27], v[116:117] op_sel_hi:[1,0,1]
v_pk_fma_f32 v[118:119], v[4:5], v[26:27], v[118:119] op_sel_hi:[1,0,1]
v_mul_f32 v61, v61, v60
v_pk_mul_f32 v[80:81], v[136:137], v[136:137]
v_pk_mul_f32 v[82:83], v[138:139], v[138:139]
v_mul_f32 v65, v65, v64
v_pk_mul_f32 v[88:89], v[116:117], v[116:117]
v_pk_mul_f32 v[90:91], v[118:119], v[118:119]
v_pk_fma_f32 v[80:81], v[80:81], v[60:61], v[60:61] op_sel:[0,1,0] op_sel_hi:[1,1,0]
v_pk_fma_f32 v[82:83], v[82:83], v[60:61], v[60:61] op_sel:[0,1,0] op_sel_hi:[1,1,0]
v_pk_fma_f32 v[88:89], v[88:89], v[64:65], v[64:65] op_sel:[0,1,0] op_sel_hi:[1,1,0]
v_pk_fma_f32 v[90:91], v[90:91], v[64:65], v[64:65] op_sel:[0,1,0] op_sel_hi:[1,1,0]
v_pk_mul_f32 v[80:81], v[80:81], v[136:137]
v_pk_mul_f32 v[82:83], v[82:83], v[138:139]
v_pk_mul_f32 v[88:89], v[88:89], v[116:117]
v_pk_mul_f32 v[90:91], v[90:91], v[118:119]
v_exp_f32 v80, v80
v_exp_f32 v81, v81
v_exp_f32 v82, v82
v_exp_f32 v83, v83
v_exp_f32 v88, v88
v_exp_f32 v89, v89
v_exp_f32 v90, v90
v_exp_f32 v91, v91
v_mul_f32 v62, v29, v29
v_mul_f32 v66, v27, v27
v_pk_fma_f32 v[80:81], v[80:81], v[62:63], v[62:63] op_sel_hi:[1,0,0]
v_pk_fma_f32 v[82:83], v[82:83], v[62:63], v[62:63] op_sel_hi:[1,0,0]
v_pk_fma_f32 v[88:89], v[88:89], v[66:67], v[66:67] op_sel_hi:[1,0,0]
v_pk_fma_f32 v[90:91], v[90:91], v[66:67], v[66:67] op_sel_hi:[1,0,0]
v_pk_fma_f32 v[140:141], v[6:7], v[28:29], v[140:141] op_sel_hi:[1,0,1]
v_pk_fma_f32 v[142:143], v[8:9], v[28:29], v[142:143] op_sel_hi:[1,0,1]
v_rcp_f32 v80, v80
v_rcp_f32 v81, v81
v_rcp_f32 v82, v82
v_rcp_f32 v83, v83
v_pk_fma_f32 v[120:121], v[6:7], v[26:27], v[120:121] op_sel_hi:[1,0,1]
v_pk_fma_f32 v[122:123], v[8:9], v[26:27], v[122:123] op_sel_hi:[1,0,1]
v_rcp_f32 v88, v88
v_rcp_f32 v89, v89
v_rcp_f32 v90, v90
v_rcp_f32 v91, v91
v_pk_mul_f32 v[136:137], v[136:137], v[140:141]
v_pk_mul_f32 v[138:139], v[138:139], v[142:143]
v_pk_mul_f32 v[116:117], v[116:117], v[120:121]
v_pk_mul_f32 v[118:119], v[118:119], v[122:123]
v_pk_mul_f32 v[136:137], v[136:137], v[80:81]
v_pk_mul_f32 v[138:139], v[138:139], v[82:83]
v_pk_mul_f32 v[116:117], v[116:117], v[88:89]
v_pk_mul_f32 v[118:119], v[118:119], v[90:91]
v_cvt_pk_bf16_f32 v232, v136, v137
v_cvt_pk_bf16_f32 v233, v138, v139
v_cvt_pk_bf16_f32 v228, v116, v117
v_cvt_pk_bf16_f32 v229, v118, v119
s_cmp_lt_u32 s43, 4
s_cbranch_scc1 L_kv_126
L_kvb_127:
v_mul_f32 v61, v68, v68
v_mul_f32 v60, 0xc0135761, v68
v_mul_f32 v61, 0x3d372713, v61
v_pk_fma_f32 v[96:97], v[2:3], v[24:25], v[96:97] op_sel_hi:[1,0,1]
v_pk_fma_f32 v[98:99], v[4:5], v[24:25], v[98:99] op_sel_hi:[1,0,1]
v_mul_f32 v61, v61, v60
v_pk_mul_f32 v[80:81], v[96:97], v[96:97]
v_pk_mul_f32 v[82:83], v[98:99], v[98:99]
v_pk_fma_f32 v[80:81], v[80:81], v[60:61], v[60:61] op_sel:[0,1,0] op_sel_hi:[1,1,0]
v_pk_fma_f32 v[82:83], v[82:83], v[60:61], v[60:61] op_sel:[0,1,0] op_sel_hi:[1,1,0]
v_pk_mul_f32 v[80:81], v[80:81], v[96:97]
v_pk_mul_f32 v[82:83], v[82:83], v[98:99]
v_exp_f32 v80, v80
v_exp_f32 v81, v81
v_exp_f32 v82, v82
v_exp_f32 v83, v83
v_mul_f32 v62, v25, v25
v_pk_fma_f32 v[100:101], v[6:7], v[24:25], v[100:101] op_sel_hi:[1,0,1]
v_pk_fma_f32 v[80:81], v[80:81], v[62:63], v[62:63] op_sel_hi:[1,0,0]
v_pk_fma_f32 v[82:83], v[82:83], v[62:63], v[62:63] op_sel_hi:[1,0,0]
v_pk_fma_f32 v[102:103], v[8:9], v[24:25], v[102:103] op_sel_hi:[1,0,1]
v_rcp_f32 v80, v80
v_rcp_f32 v81, v81
v_rcp_f32 v82, v82
v_rcp_f32 v83, v83
v_pk_mul_f32 v[96:97], v[96:97], v[100:101]
v_pk_mul_f32 v[98:99], v[98:99], v[102:103]
buffer_store_dwordx2 v[252:253], v43, s[24:27], s42 offen sc1
v_pk_mul_f32 v[96:97], v[96:97], v[80:81]
v_pk_mul_f32 v[98:99], v[98:99], v[82:83]
s_sub_u32 s42, s42, 147456
v_cvt_pk_bf16_f32 v224, v96, v97
buffer_store_dwordx2 v[248:249], v43, s[24:27], s42 offen sc1
v_cvt_pk_bf16_f32 v225, v98, v99
s_sub_u32 s42, s42, 147456
v_mov_b32 v14, v42
v_mov_b32 v15, v43
v_lshlrev_b32 v7, 4, v0
v_lshlrev_b32 v3, 3, v0
s_lshl_b32 s31, s43, 1
s_lshl_b32 s35, s44, 4
s_add_u32 s35, s35, s31
s_mul_i32 s35, s35, 144
s_add_u32 s35, s35, s45
s_add_u32 s35, s35, 112
s_lshl_b32 s35, s35, 10
s_sub_u32 s34, 16, s31
s_cmp_eq_u32 s44, 0
s_cselect_b32 s34, s34, 0
s_lshl_b32 s31, s31, 10
s_add_u32 s36, s31, 65536
v_lshlrev_b32 v4, 4, v0
v_add_u32 v2, s36, v4
s_add_u32 s36, s31, 131072
v_add_u32 v4, s36, v4
s_cmp_lt_u32 s43, 4
s_cbranch_scc1 L_ap_131
s_setprio 1
L_ap_131:
s_lshr_b32 s31, s31, 1
s_add_u32 s36, s31, 98304
v_add_u32 v3, s36, v3
v_and_b32 v5, 15, v0
v_lshrrev_b32 v6, 4, v0
v_lshlrev_b32 v6, 2, v6
v_cmp_le_u32 s[96:97], v6, v5
v_add_u32 v6, 1, v6
v_cmp_le_u32 s[98:99], v6, v5
v_add_u32 v6, 1, v6
v_cmp_le_u32 s[100:101], v6, v5
v_add_u32 v6, 1, v6
v_cmp_le_u32 s[32:33], v6, v5
v_mov_b32 v184, 0x3e8293ee
v_mov_b32 v82, 0
v_mov_b32 v83, 0
v_mov_b32 v86, 0
v_mov_b32 v87, 0
v_mov_b32 v162, 0
v_mov_b32 v163, 0
v_mov_b32 v176, 0x3f803f80
v_mov_b32 v177, 0x3f803f80
v_mov_b32 v178, 0x3f803f80
v_mov_b32 v179, 0x3f803f80
s_cmp_lt_u32 s43, 4
s_cbranch_scc1 L_nw_132
L_nwb_133:
s_barrier
s_branch L_join_5
L_nl_70:
v_mov_b32 v5, 0
global_load_dword v5, v5, s[56:57] offset:128 sc1
s_branch L_nlb_71
L_cs_72:
v_and_b32 v10, 15, v0
v_mov_b32 v11, s92
v_cmp_eq_u32 vcc, 0, v10
s_nop 1
v_cndmask_b32 v16, 0, v11, vcc
v_mov_b32 v17, v16
v_mov_b32 v18, v16
v_mov_b32 v19, v16
v_mov_b32_dpp v20, v16 row_shr:1 row_mask:0xf bank_mask:0xf bound_ctrl:0
v_mov_b32_dpp v21, v17 row_shr:1 row_mask:0xf bank_mask:0xf bound_ctrl:0
v_mov_b32_dpp v22, v18 row_shr:1 row_mask:0xf bank_mask:0xf bound_ctrl:0
v_mov_b32_dpp v23, v19 row_shr:1 row_mask:0xf bank_mask:0xf bound_ctrl:0
v_mfma_f32_16x16x32_bf16 v[12:15], v[56:59], v[16:19], 0
v_mfma_f32_16x16x32_bf16 v[12:15], v[60:63], v[16:19], v[12:15]
v_mov_b32_dpp v16, v20 row_shr:1 row_mask:0xf bank_mask:0xf bound_ctrl:0
v_mov_b32_dpp v17, v21 row_shr:1 row_mask:0xf bank_mask:0xf bound_ctrl:0
v_mov_b32_dpp v18, v22 row_shr:1 row_mask:0xf bank_mask:0xf bound_ctrl:0
v_mov_b32_dpp v19, v23 row_shr:1 row_mask:0xf bank_mask:0xf bound_ctrl:0
v_mfma_f32_16x16x32_bf16 v[12:15], v[64:67], v[20:23], v[12:15]
v_mfma_f32_16x16x32_bf16 v[12:15], v[68:71], v[20:23], v[12:15]
v_mov_b32_dpp v20, v16 row_shr:1 row_mask:0xf bank_mask:0xf bound_ctrl:0
v_mov_b32_dpp v21, v17 row_shr:1 row_mask:0xf bank_mask:0xf bound_ctrl:0
v_mov_b32_dpp v22, v18 row_shr:1 row_mask:0xf bank_mask:0xf bound_ctrl:0
v_mov_b32_dpp v23, v19 row_shr:1 row_mask:0xf bank_mask:0xf bound_ctrl:0
v_mfma_f32_16x16x32_bf16 v[12:15], v[72:75], v[16:19], v[12:15]
v_mfma_f32_16x16x32_bf16 v[12:15], v[76:79], v[16:19], v[12:15]
v_mov_b32_dpp v16, v20 row_shr:1 row_mask:0xf bank_mask:0xf bound_ctrl:0
v_mov_b32_dpp v17, v21 row_shr:1 row_mask:0xf bank_mask:0xf bound_ctrl:0
v_mov_b32_dpp v18, v22 row_shr:1 row_mask:0xf bank_mask:0xf bound_ctrl:0
v_mov_b32_dpp v19, v23 row_shr:1 row_mask:0xf bank_mask:0xf bound_ctrl:0
v_mfma_f32_16x16x32_bf16 v[12:15], v[80:83], v[20:23], v[12:15]
v_mfma_f32_16x16x32_bf16 v[12:15], v[84:87], v[20:23], v[12:15]
v_mfma_f32_16x16x32_bf16 v[12:15], v[88:91], v[16:19], v[12:15]
v_mfma_f32_16x16x32_bf16 v[12:15], v[92:95], v[16:19], v[12:15]
s_cmp_lg_u32 s44, 6
s_cbranch_scc1 L_cx_74
v_mov_b32 v11, 2147418112
s_add_u32 s93, s90, 0
v_cmp_eq_u32 vcc, 0, v10
v_mov_b32 v9, s93
s_nop 0
v_cndmask_b32 v11, v11, v9, vcc
s_add_u32 s93, s90, 448
v_cmp_eq_u32 vcc, 1, v10
v_mov_b32 v9, s93
s_nop 0
v_cndmask_b32 v11, v11, v9, vcc
s_mov_b32 s93, 128
v_cmp_eq_u32 vcc, 2, v10
v_mov_b32 v9, s93
s_nop 0
v_cndmask_b32 v11, v11, v9, vcc
s_mov_b32 s93, 192
v_cmp_eq_u32 vcc, 3, v10
v_mov_b32 v9, s93
s_nop 0
v_cndmask_b32 v11, v11, v9, vcc
s_mov_b32 s93, 0
v_cmp_eq_u32 vcc, 4, v10
v_mov_b32 v9, s93
s_nop 0
v_cndmask_b32 v11, v11, v9, vcc
v_lshrrev_b32 v10, 4, v0
v_lshl_add_u32 v11, v10, 4, v11
s_lshl_b32 s93, s45, 3
s_add_u32 s93, s93, s44
s_mul_i32 s93, s93, 1280
s_add_u32 s93, s93, 0x2f10000
buffer_store_dwordx4 v[12:15], v11, s[24:27], s93 offen sc1
L_cx_74:
s_branch L_csb_73
L_pf_75:
v_bfe_u32 v9, v0, 1, 2
v_mul_u32_u24 v9, s0, v9
v_lshrrev_b32 v23, 3, v0
v_min_u32 v23, s3, v23
v_mul_u32_u24 v23, s1, v23
v_add3_u32 v9, v9, v23, 56
v_and_b32 v23, 1, v0
s_mov_b32 m0, 152640
v_lshl_add_u32 v9, v23, 7, v9
buffer_load_dwordx4 v9, s[96:99], s100 offen lds
s_add_u32 s100, s100, s101
s_lshl_b32 s93, s2, 13
s_add_u32 s93, s84, s93
s_addc_u32 s94, s85, 0
s_cmp_eq_u32 s100, 32768
s_cmov_b32 s96, s93
s_cmov_b32 s97, s94
s_cmov_b32 s98, 8192
s_cmov_b32 s100, 0
s_cmov_b32 s101, 65536
s_branch L_pfb_76
L_cs_77:
v_and_b32 v10, 15, v0
v_mov_b32 v11, s92
v_cmp_eq_u32 vcc, 0, v10
s_nop 1
v_cndmask_b32 v16, 0, v11, vcc
v_mov_b32 v17, v16
v_mov_b32 v18, v16
v_mov_b32 v19, v16
v_mov_b32_dpp v20, v16 row_shr:1 row_mask:0xf bank_mask:0xf bound_ctrl:0
v_mov_b32_dpp v21, v17 row_shr:1 row_mask:0xf bank_mask:0xf bound_ctrl:0
v_mov_b32_dpp v22, v18 row_shr:1 row_mask:0xf bank_mask:0xf bound_ctrl:0
v_mov_b32_dpp v23, v19 row_shr:1 row_mask:0xf bank_mask:0xf bound_ctrl:0
v_mfma_f32_16x16x32_bf16 v[12:15], v[56:59], v[16:19], v[12:15]
v_mfma_f32_16x16x32_bf16 v[12:15], v[60:63], v[16:19], v[12:15]
v_mov_b32_dpp v16, v20 row_shr:1 row_mask:0xf bank_mask:0xf bound_ctrl:0
v_mov_b32_dpp v17, v21 row_shr:1 row_mask:0xf bank_mask:0xf bound_ctrl:0
v_mov_b32_dpp v18, v22 row_shr:1 row_mask:0xf bank_mask:0xf bound_ctrl:0
v_mov_b32_dpp v19, v23 row_shr:1 row_mask:0xf bank_mask:0xf bound_ctrl:0
v_mfma_f32_16x16x32_bf16 v[12:15], v[64:67], v[20:23], v[12:15]
v_mfma_f32_16x16x32_bf16 v[12:15], v[68:71], v[20:23], v[12:15]
v_mov_b32_dpp v20, v16 row_shr:1 row_mask:0xf bank_mask:0xf bound_ctrl:0
v_mov_b32_dpp v21, v17 row_shr:1 row_mask:0xf bank_mask:0xf bound_ctrl:0
v_mov_b32_dpp v22, v18 row_shr:1 row_mask:0xf bank_mask:0xf bound_ctrl:0
v_mov_b32_dpp v23, v19 row_shr:1 row_mask:0xf bank_mask:0xf bound_ctrl:0
v_mfma_f32_16x16x32_bf16 v[12:15], v[72:75], v[16:19], v[12:15]
v_mfma_f32_16x16x32_bf16 v[12:15], v[76:79], v[16:19], v[12:15]
v_mov_b32_dpp v16, v20 row_shr:1 row_mask:0xf bank_mask:0xf bound_ctrl:0
v_mov_b32_dpp v17, v21 row_shr:1 row_mask:0xf bank_mask:0xf bound_ctrl:0
v_mov_b32_dpp v18, v22 row_shr:1 row_mask:0xf bank_mask:0xf bound_ctrl:0
v_mov_b32_dpp v19, v23 row_shr:1 row_mask:0xf bank_mask:0xf bound_ctrl:0
v_mfma_f32_16x16x32_bf16 v[12:15], v[80:83], v[20:23], v[12:15]
v_mfma_f32_16x16x32_bf16 v[12:15], v[84:87], v[20:23], v[12:15]
v_mfma_f32_16x16x32_bf16 v[12:15], v[88:91], v[16:19], v[12:15]
v_mfma_f32_16x16x32_bf16 v[12:15], v[92:95], v[16:19], v[12:15]
v_mov_b32 v11, 2147418112
s_add_u32 s93, s90, 0
v_cmp_eq_u32 vcc, 0, v10
v_mov_b32 v9, s93
s_nop 0
v_cndmask_b32 v11, v11, v9, vcc
s_add_u32 s93, s90, 448
v_cmp_eq_u32 vcc, 1, v10
v_mov_b32 v9, s93
s_nop 0
v_cndmask_b32 v11, v11, v9, vcc
s_mov_b32 s93, 128
v_cmp_eq_u32 vcc, 2, v10
v_mov_b32 v9, s93
s_nop 0
v_cndmask_b32 v11, v11, v9, vcc
s_mov_b32 s93, 192
v_cmp_eq_u32 vcc, 3, v10
v_mov_b32 v9, s93
s_nop 0
v_cndmask_b32 v11, v11, v9, vcc
s_mov_b32 s93, 0
v_cmp_eq_u32 vcc, 4, v10
v_mov_b32 v9, s93
s_nop 0
v_cndmask_b32 v11, v11, v9, vcc
v_lshrrev_b32 v10, 4, v0
v_lshl_add_u32 v11, v10, 4, v11
s_lshl_b32 s93, s45, 3
s_add_u32 s93, s93, s44
s_mul_i32 s93, s93, 1280
s_add_u32 s93, s93, 0x2f10000
buffer_store_dwordx4 v[12:15], v11, s[24:27], s93 offen sc1
L_cx_79:
s_branch L_csb_78
L_nc_80:
s_mov_b32 s94, 0
L_nlp_82:
v_readfirstlane_b32 s86, v5
s_nop 0
s_cmp_lg_u32 s86, 0
s_cbranch_scc1 L_nok_83
v_mov_b32 v5, 0
global_load_dword v5, v5, s[56:57] offset:128 sc1
s_waitcnt vmcnt(0)
s_add_u32 s94, s94, 1
s_cmp_lt_u32 s94, 0x100000
s_cbranch_scc1 L_nlp_82
L_nok_83:
v_mov_b32 v10, 152576
ds_write_b32 v10, v5
s_branch L_ncb_81
L_rs_85:
v_lshlrev_b32 v20, 16, v10
v_and_b32 v10, 0xffff0000, v10
v_mul_f32 v19, v20, v20
v_add_f32 v18, v20, v10
v_lshlrev_b32 v20, 16, v11
v_and_b32 v11, 0xffff0000, v11
v_add_f32 v18, v18, v20
v_fmac_f32 v19, v20, v20
v_add_f32 v18, v18, v11
v_lshlrev_b32 v20, 16, v12
v_and_b32 v12, 0xffff0000, v12
v_add_f32 v18, v18, v20
v_fmac_f32 v19, v20, v20
v_add_f32 v18, v18, v12
v_lshlrev_b32 v20, 16, v13
v_and_b32 v13, 0xffff0000, v13
v_add_f32 v18, v18, v20
v_fmac_f32 v19, v20, v20
v_add_f32 v18, v18, v13
v_lshlrev_b32 v20, 16, v14
v_mul_f32 v21, v10, v10
v_and_b32 v14, 0xffff0000, v14
v_add_f32 v18, v18, v20
v_fmac_f32 v21, v11, v11
v_fmac_f32 v19, v20, v20
v_add_f32 v18, v18, v14
v_lshlrev_b32 v20, 16, v15
v_fmac_f32 v21, v12, v12
v_and_b32 v15, 0xffff0000, v15
v_add_f32 v18, v18, v20
v_fmac_f32 v21, v13, v13
v_fmac_f32 v19, v20, v20
v_add_f32 v18, v18, v15
v_lshlrev_b32 v20, 16, v16
v_fmac_f32 v21, v14, v14
v_add_f32 v18, v18, v20
v_fmac_f32 v19, v20, v20
v_fmac_f32 v21, v15, v15
v_and_b32 v16, 0xffff0000, v16
v_lshlrev_b32 v20, 16, v17
v_add_f32 v18, v18, v16
v_fmac_f32 v21, v16, v16
v_and_b32 v17, 0xffff0000, v17
v_add_f32 v18, v18, v20
v_fmac_f32 v19, v20, v20
v_fmac_f32 v21, v17, v17
v_add_f32 v18, v18, v17
v_add_f32 v19, v19, v21
s_nop 0
v_add_f32_dpp v18, v18, v18 quad_perm:[1,0,3,2] row_mask:0xf bank_mask:0xf
v_add_f32_dpp v19, v19, v19 quad_perm:[1,0,3,2] row_mask:0xf bank_mask:0xf
s_nop 0
v_add_f32_dpp v18, v18, v18 quad_perm:[2,3,0,1] row_mask:0xf bank_mask:0xf
v_add_f32_dpp v19, v19, v19 quad_perm:[2,3,0,1] row_mask:0xf bank_mask:0xf
s_nop 0
v_add_f32_dpp v18, v18, v18 row_half_mirror row_mask:0xf bank_mask:0xf
v_add_f32_dpp v19, v19, v19 row_half_mirror row_mask:0xf bank_mask:0xf
s_nop 0
v_add_f32_dpp v18, v18, v18 row_mirror row_mask:0xf bank_mask:0xf
v_add_f32_dpp v19, v19, v19 row_mirror row_mask:0xf bank_mask:0xf
v_mov_b32 v20, v18
v_mov_b32 v21, v19
s_nop 0
v_permlane16_swap_b32 v18, v20
v_permlane16_swap_b32 v19, v21
v_add_f32 v18, v18, v20
v_add_f32 v19, v19, v21
v_mov_b32 v20, v18
v_mov_b32 v21, v19
s_nop 0
v_permlane32_swap_b32 v18, v20
v_permlane32_swap_b32 v19, v21
v_add_f32 v18, v18, v20
v_add_f32 v19, v19, v21
v_mul_f32 v18, 0xba800000, v18
v_mul_f32 v19, 0x3a800000, v19
v_fma_f32 v19, -v18, v18, v19
v_cvt_pk_bf16_f32 v18, v18, v18
v_max_f32 v19, 0, v19
v_lshlrev_b32 v18, 16, v18
v_cvt_pk_bf16_f32 v19, v19, v19
v_lshlrev_b32 v19, 16, v19
v_add_f32 v19, 0x3727c5ac, v19
v_cvt_pk_bf16_f32 v19, v19, v19
v_lshlrev_b32 v19, 16, v19
v_sqrt_f32 v19, v19
s_nop 0
v_cvt_pk_bf16_f32 v19, v19, v19
v_lshlrev_b32 v19, 16, v19
s_lshr_b32 s95, s95, 8
s_add_u32 s95, s95, 0x2f00000
buffer_store_dwordx2 v[18:19], off, s[24:27], s95 sc1
s_branch L_rsb_86
L_rw_87:
s_lshl_b32 s95, s44, 5
s_add_u32 s95, s95, s45
s_lshl_b32 s95, s95, 3
s_add_u32 s95, s95, s43
s_lshl_b32 s95, s95, 11
v_lshlrev_b32 v14, 4, v0
buffer_load_dwordx4 v[10:13], v14, s[8:11], s95 offen
buffer_load_dwordx4 v[14:17], v14, s[8:11], s95 offen offset:1024
s_branch L_rwb_88
L_pf_89:
v_bfe_u32 v9, v0, 1, 2
v_mul_u32_u24 v9, s0, v9
v_lshrrev_b32 v23, 3, v0
v_min_u32 v23, s3, v23
v_mul_u32_u24 v23, s1, v23
v_add3_u32 v9, v9, v23, 56
v_and_b32 v23, 1, v0
s_mov_b32 m0, 152640
v_lshl_add_u32 v9, v23, 7, v9
buffer_load_dwordx4 v9, s[96:99], s100 offen lds
s_add_u32 s100, s100, s101
s_lshl_b32 s93, s2, 13
s_add_u32 s93, s84, s93
s_addc_u32 s94, s85, 0
s_cmp_eq_u32 s100, 32768
s_cmov_b32 s96, s93
s_cmov_b32 s97, s94
s_cmov_b32 s98, 8192
s_cmov_b32 s100, 0
s_cmov_b32 s101, 65536
s_branch L_pfb_90
L_cs_91:
v_and_b32 v10, 15, v0
v_mov_b32 v11, s92
v_cmp_eq_u32 vcc, 0, v10
s_nop 1
v_cndmask_b32 v16, 0, v11, vcc
v_mov_b32 v17, v16
v_mov_b32 v18, v16
v_mov_b32 v19, v16
v_mov_b32_dpp v20, v16 row_shr:1 row_mask:0xf bank_mask:0xf bound_ctrl:0
v_mov_b32_dpp v21, v17 row_shr:1 row_mask:0xf bank_mask:0xf bound_ctrl:0
v_mov_b32_dpp v22, v18 row_shr:1 row_mask:0xf bank_mask:0xf bound_ctrl:0
v_mov_b32_dpp v23, v19 row_shr:1 row_mask:0xf bank_mask:0xf bound_ctrl:0
v_mfma_f32_16x16x32_bf16 v[12:15], v[56:59], v[16:19], 0
v_mfma_f32_16x16x32_bf16 v[12:15], v[60:63], v[16:19], v[12:15]
v_mov_b32_dpp v16, v20 row_shr:1 row_mask:0xf bank_mask:0xf bound_ctrl:0
v_mov_b32_dpp v17, v21 row_shr:1 row_mask:0xf bank_mask:0xf bound_ctrl:0
v_mov_b32_dpp v18, v22 row_shr:1 row_mask:0xf bank_mask:0xf bound_ctrl:0
v_mov_b32_dpp v19, v23 row_shr:1 row_mask:0xf bank_mask:0xf bound_ctrl:0
v_mfma_f32_16x16x32_bf16 v[12:15], v[64:67], v[20:23], v[12:15]
v_mfma_f32_16x16x32_bf16 v[12:15], v[68:71], v[20:23], v[12:15]
v_mov_b32_dpp v20, v16 row_shr:1 row_mask:0xf bank_mask:0xf bound_ctrl:0
v_mov_b32_dpp v21, v17 row_shr:1 row_mask:0xf bank_mask:0xf bound_ctrl:0
v_mov_b32_dpp v22, v18 row_shr:1 row_mask:0xf bank_mask:0xf bound_ctrl:0
v_mov_b32_dpp v23, v19 row_shr:1 row_mask:0xf bank_mask:0xf bound_ctrl:0
v_mfma_f32_16x16x32_bf16 v[12:15], v[72:75], v[16:19], v[12:15]
v_mfma_f32_16x16x32_bf16 v[12:15], v[76:79], v[16:19], v[12:15]
v_mov_b32_dpp v16, v20 row_shr:1 row_mask:0xf bank_mask:0xf bound_ctrl:0
v_mov_b32_dpp v17, v21 row_shr:1 row_mask:0xf bank_mask:0xf bound_ctrl:0
v_mov_b32_dpp v18, v22 row_shr:1 row_mask:0xf bank_mask:0xf bound_ctrl:0
v_mov_b32_dpp v19, v23 row_shr:1 row_mask:0xf bank_mask:0xf bound_ctrl:0
v_mfma_f32_16x16x32_bf16 v[12:15], v[80:83], v[20:23], v[12:15]
v_mfma_f32_16x16x32_bf16 v[12:15], v[84:87], v[20:23], v[12:15]
v_mfma_f32_16x16x32_bf16 v[12:15], v[88:91], v[16:19], v[12:15]
v_mfma_f32_16x16x32_bf16 v[12:15], v[92:95], v[16:19], v[12:15]
s_cmp_lg_u32 s44, 6
s_cbranch_scc1 L_cx_93
v_mov_b32 v11, 2147418112
s_add_u32 s93, s90, 0
v_cmp_eq_u32 vcc, 0, v10
v_mov_b32 v9, s93
s_nop 0
v_cndmask_b32 v11, v11, v9, vcc
s_add_u32 s93, s90, 448
v_cmp_eq_u32 vcc, 1, v10
v_mov_b32 v9, s93
s_nop 0
v_cndmask_b32 v11, v11, v9, vcc
s_mov_b32 s93, 128
v_cmp_eq_u32 vcc, 2, v10
v_mov_b32 v9, s93
s_nop 0
v_cndmask_b32 v11, v11, v9, vcc
s_mov_b32 s93, 192
v_cmp_eq_u32 vcc, 3, v10
v_mov_b32 v9, s93
s_nop 0
v_cndmask_b32 v11, v11, v9, vcc
s_mov_b32 s93, 0
v_cmp_eq_u32 vcc, 4, v10
v_mov_b32 v9, s93
s_nop 0
v_cndmask_b32 v11, v11, v9, vcc
v_lshrrev_b32 v10, 4, v0
v_lshl_add_u32 v11, v10, 4, v11
s_lshl_b32 s93, s45, 3
s_add_u32 s93, s93, s44
s_mul_i32 s93, s93, 1280
s_add_u32 s93, s93, 0x2f10000
buffer_store_dwordx4 v[12:15], v11, s[24:27], s93 offen sc1
L_cx_93:
s_branch L_csb_92
L_fl_94:
s_lshl_b32 s93, s45, 10
s_lshl_b32 s94, s44, 7
s_add_u32 s93, s93, s94
s_add_u32 s93, s93, 0x2f68000
v_mov_b32 v23, s86
buffer_store_dword v23, off, s[24:27], s93 sc1
s_branch L_flb_95
L_rs_96:
v_lshlrev_b32 v20, 16, v10
v_and_b32 v10, 0xffff0000, v10
v_mul_f32 v19, v20, v20
v_add_f32 v18, v20, v10
v_lshlrev_b32 v20, 16, v11
v_and_b32 v11, 0xffff0000, v11
v_add_f32 v18, v18, v20
v_fmac_f32 v19, v20, v20
v_add_f32 v18, v18, v11
v_lshlrev_b32 v20, 16, v12
v_and_b32 v12, 0xffff0000, v12
v_add_f32 v18, v18, v20
v_fmac_f32 v19, v20, v20
v_add_f32 v18, v18, v12
v_lshlrev_b32 v20, 16, v13
v_and_b32 v13, 0xffff0000, v13
v_add_f32 v18, v18, v20
v_fmac_f32 v19, v20, v20
v_add_f32 v18, v18, v13
v_lshlrev_b32 v20, 16, v14
v_mul_f32 v21, v10, v10
v_and_b32 v14, 0xffff0000, v14
v_add_f32 v18, v18, v20
v_fmac_f32 v21, v11, v11
v_fmac_f32 v19, v20, v20
v_add_f32 v18, v18, v14
v_lshlrev_b32 v20, 16, v15
v_fmac_f32 v21, v12, v12
v_and_b32 v15, 0xffff0000, v15
v_add_f32 v18, v18, v20
v_fmac_f32 v21, v13, v13
v_fmac_f32 v19, v20, v20
v_add_f32 v18, v18, v15
v_lshlrev_b32 v20, 16, v16
v_fmac_f32 v21, v14, v14
v_add_f32 v18, v18, v20
v_fmac_f32 v19, v20, v20
v_fmac_f32 v21, v15, v15
v_and_b32 v16, 0xffff0000, v16
v_lshlrev_b32 v20, 16, v17
v_add_f32 v18, v18, v16
v_fmac_f32 v21, v16, v16
v_and_b32 v17, 0xffff0000, v17
v_add_f32 v18, v18, v20
v_fmac_f32 v19, v20, v20
v_fmac_f32 v21, v17, v17
v_add_f32 v18, v18, v17
v_add_f32 v19, v19, v21
s_nop 0
v_add_f32_dpp v18, v18, v18 quad_perm:[1,0,3,2] row_mask:0xf bank_mask:0xf
v_add_f32_dpp v19, v19, v19 quad_perm:[1,0,3,2] row_mask:0xf bank_mask:0xf
s_nop 0
v_add_f32_dpp v18, v18, v18 quad_perm:[2,3,0,1] row_mask:0xf bank_mask:0xf
v_add_f32_dpp v19, v19, v19 quad_perm:[2,3,0,1] row_mask:0xf bank_mask:0xf
s_nop 0
v_add_f32_dpp v18, v18, v18 row_half_mirror row_mask:0xf bank_mask:0xf
v_add_f32_dpp v19, v19, v19 row_half_mirror row_mask:0xf bank_mask:0xf
s_nop 0
v_add_f32_dpp v18, v18, v18 row_mirror row_mask:0xf bank_mask:0xf
v_add_f32_dpp v19, v19, v19 row_mirror row_mask:0xf bank_mask:0xf
v_mov_b32 v20, v18
v_mov_b32 v21, v19
s_nop 0
v_permlane16_swap_b32 v18, v20
v_permlane16_swap_b32 v19, v21
v_add_f32 v18, v18, v20
v_add_f32 v19, v19, v21
v_mov_b32 v20, v18
v_mov_b32 v21, v19
s_nop 0
v_permlane32_swap_b32 v18, v20
v_permlane32_swap_b32 v19, v21
v_add_f32 v18, v18, v20
v_add_f32 v19, v19, v21
v_mul_f32 v18, 0xba800000, v18
v_mul_f32 v19, 0x3a800000, v19
v_fma_f32 v19, -v18, v18, v19
v_cvt_pk_bf16_f32 v18, v18, v18
v_max_f32 v19, 0, v19
v_lshlrev_b32 v18, 16, v18
v_cvt_pk_bf16_f32 v19, v19, v19
v_lshlrev_b32 v19, 16, v19
v_add_f32 v19, 0x3727c5ac, v19
v_cvt_pk_bf16_f32 v19, v19, v19
v_lshlrev_b32 v19, 16, v19
v_sqrt_f32 v19, v19
s_nop 0
v_cvt_pk_bf16_f32 v19, v19, v19
v_lshlrev_b32 v19, 16, v19
s_lshr_b32 s95, s95, 8
s_add_u32 s95, s95, 0x2f00000
buffer_store_dwordx2 v[18:19], off, s[24:27], s95 sc1
s_branch L_rsb_97
L_rw_98:
s_lshl_b32 s95, s44, 5
s_add_u32 s95, s95, s45
s_lshl_b32 s95, s95, 3
s_add_u32 s95, s95, s43
s_lshl_b32 s95, s95, 11
v_lshlrev_b32 v14, 4, v0
buffer_load_dwordx4 v[10:13], v14, s[8:11], s95 offen
buffer_load_dwordx4 v[14:17], v14, s[8:11], s95 offen offset:1024
s_branch L_rwb_99
L_fs_100:
s_lshl_b32 s93, s44, 12
s_lshl_b32 s94, s45, 7
s_add_u32 s93, s93, s94
s_add_u32 s93, s93, 0x2f60000
v_mov_b32 v23, s86
buffer_store_dword v23, off, s[24:27], s93 sc1
s_branch L_fsb_101
L_cs_102:
v_and_b32 v10, 15, v0
v_mov_b32 v11, s92
v_cmp_eq_u32 vcc, 0, v10
s_nop 1
v_cndmask_b32 v16, 0, v11, vcc
v_mov_b32 v17, v16
v_mov_b32 v18, v16
v_mov_b32 v19, v16
v_mov_b32_dpp v20, v16 row_shr:1 row_mask:0xf bank_mask:0xf bound_ctrl:0
v_mov_b32_dpp v21, v17 row_shr:1 row_mask:0xf bank_mask:0xf bound_ctrl:0
v_mov_b32_dpp v22, v18 row_shr:1 row_mask:0xf bank_mask:0xf bound_ctrl:0
v_mov_b32_dpp v23, v19 row_shr:1 row_mask:0xf bank_mask:0xf bound_ctrl:0
v_mfma_f32_16x16x32_bf16 v[12:15], v[56:59], v[16:19], v[12:15]
v_mfma_f32_16x16x32_bf16 v[12:15], v[60:63], v[16:19], v[12:15]
v_mov_b32_dpp v16, v20 row_shr:1 row_mask:0xf bank_mask:0xf bound_ctrl:0
v_mov_b32_dpp v17, v21 row_shr:1 row_mask:0xf bank_mask:0xf bound_ctrl:0
v_mov_b32_dpp v18, v22 row_shr:1 row_mask:0xf bank_mask:0xf bound_ctrl:0
v_mov_b32_dpp v19, v23 row_shr:1 row_mask:0xf bank_mask:0xf bound_ctrl:0
v_mfma_f32_16x16x32_bf16 v[12:15], v[64:67], v[20:23], v[12:15]
v_mfma_f32_16x16x32_bf16 v[12:15], v[68:71], v[20:23], v[12:15]
v_mov_b32_dpp v20, v16 row_shr:1 row_mask:0xf bank_mask:0xf bound_ctrl:0
v_mov_b32_dpp v21, v17 row_shr:1 row_mask:0xf bank_mask:0xf bound_ctrl:0
v_mov_b32_dpp v22, v18 row_shr:1 row_mask:0xf bank_mask:0xf bound_ctrl:0
v_mov_b32_dpp v23, v19 row_shr:1 row_mask:0xf bank_mask:0xf bound_ctrl:0
v_mfma_f32_16x16x32_bf16 v[12:15], v[72:75], v[16:19], v[12:15]
v_mfma_f32_16x16x32_bf16 v[12:15], v[76:79], v[16:19], v[12:15]
v_mov_b32_dpp v16, v20 row_shr:1 row_mask:0xf bank_mask:0xf bound_ctrl:0
v_mov_b32_dpp v17, v21 row_shr:1 row_mask:0xf bank_mask:0xf bound_ctrl:0
v_mov_b32_dpp v18, v22 row_shr:1 row_mask:0xf bank_mask:0xf bound_ctrl:0
v_mov_b32_dpp v19, v23 row_shr:1 row_mask:0xf bank_mask:0xf bound_ctrl:0
v_mfma_f32_16x16x32_bf16 v[12:15], v[80:83], v[20:23], v[12:15]
v_mfma_f32_16x16x32_bf16 v[12:15], v[84:87], v[20:23], v[12:15]
v_mfma_f32_16x16x32_bf16 v[12:15], v[88:91], v[16:19], v[12:15]
v_mfma_f32_16x16x32_bf16 v[12:15], v[92:95], v[16:19], v[12:15]
v_mov_b32 v11, 2147418112
s_add_u32 s93, s90, 0
v_cmp_eq_u32 vcc, 0, v10
v_mov_b32 v9, s93
s_nop 0
v_cndmask_b32 v11, v11, v9, vcc
s_add_u32 s93, s90, 448
v_cmp_eq_u32 vcc, 1, v10
v_mov_b32 v9, s93
s_nop 0
v_cndmask_b32 v11, v11, v9, vcc
s_mov_b32 s93, 128
v_cmp_eq_u32 vcc, 2, v10
v_mov_b32 v9, s93
s_nop 0
v_cndmask_b32 v11, v11, v9, vcc
s_mov_b32 s93, 192
v_cmp_eq_u32 vcc, 3, v10
v_mov_b32 v9, s93
s_nop 0
v_cndmask_b32 v11, v11, v9, vcc
s_mov_b32 s93, 0
v_cmp_eq_u32 vcc, 4, v10
v_mov_b32 v9, s93
s_nop 0
v_cndmask_b32 v11, v11, v9, vcc
v_lshrrev_b32 v10, 4, v0
v_lshl_add_u32 v11, v10, 4, v11
s_lshl_b32 s93, s45, 3
s_add_u32 s93, s93, s44
s_mul_i32 s93, s93, 1280
s_add_u32 s93, s93, 0x2f10000
buffer_store_dwordx4 v[12:15], v11, s[24:27], s93 offen sc1
L_cx_104:
s_branch L_csb_103
L_cs_105:
v_and_b32 v10, 15, v0
v_mov_b32 v11, s92
v_cmp_eq_u32 vcc, 0, v10
s_nop 1
v_cndmask_b32 v16, 0, v11, vcc
v_mov_b32 v17, v16
v_mov_b32 v18, v16
v_mov_b32 v19, v16
v_mov_b32_dpp v20, v16 row_shr:1 row_mask:0xf bank_mask:0xf bound_ctrl:0
v_mov_b32_dpp v21, v17 row_shr:1 row_mask:0xf bank_mask:0xf bound_ctrl:0
v_mov_b32_dpp v22, v18 row_shr:1 row_mask:0xf bank_mask:0xf bound_ctrl:0
v_mov_b32_dpp v23, v19 row_shr:1 row_mask:0xf bank_mask:0xf bound_ctrl:0
v_mfma_f32_16x16x32_bf16 v[12:15], v[56:59], v[16:19], 0
v_mfma_f32_16x16x32_bf16 v[12:15], v[60:63], v[16:19], v[12:15]
v_mov_b32_dpp v16, v20 row_shr:1 row_mask:0xf bank_mask:0xf bound_ctrl:0
v_mov_b32_dpp v17, v21 row_shr:1 row_mask:0xf bank_mask:0xf bound_ctrl:0
v_mov_b32_dpp v18, v22 row_shr:1 row_mask:0xf bank_mask:0xf bound_ctrl:0
v_mov_b32_dpp v19, v23 row_shr:1 row_mask:0xf bank_mask:0xf bound_ctrl:0
v_mfma_f32_16x16x32_bf16 v[12:15], v[64:67], v[20:23], v[12:15]
v_mfma_f32_16x16x32_bf16 v[12:15], v[68:71], v[20:23], v[12:15]
v_mov_b32_dpp v20, v16 row_shr:1 row_mask:0xf bank_mask:0xf bound_ctrl:0
v_mov_b32_dpp v21, v17 row_shr:1 row_mask:0xf bank_mask:0xf bound_ctrl:0
v_mov_b32_dpp v22, v18 row_shr:1 row_mask:0xf bank_mask:0xf bound_ctrl:0
v_mov_b32_dpp v23, v19 row_shr:1 row_mask:0xf bank_mask:0xf bound_ctrl:0
v_mfma_f32_16x16x32_bf16 v[12:15], v[72:75], v[16:19], v[12:15]
v_mfma_f32_16x16x32_bf16 v[12:15], v[76:79], v[16:19], v[12:15]
v_mov_b32_dpp v16, v20 row_shr:1 row_mask:0xf bank_mask:0xf bound_ctrl:0
v_mov_b32_dpp v17, v21 row_shr:1 row_mask:0xf bank_mask:0xf bound_ctrl:0
v_mov_b32_dpp v18, v22 row_shr:1 row_mask:0xf bank_mask:0xf bound_ctrl:0
v_mov_b32_dpp v19, v23 row_shr:1 row_mask:0xf bank_mask:0xf bound_ctrl:0
v_mfma_f32_16x16x32_bf16 v[12:15], v[80:83], v[20:23], v[12:15]
v_mfma_f32_16x16x32_bf16 v[12:15], v[84:87], v[20:23], v[12:15]
v_mfma_f32_16x16x32_bf16 v[12:15], v[88:91], v[16:19], v[12:15]
v_mfma_f32_16x16x32_bf16 v[12:15], v[92:95], v[16:19], v[12:15]
s_branch L_csb_106
L_fl_107:
s_lshl_b32 s93, s45, 10
s_lshl_b32 s94, s44, 7
s_add_u32 s93, s93, s94
s_add_u32 s93, s93, 0x2f68000
v_mov_b32 v23, s86
buffer_store_dword v23, off, s[24:27], s93 sc1
s_branch L_flb_108
L_li_109:
v_cmp_gt_u32 vcc, 32, v0
v_lshlrev_b32 v10, 7, v0
s_lshl_b32 s93, s44, 12
v_add_u32 v11, s93, v10
s_lshl_b32 s93, s45, 10
s_add_u32 s93, s93, 28672
v_min_u32 v10, 4864, v10
v_add_u32 v10, s93, v10
v_cndmask_b32 v7, v10, v11, vcc
s_mov_b32 s29, 0x2f60000
buffer_load_dword v8, v7, s[24:27], s29 offen sc1
s_branch L_lib_110
L_cs_111:
v_and_b32 v10, 15, v0
v_mov_b32 v11, s92
v_cmp_eq_u32 vcc, 0, v10
s_nop 1
v_cndmask_b32 v16, 0, v11, vcc
v_mov_b32 v17, v16
v_mov_b32 v18, v16
v_mov_b32 v19, v16
v_mov_b32_dpp v20, v16 row_shr:1 row_mask:0xf bank_mask:0xf bound_ctrl:0
v_mov_b32_dpp v21, v17 row_shr:1 row_mask:0xf bank_mask:0xf bound_ctrl:0
v_mov_b32_dpp v22, v18 row_shr:1 row_mask:0xf bank_mask:0xf bound_ctrl:0
v_mov_b32_dpp v23, v19 row_shr:1 row_mask:0xf bank_mask:0xf bound_ctrl:0
v_mfma_f32_16x16x32_bf16 v[12:15], v[56:59], v[16:19], v[12:15]
v_mfma_f32_16x16x32_bf16 v[12:15], v[60:63], v[16:19], v[12:15]
v_mov_b32_dpp v16, v20 row_shr:1 row_mask:0xf bank_mask:0xf bound_ctrl:0
v_mov_b32_dpp v17, v21 row_shr:1 row_mask:0xf bank_mask:0xf bound_ctrl:0
v_mov_b32_dpp v18, v22 row_shr:1 row_mask:0xf bank_mask:0xf bound_ctrl:0
v_mov_b32_dpp v19, v23 row_shr:1 row_mask:0xf bank_mask:0xf bound_ctrl:0
v_mfma_f32_16x16x32_bf16 v[12:15], v[64:67], v[20:23], v[12:15]
v_mfma_f32_16x16x32_bf16 v[12:15], v[68:71], v[20:23], v[12:15]
v_mov_b32_dpp v20, v16 row_shr:1 row_mask:0xf bank_mask:0xf bound_ctrl:0
v_mov_b32_dpp v21, v17 row_shr:1 row_mask:0xf bank_mask:0xf bound_ctrl:0
v_mov_b32_dpp v22, v18 row_shr:1 row_mask:0xf bank_mask:0xf bound_ctrl:0
v_mov_b32_dpp v23, v19 row_shr:1 row_mask:0xf bank_mask:0xf bound_ctrl:0
v_mfma_f32_16x16x32_bf16 v[12:15], v[72:75], v[16:19], v[12:15]
v_mfma_f32_16x16x32_bf16 v[12:15], v[76:79], v[16:19], v[12:15]
v_mov_b32_dpp v16, v20 row_shr:1 row_mask:0xf bank_mask:0xf bound_ctrl:0
v_mov_b32_dpp v17, v21 row_shr:1 row_mask:0xf bank_mask:0xf bound_ctrl:0
v_mov_b32_dpp v18, v22 row_shr:1 row_mask:0xf bank_mask:0xf bound_ctrl:0
v_mov_b32_dpp v19, v23 row_shr:1 row_mask:0xf bank_mask:0xf bound_ctrl:0
v_mfma_f32_16x16x32_bf16 v[12:15], v[80:83], v[20:23], v[12:15]
v_mfma_f32_16x16x32_bf16 v[12:15], v[84:87], v[20:23], v[12:15]
v_mfma_f32_16x16x32_bf16 v[12:15], v[88:91], v[16:19], v[12:15]
v_mfma_f32_16x16x32_bf16 v[12:15], v[92:95], v[16:19], v[12:15]
s_branch L_csb_112
L_lc_113:
s_waitcnt vmcnt(0)
v_cmp_ne_u32 vcc, s86, v8
s_nop 1
s_cbranch_vccz L_lok_115
s_mov_b32 s94, 0
L_pln_116:
buffer_load_dword v8, v7, s[24:27], s29 offen sc1
s_waitcnt vmcnt(0)
v_cmp_ne_u32 vcc, s86, v8
s_nop 1
s_cbranch_vccz L_plnok_117
s_add_u32 s94, s94, 1
s_cmp_lt_u32 s94, 0x80000
s_cbranch_scc1 L_pln_116
L_plnok_117:
L_lok_115:
s_branch L_lcb_114
L_pc_118:
s_mul_i32 s93, s45, 10240
s_add_u32 s93, s93, 0x2f10000
buffer_load_dwordx2 v[10:11], v9, s[24:27], s93 offen offset:0 sc1
buffer_load_dwordx2 v[12:13], v9, s[24:27], s93 offen offset:1280 sc1
buffer_load_dwordx2 v[14:15], v9, s[24:27], s93 offen offset:2560 sc1
s_add_u32 s93, s93, 3840
buffer_load_dwordx2 v[16:17], v9, s[24:27], s93 offen offset:0 sc1
buffer_load_dwordx2 v[18:19], v9, s[24:27], s93 offen offset:1280 sc1
buffer_load_dwordx2 v[20:21], v9, s[24:27], s93 offen offset:2560 sc1
s_add_u32 s93, s93, 3840
buffer_load_dwordx2 v[22:23], v9, s[24:27], s93 offen offset:0 sc1
s_branch L_pcb_119
L_cs_120:
v_and_b32 v10, 15, v0
v_mov_b32 v11, s92
v_cmp_eq_u32 vcc, 0, v10
s_nop 1
v_cndmask_b32 v16, 0, v11, vcc
v_mov_b32 v17, v16
v_mov_b32 v18, v16
v_mov_b32 v19, v16
v_mov_b32_dpp v20, v16 row_shr:1 row_mask:0xf bank_mask:0xf bound_ctrl:0
v_mov_b32_dpp v21, v17 row_shr:1 row_mask:0xf bank_mask:0xf bound_ctrl:0
v_mov_b32_dpp v22, v18 row_shr:1 row_mask:0xf bank_mask:0xf bound_ctrl:0
v_mov_b32_dpp v23, v19 row_shr:1 row_mask:0xf bank_mask:0xf bound_ctrl:0
v_mfma_f32_16x16x32_bf16 v[12:15], v[56:59], v[16:19], v[12:15]
v_mfma_f32_16x16x32_bf16 v[12:15], v[60:63], v[16:19], v[12:15]
v_mov_b32_dpp v16, v20 row_shr:1 row_mask:0xf bank_mask:0xf bound_ctrl:0
v_mov_b32_dpp v17, v21 row_shr:1 row_mask:0xf bank_mask:0xf bound_ctrl:0
v_mov_b32_dpp v18, v22 row_shr:1 row_mask:0xf bank_mask:0xf bound_ctrl:0
v_mov_b32_dpp v19, v23 row_shr:1 row_mask:0xf bank_mask:0xf bound_ctrl:0
v_mfma_f32_16x16x32_bf16 v[12:15], v[64:67], v[20:23], v[12:15]
v_mfma_f32_16x16x32_bf16 v[12:15], v[68:71], v[20:23], v[12:15]
v_mov_b32_dpp v20, v16 row_shr:1 row_mask:0xf bank_mask:0xf bound_ctrl:0
v_mov_b32_dpp v21, v17 row_shr:1 row_mask:0xf bank_mask:0xf bound_ctrl:0
v_mov_b32_dpp v22, v18 row_shr:1 row_mask:0xf bank_mask:0xf bound_ctrl:0
v_mov_b32_dpp v23, v19 row_shr:1 row_mask:0xf bank_mask:0xf bound_ctrl:0
v_mfma_f32_16x16x32_bf16 v[12:15], v[72:75], v[16:19], v[12:15]
v_mfma_f32_16x16x32_bf16 v[12:15], v[76:79], v[16:19], v[12:15]
v_mov_b32_dpp v16, v20 row_shr:1 row_mask:0xf bank_mask:0xf bound_ctrl:0
v_mov_b32_dpp v17, v21 row_shr:1 row_mask:0xf bank_mask:0xf bound_ctrl:0
v_mov_b32_dpp v18, v22 row_shr:1 row_mask:0xf bank_mask:0xf bound_ctrl:0
v_mov_b32_dpp v19, v23 row_shr:1 row_mask:0xf bank_mask:0xf bound_ctrl:0
v_mfma_f32_16x16x32_bf16 v[12:15], v[80:83], v[20:23], v[12:15]
v_mfma_f32_16x16x32_bf16 v[12:15], v[84:87], v[20:23], v[12:15]
v_mfma_f32_16x16x32_bf16 v[12:15], v[88:91], v[16:19], v[12:15]
v_mfma_f32_16x16x32_bf16 v[12:15], v[92:95], v[16:19], v[12:15]
v_mov_b32 v11, 5184
s_add_u32 s93, s90, 0
v_cmp_eq_u32 vcc, 0, v10
v_mov_b32 v9, s93
s_nop 0
v_cndmask_b32 v11, v11, v9, vcc
s_add_u32 s93, s90, 448
v_cmp_eq_u32 vcc, 1, v10
v_mov_b32 v9, s93
s_nop 0
v_cndmask_b32 v11, v11, v9, vcc
s_mov_b32 s93, 128
v_cmp_eq_u32 vcc, 2, v10
v_mov_b32 v9, s93
s_nop 0
v_cndmask_b32 v11, v11, v9, vcc
s_mov_b32 s93, 192
v_cmp_eq_u32 vcc, 3, v10
v_mov_b32 v9, s93
s_nop 0
v_cndmask_b32 v11, v11, v9, vcc
s_mov_b32 s93, 0
v_cmp_eq_u32 vcc, 4, v10
v_mov_b32 v9, s93
s_nop 0
v_cndmask_b32 v11, v11, v9, vcc
v_lshrrev_b32 v10, 4, v0
v_lshl_add_u32 v11, v10, 4, v11
v_add_u32 v11, 147456, v11
ds_write_b128 v11, v[12:15]
L_cx_122:
s_branch L_csb_121
L_ps_123:
s_waitcnt vmcnt(0)
v_add_f32 v10, v10, v12
v_add_f32 v11, v11, v13
v_add_f32 v14, v14, v16
v_add_f32 v15, v15, v17
v_add_f32 v18, v18, v20
v_add_f32 v19, v19, v21
v_add_f32 v22, v22, v6
v_add_f32 v23, v23, v7
v_add_f32 v10, v10, v14
v_add_f32 v11, v11, v15
v_add_f32 v18, v18, v22
v_add_f32 v19, v19, v23
v_add_f32 v10, v10, v18
v_add_f32 v11, v11, v19
v_add_u32 v9, 151296, v9
ds_write_b64 v9, v[10:11]
s_branch L_psb_124
L_kv_126:
s_cmp_eq_u32 s44, 0
s_cselect_b32 s14, 0, s26
s_cbranch_scc1 L_kvok_128
s_waitcnt vmcnt(0)
v_cmp_ne_u32 vcc, s86, v185
v_mov_b32 v45, 0
s_nop 0
s_cbranch_vccz L_kvok_128
s_mov_b32 s94, 0
L_pkv_129:
buffer_load_dword v185, v45, s[24:27], s35 offen sc1
s_waitcnt vmcnt(0)
v_cmp_ne_u32 vcc, s86, v185
s_nop 1
s_cbranch_vccz L_pkvok_130
s_add_u32 s94, s94, 1
s_cmp_lt_u32 s94, 0x80000
s_cbranch_scc1 L_pkv_129
L_pkvok_130:
L_kvok_128:
v_lshlrev_b32 v45, 4, v0
s_lshl_b32 s33, s43, 12
s_lshl_b32 s31, s45, 7
s_lshl_b32 s32, s44, 4
s_add_u32 s31, s31, s32
s_lshl_b32 s31, s31, 10
s_add_u32 s31, s31, s33
s_add_u32 s31, s31, 0x15fc000
s_lshr_b32 s34, s43, 1
s_lshl_b32 s32, s45, 1
s_add_u32 s32, s32, s34
s_lshl_b32 s32, s32, 16
s_lshl_b32 s36, s44, 13
s_add_u32 s32, s32, s36
s_and_b32 s36, s33, 4096
s_add_u32 s32, s32, s36
s_add_u32 s32, s32, 0x19fe000
s_lshl_b32 s34, s34, 14
s_add_u32 s34, s34, s36
s_add_u32 m0, s33, 65536
s_nop 0
buffer_load_dwordx4 v45, s[12:15], s31 offen offset:0 sc1 lds
buffer_load_dwordx4 v45, s[12:15], s31 offen offset:1024 sc1 lds
buffer_load_dwordx4 v45, s[12:15], s31 offen offset:2048 sc1 lds
buffer_load_dwordx4 v45, s[12:15], s31 offen offset:3072 sc1 lds
s_add_u32 m0, s34, 98304
s_nop 0
buffer_load_dwordx4 v45, s[12:15], s32 offen offset:0 sc1 lds
buffer_load_dwordx4 v45, s[12:15], s32 offen offset:1024 sc1 lds
buffer_load_dwordx4 v45, s[12:15], s32 offen offset:2048 sc1 lds
buffer_load_dwordx4 v45, s[12:15], s32 offen offset:3072 sc1 lds
s_branch L_kvb_127
L_nw_132:
s_waitcnt vmcnt(2)
s_branch L_nwb_133
L_join_5:
ds_read_b128 v[164:167], v4
ds_read_b128 v[16:19], v2 offset:0
ds_read_b128 v[20:23], v2 offset:1024
ds_read_b128 v[24:27], v2 offset:2048
ds_read_b128 v[28:31], v2 offset:3072
ds_read_b128 v[32:35], v2 offset:4096
ds_read_b128 v[36:39], v2 offset:5120
ds_read_b128 v[40:43], v2 offset:6144
ds_read_b128 v[44:47], v2 offset:7168
ds_read_b128 v[48:51], v2 offset:8192
ds_read_b128 v[52:55], v2 offset:9216
ds_read_b128 v[56:59], v2 offset:10240
ds_read_b128 v[60:63], v2 offset:11264
ds_read_b128 v[64:67], v2 offset:12288
ds_read_b128 v[68:71], v2 offset:13312
ds_read_b128 v[72:75], v2 offset:14336
ds_read_b128 v[76:79], v2 offset:15360
ds_read_b128 v[88:91], v2 offset:16384
s_waitcnt lgkmcnt(15)
v_mfma_f32_16x16x32_bf16 v[92:95], v[16:19], v[164:167], 0
ds_read_b64_tr_b16 v[80:81], v3 offset:8192
buffer_store_dwordx4 v[244:247], v14, s[24:27], s42 offen sc1
v_mfma_f32_16x16x32_bf16 v[96:99], v[20:23], v[164:167], 0
ds_read_b64_tr_b16 v[84:85], v3 offset:24576
buffer_store_dwordx2 v[244:245], v15, s[24:27], s42 offen sc1
s_waitcnt lgkmcnt(15)
v_mfma_f32_16x16x32_bf16 v[100:103], v[24:27], v[164:167], 0
ds_read_b64_tr_b16 v[16:17], v3 offset:0
s_sub_u32 s42, s42, 147456
ds_read_b64_tr_b16 v[18:19], v3 offset:512
v_mfma_f32_16x16x32_bf16 v[104:107], v[28:31], v[164:167], 0
ds_read_b64_tr_b16 v[20:21], v3 offset:16384
buffer_store_dwordx4 v[240:243], v14, s[24:27], s42 offen sc1
s_waitcnt lgkmcnt(15)
v_mfma_f32_16x16x32_bf16 v[108:111], v[32:35], v[164:167], 0
ds_read_b64_tr_b16 v[22:23], v3 offset:16896
v_add_u32 v2, 1024, v2
v_mfma_f32_16x16x32_bf16 v[112:115], v[36:39], v[164:167], 0
ds_read_b64_tr_b16 v[24:25], v3 offset:1024
buffer_store_dwordx2 v[240:241], v15, s[24:27], s42 offen sc1
v_mfma_f32_16x16x32_bf16 v[116:119], v[40:43], v[164:167], 0
ds_read_b64_tr_b16 v[26:27], v3 offset:1536
s_sub_u32 s42, s42, 147456
ds_read_b64_tr_b16 v[28:29], v3 offset:17408
s_waitcnt lgkmcnt(15)
v_mfma_f32_16x16x32_bf16 v[120:123], v[44:47], v[164:167], 0
ds_read_b64_tr_b16 v[30:31], v3 offset:17920
ds_read_b64_tr_b16 v[32:33], v3 offset:2048
v_mfma_f32_16x16x32_bf16 v[124:127], v[48:51], v[164:167], 0
ds_read_b64_tr_b16 v[34:35], v3 offset:2560
ds_read_b64_tr_b16 v[36:37], v3 offset:18432
v_mfma_f32_16x16x32_bf16 v[128:131], v[52:55], v[164:167], 0
ds_read_b64_tr_b16 v[38:39], v3 offset:18944
ds_read_b64_tr_b16 v[40:41], v3 offset:3072
v_mfma_f32_16x16x32_bf16 v[132:135], v[56:59], v[164:167], 0
ds_read_b64_tr_b16 v[42:43], v3 offset:3584
ds_read_b64_tr_b16 v[44:45], v3 offset:19456
s_waitcnt lgkmcnt(15)
v_mfma_f32_16x16x32_bf16 v[136:139], v[60:63], v[164:167], 0
ds_read_b64_tr_b16 v[46:47], v3 offset:19968
ds_read_b64_tr_b16 v[48:49], v3 offset:4096
v_mfma_f32_16x16x32_bf16 v[140:143], v[64:67], v[164:167], 0
ds_read_b64_tr_b16 v[50:51], v3 offset:4608
ds_read_b64_tr_b16 v[52:53], v3 offset:20480
v_mfma_f32_16x16x32_bf16 v[144:147], v[68:71], v[164:167], 0
ds_read_b64_tr_b16 v[54:55], v3 offset:20992
ds_read_b64_tr_b16 v[56:57], v3 offset:5120
v_mfma_f32_16x16x32_bf16 v[148:151], v[72:75], v[164:167], 0
ds_read_b64_tr_b16 v[58:59], v3 offset:5632
ds_read_b64_tr_b16 v[60:61], v3 offset:21504
v_mfma_f32_16x16x32_bf16 v[152:155], v[76:79], v[164:167], 0
ds_read_b64_tr_b16 v[62:63], v3 offset:22016
ds_read_b64_tr_b16 v[64:65], v3 offset:6144
v_mfma_f32_16x16x32_bf16 v[156:159], v[88:91], v[164:167], 0
ds_read_b64_tr_b16 v[66:67], v3 offset:6656
ds_read_b64_tr_b16 v[68:69], v3 offset:22528
ds_read_b64_tr_b16 v[70:71], v3 offset:23040
ds_read_b64_tr_b16 v[72:73], v3 offset:7168
ds_read_b64_tr_b16 v[74:75], v3 offset:7680
ds_read_b64_tr_b16 v[76:77], v3 offset:23552
ds_read_b64_tr_b16 v[78:79], v3 offset:24064
ds_read_b128 v[164:167], v4 offset:1024
ds_read_b128 v[88:91], v2 offset:16384
s_cmp_lg_u32 s34, 0
s_cbranch_scc1 L_mk_134
L_mkb_135:
v_max3_f32 v5, v96, v97, v98
v_max3_f32 v6, v99, v100, v101
v_max3_f32 v186, v102, v103, v104
v_max3_f32 v187, v105, v106, v107
v_max3_f32 v5, v5, v108, v109
v_max3_f32 v6, v6, v110, v111
v_max3_f32 v186, v186, v112, v113
v_max3_f32 v187, v187, v114, v115
v_max3_f32 v5, v5, v116, v117
v_max3_f32 v6, v6, v118, v119
v_max3_f32 v186, v186, v120, v121
v_max3_f32 v187, v187, v122, v123
v_max3_f32 v5, v5, v124, v125
v_max3_f32 v6, v6, v126, v127
v_max3_f32 v186, v186, v128, v129
v_max3_f32 v187, v187, v130, v131
v_max3_f32 v5, v5, v132, v133
v_max3_f32 v6, v6, v134, v135
v_max3_f32 v186, v186, v136, v137
v_max3_f32 v187, v187, v138, v139
v_max3_f32 v5, v5, v140, v141
v_max3_f32 v6, v6, v142, v143
v_max3_f32 v186, v186, v144, v145
v_max3_f32 v187, v187, v146, v147
v_max3_f32 v5, v5, v148, v149
v_cndmask_b32 v92, v92, v156, s[96:97]
v_cndmask_b32 v93, v93, v157, s[98:99]
v_max3_f32 v6, v6, v150, v151
v_max3_f32 v186, v186, v152, v153
v_max3_f32 v187, v187, v154, v155
v_cndmask_b32 v94, v94, v158, s[100:101]
v_cndmask_b32 v95, v95, v159, s[32:33]
v_max3_f32 v5, v5, v92, v93
v_max3_f32 v6, v6, v94, v95
v_max3_f32 v5, v5, v186, v187
v_add_u32 v3, 512, v3
v_max_f32 v5, v5, v6
buffer_store_dwordx4 v[236:239], v14, s[24:27], s42 offen sc1
v_mov_b32 v6, v5
s_nop 1
v_permlane16_swap_b32 v5, v6
v_max_f32 v5, v5, v6
v_mov_b32 v6, v5
s_nop 1
v_permlane32_swap_b32 v5, v6
v_max_f32 v5, v5, v6
v_mul_f32 v186, v184, v5
v_sub_f32 v186, 0, v186
v_pk_fma_f32 v[92:93], v[92:93], v[184:185], v[186:187] op_sel_hi:[1,0,0]
v_pk_fma_f32 v[94:95], v[94:95], v[184:185], v[186:187] op_sel_hi:[1,0,0]
v_exp_f32 v92, v92
v_exp_f32 v93, v93
v_exp_f32 v94, v94
v_exp_f32 v95, v95
v_pk_fma_f32 v[96:97], v[96:97], v[184:185], v[186:187] op_sel_hi:[1,0,0]
v_pk_fma_f32 v[98:99], v[98:99], v[184:185], v[186:187] op_sel_hi:[1,0,0]
v_cndmask_b32 v156, 0, v92, s[96:97]
v_cndmask_b32 v157, 0, v93, s[98:99]
v_cndmask_b32 v158, 0, v94, s[100:101]
v_cndmask_b32 v159, 0, v95, s[32:33]
v_cndmask_b32 v92, v92, 0, s[96:97]
v_cndmask_b32 v93, v93, 0, s[98:99]
v_exp_f32 v96, v96
v_exp_f32 v97, v97
v_exp_f32 v98, v98
v_exp_f32 v99, v99
v_cvt_pk_bf16_f32 v160, v156, v157
v_cvt_pk_bf16_f32 v161, v158, v159
v_cndmask_b32 v94, v94, 0, s[100:101]
v_cndmask_b32 v95, v95, 0, s[32:33]
v_pk_fma_f32 v[100:101], v[100:101], v[184:185], v[186:187] op_sel_hi:[1,0,0]
v_mfma_f32_16x16x32_bf16 v[168:171], v[80:83], v[160:163], 0
ds_read_b64_tr_b16 v[80:81], v3 offset:8192
v_cvt_pk_bf16_f32 v92, v92, v93
v_mfma_f32_16x16x32_bf16 v[172:175], v[84:87], v[160:163], 0
ds_read_b64_tr_b16 v[84:85], v3 offset:24576
v_pk_fma_f32 v[102:103], v[102:103], v[184:185], v[186:187] op_sel_hi:[1,0,0]
v_mfma_f32_16x16x32_bf16 v[180:183], v[176:179], v[160:163], 0
v_cvt_pk_bf16_f32 v93, v94, v95
v_exp_f32 v100, v100
v_exp_f32 v101, v101
v_pk_fma_f32 v[104:105], v[104:105], v[184:185], v[186:187] op_sel_hi:[1,0,0]
v_pk_fma_f32 v[106:107], v[106:107], v[184:185], v[186:187] op_sel_hi:[1,0,0]
v_cvt_pk_bf16_f32 v94, v96, v97
v_cvt_pk_bf16_f32 v95, v98, v99
v_exp_f32 v102, v102
v_exp_f32 v103, v103
s_waitcnt lgkmcnt(15)
v_mfma_f32_16x16x32_bf16 v[168:171], v[16:19], v[92:95], v[168:171]
ds_read_b128 v[16:19], v2 offset:0
v_exp_f32 v104, v104
v_mfma_f32_16x16x32_bf16 v[172:175], v[20:23], v[92:95], v[172:175]
ds_read_b128 v[20:23], v2 offset:1024
v_exp_f32 v105, v105
v_mfma_f32_16x16x32_bf16 v[180:183], v[176:179], v[92:95], v[180:183]
ds_read_b64_tr_b16 v[192:193], v3 offset:0
v_exp_f32 v106, v106
ds_read_b64_tr_b16 v[194:195], v3 offset:512
v_exp_f32 v107, v107
ds_read_b64_tr_b16 v[196:197], v3 offset:1024
v_cvt_pk_bf16_f32 v100, v100, v101
ds_read_b64_tr_b16 v[198:199], v3 offset:1536
v_cvt_pk_bf16_f32 v101, v102, v103
v_cvt_pk_bf16_f32 v102, v104, v105
v_cvt_pk_bf16_f32 v103, v106, v107
v_pk_fma_f32 v[108:109], v[108:109], v[184:185], v[186:187] op_sel_hi:[1,0,0]
v_pk_fma_f32 v[110:111], v[110:111], v[184:185], v[186:187] op_sel_hi:[1,0,0]
v_exp_f32 v108, v108
v_mfma_f32_16x16x32_bf16 v[168:171], v[24:27], v[100:103], v[168:171]
ds_read_b128 v[24:27], v2 offset:2048
v_exp_f32 v109, v109
v_mfma_f32_16x16x32_bf16 v[172:175], v[28:31], v[100:103], v[172:175]
ds_read_b128 v[28:31], v2 offset:3072
v_pk_fma_f32 v[112:113], v[112:113], v[184:185], v[186:187] op_sel_hi:[1,0,0]
v_mfma_f32_16x16x32_bf16 v[180:183], v[176:179], v[100:103], v[180:183]
ds_read_b64_tr_b16 v[200:201], v3 offset:2048
v_pk_fma_f32 v[114:115], v[114:115], v[184:185], v[186:187] op_sel_hi:[1,0,0]
ds_read_b64_tr_b16 v[202:203], v3 offset:2560
v_exp_f32 v110, v110
ds_read_b64_tr_b16 v[204:205], v3 offset:3072
v_exp_f32 v111, v111
ds_read_b64_tr_b16 v[206:207], v3 offset:3584
buffer_store_dwordx2 v[236:237], v15, s[24:27], s42 offen sc1
v_exp_f32 v112, v112
v_exp_f32 v113, v113
v_exp_f32 v114, v114
v_exp_f32 v115, v115
s_sub_u32 s42, s42, 147456
v_pk_fma_f32 v[116:117], v[116:117], v[184:185], v[186:187] op_sel_hi:[1,0,0]
v_pk_fma_f32 v[118:119], v[118:119], v[184:185], v[186:187] op_sel_hi:[1,0,0]
v_cvt_pk_bf16_f32 v108, v108, v109
buffer_store_dwordx4 v[232:235], v14, s[24:27], s42 offen sc1
v_cvt_pk_bf16_f32 v109, v110, v111
buffer_store_dwordx2 v[232:233], v15, s[24:27], s42 offen sc1
v_exp_f32 v116, v116
v_exp_f32 v117, v117
v_exp_f32 v118, v118
v_exp_f32 v119, v119
v_pk_fma_f32 v[120:121], v[120:121], v[184:185], v[186:187] op_sel_hi:[1,0,0]
v_pk_fma_f32 v[122:123], v[122:123], v[184:185], v[186:187] op_sel_hi:[1,0,0]
v_cvt_pk_bf16_f32 v110, v112, v113
v_cvt_pk_bf16_f32 v111, v114, v115
s_sub_u32 s42, s42, 147456
s_nop 0
v_mfma_f32_16x16x32_bf16 v[168:171], v[32:35], v[108:111], v[168:171]
ds_read_b128 v[32:35], v2 offset:4096
v_exp_f32 v120, v120
v_mfma_f32_16x16x32_bf16 v[172:175], v[36:39], v[108:111], v[172:175]
ds_read_b128 v[36:39], v2 offset:5120
v_exp_f32 v121, v121
v_mfma_f32_16x16x32_bf16 v[180:183], v[176:179], v[108:111], v[180:183]
ds_read_b64_tr_b16 v[208:209], v3 offset:4096
v_exp_f32 v122, v122
ds_read_b64_tr_b16 v[210:211], v3 offset:4608
v_exp_f32 v123, v123
ds_read_b64_tr_b16 v[212:213], v3 offset:5120
v_pk_fma_f32 v[124:125], v[124:125], v[184:185], v[186:187] op_sel_hi:[1,0,0]
ds_read_b64_tr_b16 v[214:215], v3 offset:5632
v_cvt_pk_bf16_f32 v116, v116, v117
v_pk_fma_f32 v[126:127], v[126:127], v[184:185], v[186:187] op_sel_hi:[1,0,0]
v_cvt_pk_bf16_f32 v117, v118, v119
v_exp_f32 v124, v124
v_exp_f32 v125, v125
v_pk_fma_f32 v[128:129], v[128:129], v[184:185], v[186:187] op_sel_hi:[1,0,0]
v_pk_fma_f32 v[130:131], v[130:131], v[184:185], v[186:187] op_sel_hi:[1,0,0]
v_cvt_pk_bf16_f32 v118, v120, v121
v_cvt_pk_bf16_f32 v119, v122, v123
v_exp_f32 v126, v126
v_exp_f32 v127, v127
v_mfma_f32_16x16x32_bf16 v[168:171], v[40:43], v[116:119], v[168:171]
ds_read_b128 v[40:43], v2 offset:6144
v_exp_f32 v128, v128
v_mfma_f32_16x16x32_bf16 v[172:175], v[44:47], v[116:119], v[172:175]
ds_read_b128 v[44:47], v2 offset:7168
v_exp_f32 v129, v129
v_mfma_f32_16x16x32_bf16 v[180:183], v[176:179], v[116:119], v[180:183]
ds_read_b64_tr_b16 v[216:217], v3 offset:6144
v_exp_f32 v130, v130
ds_read_b64_tr_b16 v[218:219], v3 offset:6656
v_exp_f32 v131, v131
ds_read_b64_tr_b16 v[220:221], v3 offset:7168
v_cvt_pk_bf16_f32 v124, v124, v125
ds_read_b64_tr_b16 v[222:223], v3 offset:7680
v_cvt_pk_bf16_f32 v125, v126, v127
v_cvt_pk_bf16_f32 v126, v128, v129
v_cvt_pk_bf16_f32 v127, v130, v131
buffer_store_dwordx4 v[228:231], v14, s[24:27], s42 offen sc1
v_pk_fma_f32 v[132:133], v[132:133], v[184:185], v[186:187] op_sel_hi:[1,0,0]
buffer_store_dwordx2 v[228:229], v15, s[24:27], s42 offen sc1
v_mfma_f32_16x16x32_bf16 v[168:171], v[48:51], v[124:127], v[168:171]
ds_read_b128 v[48:51], v2 offset:8192
v_pk_fma_f32 v[134:135], v[134:135], v[184:185], v[186:187] op_sel_hi:[1,0,0]
v_mfma_f32_16x16x32_bf16 v[172:175], v[52:55], v[124:127], v[172:175]
ds_read_b128 v[52:55], v2 offset:9216
v_exp_f32 v132, v132
v_mfma_f32_16x16x32_bf16 v[180:183], v[176:179], v[124:127], v[180:183]
v_exp_f32 v133, v133
s_sub_u32 s42, s42, 147456
v_pk_fma_f32 v[136:137], v[136:137], v[184:185], v[186:187] op_sel_hi:[1,0,0]
v_pk_fma_f32 v[138:139], v[138:139], v[184:185], v[186:187] op_sel_hi:[1,0,0]
v_exp_f32 v134, v134
v_exp_f32 v135, v135
buffer_store_dwordx4 v[224:227], v14, s[24:27], s42 offen sc1
buffer_store_dwordx2 v[224:225], v15, s[24:27], s42 offen sc1
ds_read_b64_tr_b16 v[224:225], v3 offset:16384
v_exp_f32 v136, v136
ds_read_b64_tr_b16 v[226:227], v3 offset:16896
v_exp_f32 v137, v137
ds_read_b64_tr_b16 v[228:229], v3 offset:17408
v_exp_f32 v138, v138
ds_read_b64_tr_b16 v[230:231], v3 offset:17920
v_exp_f32 v139, v139
v_pk_fma_f32 v[140:141], v[140:141], v[184:185], v[186:187] op_sel_hi:[1,0,0]
v_pk_fma_f32 v[142:143], v[142:143], v[184:185], v[186:187] op_sel_hi:[1,0,0]
v_cvt_pk_bf16_f32 v132, v132, v133
v_cvt_pk_bf16_f32 v133, v134, v135
v_exp_f32 v140, v140
v_exp_f32 v141, v141
v_exp_f32 v142, v142
v_exp_f32 v143, v143
v_pk_fma_f32 v[144:145], v[144:145], v[184:185], v[186:187] op_sel_hi:[1,0,0]
v_pk_fma_f32 v[146:147], v[146:147], v[184:185], v[186:187] op_sel_hi:[1,0,0]
v_cvt_pk_bf16_f32 v134, v136, v137
v_cvt_pk_bf16_f32 v135, v138, v139
s_sub_u32 s42, s42, 147456
s_nop 0
v_mfma_f32_16x16x32_bf16 v[180:183], v[176:179], v[132:135], v[180:183]
v_pk_fma_f32 v[148:149], v[148:149], v[184:185], v[186:187] op_sel_hi:[1,0,0]
v_exp_f32 v144, v144
s_waitcnt lgkmcnt(15)
v_mfma_f32_16x16x32_bf16 v[168:171], v[56:59], v[132:135], v[168:171]
ds_read_b128 v[56:59], v2 offset:10240
v_exp_f32 v145, v145
v_mfma_f32_16x16x32_bf16 v[172:175], v[60:63], v[132:135], v[172:175]
ds_read_b128 v[60:63], v2 offset:11264
v_exp_f32 v146, v146
ds_read_b64_tr_b16 v[232:233], v3 offset:18432
v_exp_f32 v147, v147
ds_read_b64_tr_b16 v[234:235], v3 offset:18944
v_pk_fma_f32 v[150:151], v[150:151], v[184:185], v[186:187] op_sel_hi:[1,0,0]
ds_read_b64_tr_b16 v[236:237], v3 offset:19456
v_cvt_pk_bf16_f32 v140, v140, v141
ds_read_b64_tr_b16 v[238:239], v3 offset:19968
v_exp_f32 v148, v148
v_exp_f32 v149, v149
v_pk_fma_f32 v[152:153], v[152:153], v[184:185], v[186:187] op_sel_hi:[1,0,0]
v_pk_fma_f32 v[154:155], v[154:155], v[184:185], v[186:187] op_sel_hi:[1,0,0]
v_cvt_pk_bf16_f32 v141, v142, v143
v_exp_f32 v150, v150
v_exp_f32 v151, v151
v_cvt_pk_bf16_f32 v142, v144, v145
v_cvt_pk_bf16_f32 v143, v146, v147
v_exp_f32 v152, v152
v_exp_f32 v153, v153
v_mfma_f32_16x16x32_bf16 v[180:183], v[176:179], v[140:143], v[180:183]
v_exp_f32 v154, v154
v_mfma_f32_16x16x32_bf16 v[168:171], v[64:67], v[140:143], v[168:171]
ds_read_b128 v[64:67], v2 offset:12288
v_exp_f32 v155, v155
v_mfma_f32_16x16x32_bf16 v[172:175], v[68:71], v[140:143], v[172:175]
ds_read_b128 v[68:71], v2 offset:13312
v_cvt_pk_bf16_f32 v148, v148, v149
ds_read_b64_tr_b16 v[240:241], v3 offset:20480
v_cvt_pk_bf16_f32 v149, v150, v151
ds_read_b64_tr_b16 v[242:243], v3 offset:20992
v_cvt_pk_bf16_f32 v150, v152, v153
ds_read_b64_tr_b16 v[244:245], v3 offset:21504
v_cvt_pk_bf16_f32 v151, v154, v155
ds_read_b64_tr_b16 v[246:247], v3 offset:22016
s_nop 0
v_mfma_f32_16x16x32_bf16 v[180:183], v[176:179], v[148:151], v[180:183]
v_mfma_f32_16x16x32_bf16 v[168:171], v[72:75], v[148:151], v[168:171]
ds_read_b128 v[72:75], v2 offset:14336
v_mfma_f32_16x16x32_bf16 v[172:175], v[76:79], v[148:151], v[172:175]
ds_read_b128 v[76:79], v2 offset:15360
ds_read_b64_tr_b16 v[248:249], v3 offset:22528
s_nop 2
v_rcp_f32 v186, v180
ds_read_b64_tr_b16 v[250:251], v3 offset:23040
ds_read_b64_tr_b16 v[252:253], v3 offset:23552
v_pk_mul_f32 v[168:169], v[168:169], v[186:187] op_sel_hi:[1,0]
ds_read_b64_tr_b16 v[254:255], v3 offset:24064
v_pk_mul_f32 v[170:171], v[170:171], v[186:187] op_sel_hi:[1,0]
v_cvt_pk_bf16_f32 v156, v168, v169
v_pk_mul_f32 v[172:173], v[172:173], v[186:187] op_sel_hi:[1,0]
v_pk_mul_f32 v[174:175], v[174:175], v[186:187] op_sel_hi:[1,0]
v_cvt_pk_bf16_f32 v157, v170, v171
v_cvt_pk_bf16_f32 v158, v172, v173
v_cvt_pk_bf16_f32 v159, v174, v175
s_waitcnt lgkmcnt(0)
s_waitcnt vmcnt(0)
s_barrier
s_cmp_lg_u32 s43, 0
s_cbranch_scc1 L_wf_137
s_lshl_b32 s93, s44, 12
s_lshl_b32 s94, s45, 7
s_add_u32 s93, s93, s94
s_add_u32 s93, s93, 0x2f78000
v_mov_b32 v6, s86
buffer_store_dword v6, off, s[24:27], s93 sc1
L_wf_137:
buffer_store_dwordx4 v[156:159], v7, s[24:27], s35 offen sc1
s_add_u32 s35, s35, 147456
v_mfma_f32_16x16x32_bf16 v[92:95], v[16:19], v[164:167], 0
v_add_u32 v2, 1024, v2
v_mfma_f32_16x16x32_bf16 v[96:99], v[20:23], v[164:167], 0
v_mfma_f32_16x16x32_bf16 v[100:103], v[24:27], v[164:167], 0
v_mfma_f32_16x16x32_bf16 v[104:107], v[28:31], v[164:167], 0
v_mfma_f32_16x16x32_bf16 v[108:111], v[32:35], v[164:167], 0
v_mfma_f32_16x16x32_bf16 v[112:115], v[36:39], v[164:167], 0
v_mfma_f32_16x16x32_bf16 v[116:119], v[40:43], v[164:167], 0
v_mfma_f32_16x16x32_bf16 v[120:123], v[44:47], v[164:167], 0
v_mfma_f32_16x16x32_bf16 v[124:127], v[48:51], v[164:167], 0
v_mfma_f32_16x16x32_bf16 v[128:131], v[52:55], v[164:167], 0
v_mfma_f32_16x16x32_bf16 v[132:135], v[56:59], v[164:167], 0
v_mfma_f32_16x16x32_bf16 v[136:139], v[60:63], v[164:167], 0
v_mfma_f32_16x16x32_bf16 v[140:143], v[64:67], v[164:167], 0
v_mfma_f32_16x16x32_bf16 v[144:147], v[68:71], v[164:167], 0
v_mfma_f32_16x16x32_bf16 v[148:151], v[72:75], v[164:167], 0
v_mfma_f32_16x16x32_bf16 v[152:155], v[76:79], v[164:167], 0
v_mfma_f32_16x16x32_bf16 v[156:159], v[88:91], v[164:167], 0
s_cmp_lg_u32 s34, 0
s_cbranch_scc1 L_mk_138
L_mkb_139:
v_max3_f32 v5, v96, v97, v98
v_max3_f32 v6, v99, v100, v101
v_max3_f32 v186, v102, v103, v104
v_max3_f32 v187, v105, v106, v107
v_max3_f32 v5, v5, v108, v109
v_max3_f32 v6, v6, v110, v111
v_max3_f32 v186, v186, v112, v113
v_max3_f32 v187, v187, v114, v115
v_max3_f32 v5, v5, v116, v117
v_max3_f32 v6, v6, v118, v119
v_max3_f32 v186, v186, v120, v121
v_max3_f32 v187, v187, v122, v123
v_max3_f32 v5, v5, v124, v125
v_max3_f32 v6, v6, v126, v127
v_max3_f32 v186, v186, v128, v129
v_max3_f32 v187, v187, v130, v131
v_max3_f32 v5, v5, v132, v133
v_max3_f32 v6, v6, v134, v135
v_max3_f32 v186, v186, v136, v137
v_max3_f32 v187, v187, v138, v139
v_max3_f32 v5, v5, v140, v141
v_max3_f32 v6, v6, v142, v143
v_max3_f32 v186, v186, v144, v145
v_max3_f32 v187, v187, v146, v147
v_max3_f32 v5, v5, v148, v149
v_cndmask_b32 v92, v92, v156, s[96:97]
v_cndmask_b32 v93, v93, v157, s[98:99]
v_max3_f32 v6, v6, v150, v151
v_max3_f32 v186, v186, v152, v153
v_max3_f32 v187, v187, v154, v155
v_cndmask_b32 v94, v94, v158, s[100:101]
v_cndmask_b32 v95, v95, v159, s[32:33]
v_max3_f32 v5, v5, v92, v93
v_max3_f32 v6, v6, v94, v95
v_max3_f32 v5, v5, v186, v187
v_add_u32 v3, 512, v3
v_max_f32 v5, v5, v6
v_mov_b32 v6, v5
s_nop 1
v_permlane16_swap_b32 v5, v6
v_max_f32 v5, v5, v6
v_mov_b32 v6, v5
s_nop 1
v_permlane32_swap_b32 v5, v6
v_max_f32 v5, v5, v6
v_mul_f32 v186, v184, v5
v_sub_f32 v186, 0, v186
s_mov_b32 s23, s2
s_lshr_b32 s36, s43, 2
s_xor_b32 s36, s36, 1
s_cmp_eq_u32 s36, 0
s_cbranch_scc1 L_w2_141
L_w2b_142:
s_cmp_eq_u32 s36, 0
s_cbranch_scc1 L_hl_143
L_hlb_144:
v_pk_fma_f32 v[92:93], v[92:93], v[184:185], v[186:187] op_sel_hi:[1,0,0]
v_pk_fma_f32 v[94:95], v[94:95], v[184:185], v[186:187] op_sel_hi:[1,0,0]
v_exp_f32 v92, v92
v_exp_f32 v93, v93
v_exp_f32 v94, v94
v_exp_f32 v95, v95
v_pk_fma_f32 v[96:97], v[96:97], v[184:185], v[186:187] op_sel_hi:[1,0,0]
v_pk_fma_f32 v[98:99], v[98:99], v[184:185], v[186:187] op_sel_hi:[1,0,0]
v_cndmask_b32 v156, 0, v92, s[96:97]
v_cndmask_b32 v157, 0, v93, s[98:99]
v_cndmask_b32 v158, 0, v94, s[100:101]
v_cndmask_b32 v159, 0, v95, s[32:33]
v_pk_fma_f32 v[100:101], v[100:101], v[184:185], v[186:187] op_sel_hi:[1,0,0]
v_cndmask_b32 v92, v92, 0, s[96:97]
v_cndmask_b32 v93, v93, 0, s[98:99]
v_exp_f32 v96, v96
v_exp_f32 v97, v97
v_exp_f32 v98, v98
v_exp_f32 v99, v99
v_cvt_pk_bf16_f32 v160, v156, v157
v_cvt_pk_bf16_f32 v161, v158, v159
v_pk_fma_f32 v[102:103], v[102:103], v[184:185], v[186:187] op_sel_hi:[1,0,0]
v_cndmask_b32 v94, v94, 0, s[100:101]
v_cndmask_b32 v95, v95, 0, s[32:33]
v_mfma_f32_16x16x32_bf16 v[168:171], v[80:83], v[160:163], 0
v_cvt_pk_bf16_f32 v92, v92, v93
v_exp_f32 v100, v100
v_mfma_f32_16x16x32_bf16 v[172:175], v[84:87], v[160:163], 0
v_exp_f32 v101, v101
v_mfma_f32_16x16x32_bf16 v[180:183], v[176:179], v[160:163], 0
v_pk_fma_f32 v[104:105], v[104:105], v[184:185], v[186:187] op_sel_hi:[1,0,0]
v_pk_fma_f32 v[106:107], v[106:107], v[184:185], v[186:187] op_sel_hi:[1,0,0]
v_cvt_pk_bf16_f32 v93, v94, v95
v_exp_f32 v102, v102
v_exp_f32 v103, v103
v_pk_fma_f32 v[108:109], v[108:109], v[184:185], v[186:187] op_sel_hi:[1,0,0]
v_cvt_pk_bf16_f32 v94, v96, v97
v_cvt_pk_bf16_f32 v95, v98, v99
v_exp_f32 v104, v104
v_exp_f32 v105, v105
v_mfma_f32_16x16x32_bf16 v[168:171], v[192:195], v[92:95], v[168:171]
v_exp_f32 v106, v106
v_mfma_f32_16x16x32_bf16 v[172:175], v[224:227], v[92:95], v[172:175]
v_exp_f32 v107, v107
v_mfma_f32_16x16x32_bf16 v[180:183], v[176:179], v[92:95], v[180:183]
v_pk_fma_f32 v[110:111], v[110:111], v[184:185], v[186:187] op_sel_hi:[1,0,0]
v_cvt_pk_bf16_f32 v100, v100, v101
v_exp_f32 v108, v108
v_exp_f32 v109, v109
v_pk_fma_f32 v[112:113], v[112:113], v[184:185], v[186:187] op_sel_hi:[1,0,0]
v_pk_fma_f32 v[114:115], v[114:115], v[184:185], v[186:187] op_sel_hi:[1,0,0]
v_cvt_pk_bf16_f32 v101, v102, v103
v_exp_f32 v110, v110
v_exp_f32 v111, v111
v_cvt_pk_bf16_f32 v102, v104, v105
v_cvt_pk_bf16_f32 v103, v106, v107
v_exp_f32 v112, v112
v_exp_f32 v113, v113
v_mfma_f32_16x16x32_bf16 v[168:171], v[196:199], v[100:103], v[168:171]
v_exp_f32 v114, v114
v_mfma_f32_16x16x32_bf16 v[172:175], v[228:231], v[100:103], v[172:175]
v_exp_f32 v115, v115
v_mfma_f32_16x16x32_bf16 v[180:183], v[176:179], v[100:103], v[180:183]
v_pk_fma_f32 v[116:117], v[116:117], v[184:185], v[186:187] op_sel_hi:[1,0,0]
v_pk_fma_f32 v[118:119], v[118:119], v[184:185], v[186:187] op_sel_hi:[1,0,0]
v_cvt_pk_bf16_f32 v108, v108, v109
v_cvt_pk_bf16_f32 v109, v110, v111
v_exp_f32 v116, v116
v_exp_f32 v117, v117
v_exp_f32 v118, v118
v_exp_f32 v119, v119
v_pk_fma_f32 v[120:121], v[120:121], v[184:185], v[186:187] op_sel_hi:[1,0,0]
v_pk_fma_f32 v[122:123], v[122:123], v[184:185], v[186:187] op_sel_hi:[1,0,0]
v_cvt_pk_bf16_f32 v110, v112, v113
v_cvt_pk_bf16_f32 v111, v114, v115
s_nop 1
v_mfma_f32_16x16x32_bf16 v[168:171], v[200:203], v[108:111], v[168:171]
v_pk_fma_f32 v[124:125], v[124:125], v[184:185], v[186:187] op_sel_hi:[1,0,0]
v_exp_f32 v120, v120
v_mfma_f32_16x16x32_bf16 v[172:175], v[232:235], v[108:111], v[172:175]
v_exp_f32 v121, v121
v_mfma_f32_16x16x32_bf16 v[180:183], v[176:179], v[108:111], v[180:183]
v_exp_f32 v122, v122
v_exp_f32 v123, v123
v_pk_fma_f32 v[126:127], v[126:127], v[184:185], v[186:187] op_sel_hi:[1,0,0]
v_cvt_pk_bf16_f32 v116, v116, v117
v_exp_f32 v124, v124
v_exp_f32 v125, v125
v_pk_fma_f32 v[128:129], v[128:129], v[184:185], v[186:187] op_sel_hi:[1,0,0]
v_pk_fma_f32 v[130:131], v[130:131], v[184:185], v[186:187] op_sel_hi:[1,0,0]
v_cvt_pk_bf16_f32 v117, v118, v119
v_exp_f32 v126, v126
v_exp_f32 v127, v127
v_pk_fma_f32 v[132:133], v[132:133], v[184:185], v[186:187] op_sel_hi:[1,0,0]
v_cvt_pk_bf16_f32 v118, v120, v121
v_cvt_pk_bf16_f32 v119, v122, v123
v_exp_f32 v128, v128
v_exp_f32 v129, v129
v_mfma_f32_16x16x32_bf16 v[168:171], v[204:207], v[116:119], v[168:171]
v_exp_f32 v130, v130
v_mfma_f32_16x16x32_bf16 v[172:175], v[236:239], v[116:119], v[172:175]
v_exp_f32 v131, v131
v_mfma_f32_16x16x32_bf16 v[180:183], v[176:179], v[116:119], v[180:183]
v_pk_fma_f32 v[134:135], v[134:135], v[184:185], v[186:187] op_sel_hi:[1,0,0]
v_cvt_pk_bf16_f32 v124, v124, v125
v_exp_f32 v132, v132
v_exp_f32 v133, v133
v_pk_fma_f32 v[136:137], v[136:137], v[184:185], v[186:187] op_sel_hi:[1,0,0]
v_pk_fma_f32 v[138:139], v[138:139], v[184:185], v[186:187] op_sel_hi:[1,0,0]
v_cvt_pk_bf16_f32 v125, v126, v127
v_exp_f32 v134, v134
v_exp_f32 v135, v135
v_cvt_pk_bf16_f32 v126, v128, v129
v_cvt_pk_bf16_f32 v127, v130, v131
v_exp_f32 v136, v136
v_exp_f32 v137, v137
v_mfma_f32_16x16x32_bf16 v[168:171], v[208:211], v[124:127], v[168:171]
v_exp_f32 v138, v138
v_mfma_f32_16x16x32_bf16 v[172:175], v[240:243], v[124:127], v[172:175]
v_exp_f32 v139, v139
v_mfma_f32_16x16x32_bf16 v[180:183], v[176:179], v[124:127], v[180:183]
v_pk_fma_f32 v[140:141], v[140:141], v[184:185], v[186:187] op_sel_hi:[1,0,0]
v_pk_fma_f32 v[142:143], v[142:143], v[184:185], v[186:187] op_sel_hi:[1,0,0]
v_cvt_pk_bf16_f32 v132, v132, v133
v_cvt_pk_bf16_f32 v133, v134, v135
v_exp_f32 v140, v140
v_exp_f32 v141, v141
v_exp_f32 v142, v142
v_exp_f32 v143, v143
v_pk_fma_f32 v[144:145], v[144:145], v[184:185], v[186:187] op_sel_hi:[1,0,0]
v_pk_fma_f32 v[146:147], v[146:147], v[184:185], v[186:187] op_sel_hi:[1,0,0]
v_cvt_pk_bf16_f32 v134, v136, v137
v_cvt_pk_bf16_f32 v135, v138, v139
s_cmp_eq_u32 s36, 0
s_cbranch_scc1 L_hp_145
L_hpb_146:
v_mfma_f32_16x16x32_bf16 v[180:183], v[176:179], v[132:135], v[180:183]
v_pk_fma_f32 v[148:149], v[148:149], v[184:185], v[186:187] op_sel_hi:[1,0,0]
v_exp_f32 v144, v144
v_mfma_f32_16x16x32_bf16 v[168:171], v[212:215], v[132:135], v[168:171]
v_exp_f32 v145, v145
v_mfma_f32_16x16x32_bf16 v[172:175], v[244:247], v[132:135], v[172:175]
v_exp_f32 v146, v146
v_exp_f32 v147, v147
v_pk_fma_f32 v[150:151], v[150:151], v[184:185], v[186:187] op_sel_hi:[1,0,0]
v_cvt_pk_bf16_f32 v140, v140, v141
v_exp_f32 v148, v148
v_exp_f32 v149, v149
v_pk_fma_f32 v[152:153], v[152:153], v[184:185], v[186:187] op_sel_hi:[1,0,0]
v_pk_fma_f32 v[154:155], v[154:155], v[184:185], v[186:187] op_sel_hi:[1,0,0]
v_cvt_pk_bf16_f32 v141, v142, v143
v_exp_f32 v150, v150
v_exp_f32 v151, v151
v_cvt_pk_bf16_f32 v142, v144, v145
v_cvt_pk_bf16_f32 v143, v146, v147
v_exp_f32 v152, v152
v_exp_f32 v153, v153
v_mfma_f32_16x16x32_bf16 v[180:183], v[176:179], v[140:143], v[180:183]
v_exp_f32 v154, v154
v_mfma_f32_16x16x32_bf16 v[168:171], v[216:219], v[140:143], v[168:171]
v_exp_f32 v155, v155
v_mfma_f32_16x16x32_bf16 v[172:175], v[248:251], v[140:143], v[172:175]
v_cvt_pk_bf16_f32 v148, v148, v149
v_cvt_pk_bf16_f32 v149, v150, v151
v_cvt_pk_bf16_f32 v150, v152, v153
v_cvt_pk_bf16_f32 v151, v154, v155
s_setprio 0
s_nop 0
v_mfma_f32_16x16x32_bf16 v[180:183], v[176:179], v[148:151], v[180:183]
v_mfma_f32_16x16x32_bf16 v[168:171], v[220:223], v[148:151], v[168:171]
v_mfma_f32_16x16x32_bf16 v[172:175], v[252:255], v[148:151], v[172:175]
s_nop 5
v_rcp_f32 v186, v180
s_nop 0
v_pk_mul_f32 v[168:169], v[168:169], v[186:187] op_sel_hi:[1,0]
v_pk_mul_f32 v[170:171], v[170:171], v[186:187] op_sel_hi:[1,0]
v_cvt_pk_bf16_f32 v156, v168, v169
v_cvt_pk_bf16_f32 v157, v170, v171
v_pk_mul_f32 v[172:173], v[172:173], v[186:187] op_sel_hi:[1,0]
v_pk_mul_f32 v[174:175], v[174:175], v[186:187] op_sel_hi:[1,0]
v_cvt_pk_bf16_f32 v158, v172, v173
v_cvt_pk_bf16_f32 v159, v174, v175
s_cmp_eq_u32 s36, 0
s_cbranch_scc1 L_hg_149
L_hgb_150:
buffer_store_dwordx4 v[156:159], v7, s[24:27], s35 offen sc1
s_add_u32 s35, s35, 147456
s_cmp_ge_u32 s43, 4
s_cbranch_scc1 L_ld_154
s_and_b32 s93, s23, 7
s_lshr_b32 s94, s23, 3
s_and_b32 s22, s93, 1
s_lshr_b32 s20, s93, 1
s_lshl_b32 s20, s20, 2
s_and_b32 s93, s94, 3
s_add_u32 s20, s20, s93
s_lshr_b32 s21, s94, 2
s_lshr_b32 s93, s43, 1
s_lshl_b32 s94, s93, 13
v_lshlrev_b32 v12, 4, v0
s_lshl_b32 s41, s22, 12
s_add_u32 s94, s94, s41
v_add_u32 v2, s94, v12
v_xor_b32 v1, 4096, v2
v_lshrrev_b32 v8, 2, v0
v_and_b32 v9, 7, v8
v_lshlrev_b32 v9, 1, v9
v_bfe_u32 v10, v0, 1, 1
v_xor_b32 v9, v9, v10
v_lshlrev_b32 v8, 8, v8
v_and_b32 v10, 1, v0
v_lshl_add_u32 v8, v10, 3, v8
v_add_u32 v8, 16384, v8
s_and_b32 s94, s43, 1
s_lshl_b32 s94, s94, 3
s_add_u32 s41, s94, 0
v_xor_b32 v10, s41, v9
v_lshl_add_u32 v4, v10, 4, v8
s_add_u32 s41, s94, 2
v_xor_b32 v10, s41, v9
v_lshl_add_u32 v5, v10, 4, v8
s_add_u32 s41, s94, 4
v_xor_b32 v10, s41, v9
v_lshl_add_u32 v6, v10, 4, v8
s_add_u32 s41, s94, 6
v_xor_b32 v10, s41, v9
v_lshl_add_u32 v7, v10, 4, v8
s_mov_b32 s29, 0
s_mov_b32 s31, 2
s_waitcnt lgkmcnt(0)
s_barrier
ds_read_b128 v[16:19], v1 offset:0
ds_read_b64_tr_b16 v[48:49], v4 offset:0
ds_read_b64_tr_b16 v[50:51], v4 offset:4096
ds_read_b128 v[20:23], v1 offset:1024
ds_read_b64_tr_b16 v[52:53], v4 offset:8192
ds_read_b64_tr_b16 v[54:55], v4 offset:12288
ds_read_b64_tr_b16 v[60:61], v5 offset:8192
ds_read_b64_tr_b16 v[62:63], v5 offset:12288
ds_read_b64_tr_b16 v[56:57], v5 offset:0
ds_read_b64_tr_b16 v[58:59], v5 offset:4096
ds_read_b64_tr_b16 v[64:65], v6 offset:0
ds_read_b64_tr_b16 v[66:67], v6 offset:4096
ds_read_b64_tr_b16 v[68:69], v6 offset:8192
ds_read_b64_tr_b16 v[70:71], v6 offset:12288
ds_read_b64_tr_b16 v[76:77], v7 offset:8192
ds_read_b64_tr_b16 v[78:79], v7 offset:12288
ds_read_b64_tr_b16 v[72:73], v7 offset:0
ds_read_b64_tr_b16 v[74:75], v7 offset:4096
ds_read_b128 v[24:27], v1 offset:2048
ds_read_b128 v[28:31], v1 offset:3072
ds_read_b128 v[32:35], v2 offset:0
ds_read_b128 v[36:39], v2 offset:1024
ds_read_b128 v[40:43], v2 offset:2048
ds_read_b128 v[44:47], v2 offset:3072
s_add_u32 s39, s29, 32768
s_cmp_eq_u32 s29, 32768
s_cmov_b32 s39, 131072
s_cmp_eq_u32 s29, 131072
s_cmov_b32 s39, 65536
s_cmp_eq_u32 s29, 98304
s_cmov_b32 s39, 0
s_sub_u32 s30, s39, s29
s_mov_b32 s29, s39
v_add_u32 v1, s30, v1
v_add_u32 v2, s30, v2
v_add_u32 v4, s30, v4
v_add_u32 v5, s30, v5
v_add_u32 v6, s30, v6
v_add_u32 v7, s30, v7
v_and_b32 v15, 15, v0
v_lshlrev_b32 v3, 11, v15
v_bfe_u32 v15, v0, 4, 1
v_lshl_add_u32 v3, v15, 5, v3
v_lshrrev_b32 v15, 5, v0
v_lshl_add_u32 v3, v15, 4, v3
s_lshl_b32 s93, s93, 6
s_lshl_b32 s32, s20, 7
s_add_u32 s32, s32, s93
s_lshl_b32 s93, s22, 5
s_add_u32 s32, s32, s93
s_lshl_b32 s32, s32, 11
s_lshl_b32 s93, s21, 8
s_lshl_b32 s94, s94, 4
s_add_u32 s32, s32, s93
s_add_u32 s32, s32, s94
s_mov_b32 s8, s4
s_mov_b32 s9, s5
s_mov_b32 s10, 0x400000
s_mov_b32 s11, 0x20000
s_mov_b32 s12, s54
s_mov_b32 s13, s55
s_mov_b32 s14, 0x400000
s_mov_b32 s15, 0x20000
s_lshl_b32 s93, s20, 3
s_add_u32 s93, s93, s21
s_lshl_b32 s93, s93, 3
s_add_u32 s93, s93, s43
s_lshl_b32 s94, s22, 2
s_add_u32 s34, s93, s94
s_xor_b32 s35, s34, 4
s_lshl_b32 s36, s34, 13
s_add_u32 s36, s36, 0x2200000
s_lshl_b32 s37, s35, 13
s_add_u32 s37, s37, 0x2200000
s_lshl_b32 s34, s34, 7
s_add_u32 s34, s34, 0x2f88000
s_lshl_b32 s35, s35, 7
s_add_u32 s35, s35, 0x2f88000
s_add_u32 s38, s32, 32768
s_waitcnt vmcnt(0)
s_waitcnt lgkmcnt(0)
s_barrier
v_mfma_f32_16x16x32_bf16 v[144:147], v[48:51], v[16:19], 0
ds_read_b128 v[80:83], v1 offset:0
v_mfma_f32_16x16x32_bf16 v[144:147], v[52:55], v[20:23], v[144:147]
ds_read_b64_tr_b16 v[112:113], v4 offset:0
v_mfma_f32_16x16x32_bf16 v[148:151], v[60:63], v[20:23], 0
ds_read_b64_tr_b16 v[114:115], v4 offset:4096
v_mfma_f32_16x16x32_bf16 v[148:151], v[56:59], v[16:19], v[148:151]
ds_read_b128 v[84:87], v1 offset:1024
v_mfma_f32_16x16x32_bf16 v[152:155], v[64:67], v[16:19], 0
ds_read_b64_tr_b16 v[116:117], v4 offset:8192
v_mfma_f32_16x16x32_bf16 v[152:155], v[68:71], v[20:23], v[152:155]
ds_read_b64_tr_b16 v[118:119], v4 offset:12288
v_mfma_f32_16x16x32_bf16 v[156:159], v[76:79], v[20:23], 0
ds_read_b64_tr_b16 v[124:125], v5 offset:8192
v_mfma_f32_16x16x32_bf16 v[156:159], v[72:75], v[16:19], v[156:159]
ds_read_b64_tr_b16 v[126:127], v5 offset:12288
v_mfma_f32_16x16x32_bf16 v[172:175], v[72:75], v[24:27], 0
v_mfma_f32_16x16x32_bf16 v[172:175], v[76:79], v[28:31], v[172:175]
ds_read_b64_tr_b16 v[120:121], v5 offset:0
v_mfma_f32_16x16x32_bf16 v[168:171], v[68:71], v[28:31], 0
ds_read_b64_tr_b16 v[122:123], v5 offset:4096
v_mfma_f32_16x16x32_bf16 v[168:171], v[64:67], v[24:27], v[168:171]
ds_read_b64_tr_b16 v[128:129], v6 offset:0
v_mfma_f32_16x16x32_bf16 v[164:167], v[56:59], v[24:27], 0
ds_read_b64_tr_b16 v[130:131], v6 offset:4096
v_mfma_f32_16x16x32_bf16 v[164:167], v[60:63], v[28:31], v[164:167]
ds_read_b64_tr_b16 v[132:133], v6 offset:8192
v_mfma_f32_16x16x32_bf16 v[160:163], v[52:55], v[28:31], 0
ds_read_b64_tr_b16 v[134:135], v6 offset:12288
v_mfma_f32_16x16x32_bf16 v[160:163], v[48:51], v[24:27], v[160:163]
ds_read_b64_tr_b16 v[140:141], v7 offset:8192
v_mfma_f32_16x16x32_bf16 v[176:179], v[48:51], v[32:35], 0
ds_read_b64_tr_b16 v[142:143], v7 offset:12288
v_mfma_f32_16x16x32_bf16 v[176:179], v[52:55], v[36:39], v[176:179]
v_mfma_f32_16x16x32_bf16 v[180:183], v[60:63], v[36:39], 0
ds_read_b64_tr_b16 v[136:137], v7 offset:0
v_mfma_f32_16x16x32_bf16 v[180:183], v[56:59], v[32:35], v[180:183]
ds_read_b64_tr_b16 v[138:139], v7 offset:4096
v_mfma_f32_16x16x32_bf16 v[184:187], v[64:67], v[32:35], 0
ds_read_b128 v[88:91], v1 offset:2048
s_add_u32 s39, s29, 32768
s_cmp_eq_u32 s29, 32768
s_cmov_b32 s39, 131072
s_cmp_eq_u32 s29, 131072
s_cmov_b32 s39, 65536
s_cmp_eq_u32 s29, 98304
s_cmov_b32 s39, 0
v_mfma_f32_16x16x32_bf16 v[184:187], v[68:71], v[36:39], v[184:187]
ds_read_b128 v[92:95], v1 offset:3072
v_mfma_f32_16x16x32_bf16 v[188:191], v[76:79], v[36:39], 0
ds_read_b128 v[96:99], v2 offset:0
s_sub_u32 s30, s39, s29
s_mov_b32 s29, s39
v_mfma_f32_16x16x32_bf16 v[188:191], v[72:75], v[32:35], v[188:191]
ds_read_b128 v[100:103], v2 offset:1024
v_mfma_f32_16x16x32_bf16 v[204:207], v[72:75], v[40:43], 0
ds_read_b128 v[104:107], v2 offset:2048
v_mfma_f32_16x16x32_bf16 v[204:207], v[76:79], v[44:47], v[204:207]
ds_read_b128 v[108:111], v2 offset:3072
v_mfma_f32_16x16x32_bf16 v[200:203], v[68:71], v[44:47], 0
v_mfma_f32_16x16x32_bf16 v[200:203], v[64:67], v[40:43], v[200:203]
v_add_u32 v1, s30, v1
v_add_u32 v2, s30, v2
v_mfma_f32_16x16x32_bf16 v[196:199], v[56:59], v[40:43], 0
v_add_u32 v4, s30, v4
v_mfma_f32_16x16x32_bf16 v[196:199], v[60:63], v[44:47], v[196:199]
v_add_u32 v5, s30, v5
v_mfma_f32_16x16x32_bf16 v[192:195], v[52:55], v[44:47], 0
v_add_u32 v6, s30, v6
v_mfma_f32_16x16x32_bf16 v[192:195], v[48:51], v[40:43], v[192:195]
v_add_u32 v7, s30, v7
s_waitcnt lgkmcnt(15)
v_mfma_f32_16x16x32_bf16 v[144:147], v[112:115], v[80:83], v[144:147]
ds_read_b128 v[16:19], v1 offset:0
v_mfma_f32_16x16x32_bf16 v[144:147], v[116:119], v[84:87], v[144:147]
ds_read_b64_tr_b16 v[48:49], v4 offset:0
v_mfma_f32_16x16x32_bf16 v[148:151], v[124:127], v[84:87], v[148:151]
ds_read_b64_tr_b16 v[50:51], v4 offset:4096
s_waitcnt lgkmcnt(15)
v_mfma_f32_16x16x32_bf16 v[148:151], v[120:123], v[80:83], v[148:151]
ds_read_b128 v[20:23], v1 offset:1024
v_mfma_f32_16x16x32_bf16 v[152:155], v[128:131], v[80:83], v[152:155]
ds_read_b64_tr_b16 v[52:53], v4 offset:8192
s_waitcnt lgkmcnt(15)
v_mfma_f32_16x16x32_bf16 v[152:155], v[132:135], v[84:87], v[152:155]
ds_read_b64_tr_b16 v[54:55], v4 offset:12288
s_waitcnt lgkmcnt(14)
v_mfma_f32_16x16x32_bf16 v[156:159], v[140:143], v[84:87], v[156:159]
ds_read_b64_tr_b16 v[60:61], v5 offset:8192
s_waitcnt lgkmcnt(13)
v_mfma_f32_16x16x32_bf16 v[156:159], v[136:139], v[80:83], v[156:159]
ds_read_b64_tr_b16 v[62:63], v5 offset:12288
s_waitcnt lgkmcnt(13)
v_mfma_f32_16x16x32_bf16 v[172:175], v[136:139], v[88:91], v[172:175]
s_waitcnt lgkmcnt(12)
v_mfma_f32_16x16x32_bf16 v[172:175], v[140:143], v[92:95], v[172:175]
ds_read_b64_tr_b16 v[56:57], v5 offset:0
v_mfma_f32_16x16x32_bf16 v[168:171], v[132:135], v[92:95], v[168:171]
ds_read_b64_tr_b16 v[58:59], v5 offset:4096
v_mfma_f32_16x16x32_bf16 v[168:171], v[128:131], v[88:91], v[168:171]
ds_read_b64_tr_b16 v[64:65], v6 offset:0
v_mfma_f32_16x16x32_bf16 v[164:167], v[120:123], v[88:91], v[164:167]
ds_read_b64_tr_b16 v[66:67], v6 offset:4096
v_mfma_f32_16x16x32_bf16 v[164:167], v[124:127], v[92:95], v[164:167]
ds_read_b64_tr_b16 v[68:69], v6 offset:8192
v_mfma_f32_16x16x32_bf16 v[160:163], v[116:119], v[92:95], v[160:163]
ds_read_b64_tr_b16 v[70:71], v6 offset:12288
v_mfma_f32_16x16x32_bf16 v[160:163], v[112:115], v[88:91], v[160:163]
ds_read_b64_tr_b16 v[76:77], v7 offset:8192
s_waitcnt lgkmcnt(15)
v_mfma_f32_16x16x32_bf16 v[176:179], v[112:115], v[96:99], v[176:179]
ds_read_b64_tr_b16 v[78:79], v7 offset:12288
v_mfma_f32_16x16x32_bf16 v[176:179], v[116:119], v[100:103], v[176:179]
v_mfma_f32_16x16x32_bf16 v[180:183], v[124:127], v[100:103], v[180:183]
ds_read_b64_tr_b16 v[72:73], v7 offset:0
v_mfma_f32_16x16x32_bf16 v[180:183], v[120:123], v[96:99], v[180:183]
ds_read_b64_tr_b16 v[74:75], v7 offset:4096
v_mfma_f32_16x16x32_bf16 v[184:187], v[128:131], v[96:99], v[184:187]
ds_read_b128 v[24:27], v1 offset:2048
s_add_u32 s39, s29, 32768
s_cmp_eq_u32 s29, 32768
s_cmov_b32 s39, 131072
s_cmp_eq_u32 s29, 131072
s_cmov_b32 s39, 65536
s_cmp_eq_u32 s29, 98304
s_cmov_b32 s39, 0
v_mfma_f32_16x16x32_bf16 v[184:187], v[132:135], v[100:103], v[184:187]
ds_read_b128 v[28:31], v1 offset:3072
v_mfma_f32_16x16x32_bf16 v[188:191], v[140:143], v[100:103], v[188:191]
ds_read_b128 v[32:35], v2 offset:0
s_sub_u32 s30, s39, s29
s_mov_b32 s29, s39
v_mfma_f32_16x16x32_bf16 v[188:191], v[136:139], v[96:99], v[188:191]
ds_read_b128 v[36:39], v2 offset:1024
v_mfma_f32_16x16x32_bf16 v[204:207], v[136:139], v[104:107], v[204:207]
ds_read_b128 v[40:43], v2 offset:2048
v_mfma_f32_16x16x32_bf16 v[204:207], v[140:143], v[108:111], v[204:207]
ds_read_b128 v[44:47], v2 offset:3072
v_mfma_f32_16x16x32_bf16 v[200:203], v[132:135], v[108:111], v[200:203]
v_mfma_f32_16x16x32_bf16 v[200:203], v[128:131], v[104:107], v[200:203]
v_add_u32 v1, s30, v1
v_add_u32 v2, s30, v2
v_mfma_f32_16x16x32_bf16 v[196:199], v[120:123], v[104:107], v[196:199]
v_add_u32 v4, s30, v4
v_mfma_f32_16x16x32_bf16 v[196:199], v[124:127], v[108:111], v[196:199]
v_add_u32 v5, s30, v5
v_mfma_f32_16x16x32_bf16 v[192:195], v[116:119], v[108:111], v[192:195]
v_add_u32 v6, s30, v6
v_mfma_f32_16x16x32_bf16 v[192:195], v[112:115], v[104:107], v[192:195]
v_add_u32 v7, s30, v7
.p2align 6
L_g2l_156:
s_waitcnt lgkmcnt(0)
s_barrier
v_mfma_f32_16x16x32_bf16 v[144:147], v[48:51], v[16:19], v[144:147]
ds_read_b128 v[80:83], v1 offset:0
v_mfma_f32_16x16x32_bf16 v[144:147], v[52:55], v[20:23], v[144:147]
ds_read_b64_tr_b16 v[112:113], v4 offset:0
s_cmp_eq_u32 s31, 2
s_cbranch_scc1 L_fo_157
L_fob_158:
v_mfma_f32_16x16x32_bf16 v[148:151], v[60:63], v[20:23], v[148:151]
ds_read_b64_tr_b16 v[114:115], v4 offset:4096
v_mfma_f32_16x16x32_bf16 v[148:151], v[56:59], v[16:19], v[148:151]
ds_read_b128 v[84:87], v1 offset:1024
v_mfma_f32_16x16x32_bf16 v[152:155], v[64:67], v[16:19], v[152:155]
ds_read_b64_tr_b16 v[116:117], v4 offset:8192
v_mfma_f32_16x16x32_bf16 v[152:155], v[68:71], v[20:23], v[152:155]
ds_read_b64_tr_b16 v[118:119], v4 offset:12288
v_mfma_f32_16x16x32_bf16 v[156:159], v[76:79], v[20:23], v[156:159]
ds_read_b64_tr_b16 v[124:125], v5 offset:8192
v_mfma_f32_16x16x32_bf16 v[156:159], v[72:75], v[16:19], v[156:159]
ds_read_b64_tr_b16 v[126:127], v5 offset:12288
v_mfma_f32_16x16x32_bf16 v[172:175], v[72:75], v[24:27], v[172:175]
v_mfma_f32_16x16x32_bf16 v[172:175], v[76:79], v[28:31], v[172:175]
ds_read_b64_tr_b16 v[120:121], v5 offset:0
v_mfma_f32_16x16x32_bf16 v[168:171], v[68:71], v[28:31], v[168:171]
ds_read_b64_tr_b16 v[122:123], v5 offset:4096
v_mfma_f32_16x16x32_bf16 v[168:171], v[64:67], v[24:27], v[168:171]
ds_read_b64_tr_b16 v[128:129], v6 offset:0
v_mfma_f32_16x16x32_bf16 v[164:167], v[56:59], v[24:27], v[164:167]
ds_read_b64_tr_b16 v[130:131], v6 offset:4096
v_mfma_f32_16x16x32_bf16 v[164:167], v[60:63], v[28:31], v[164:167]
ds_read_b64_tr_b16 v[132:133], v6 offset:8192
v_mfma_f32_16x16x32_bf16 v[160:163], v[52:55], v[28:31], v[160:163]
ds_read_b64_tr_b16 v[134:135], v6 offset:12288
v_mfma_f32_16x16x32_bf16 v[160:163], v[48:51], v[24:27], v[160:163]
ds_read_b64_tr_b16 v[140:141], v7 offset:8192
v_mfma_f32_16x16x32_bf16 v[176:179], v[48:51], v[32:35], v[176:179]
ds_read_b64_tr_b16 v[142:143], v7 offset:12288
v_mfma_f32_16x16x32_bf16 v[176:179], v[52:55], v[36:39], v[176:179]
v_mfma_f32_16x16x32_bf16 v[180:183], v[60:63], v[36:39], v[180:183]
ds_read_b64_tr_b16 v[136:137], v7 offset:0
v_mfma_f32_16x16x32_bf16 v[180:183], v[56:59], v[32:35], v[180:183]
ds_read_b64_tr_b16 v[138:139], v7 offset:4096
v_mfma_f32_16x16x32_bf16 v[184:187], v[64:67], v[32:35], v[184:187]
ds_read_b128 v[88:91], v1 offset:2048
s_add_u32 s39, s29, 32768
s_cmp_eq_u32 s29, 32768
s_cmov_b32 s39, 131072
s_cmp_eq_u32 s29, 131072
s_cmov_b32 s39, 65536
s_cmp_eq_u32 s29, 98304
s_cmov_b32 s39, 0
v_mfma_f32_16x16x32_bf16 v[184:187], v[68:71], v[36:39], v[184:187]
ds_read_b128 v[92:95], v1 offset:3072
v_mfma_f32_16x16x32_bf16 v[188:191], v[76:79], v[36:39], v[188:191]
ds_read_b128 v[96:99], v2 offset:0
s_sub_u32 s30, s39, s29
s_mov_b32 s29, s39
v_mfma_f32_16x16x32_bf16 v[188:191], v[72:75], v[32:35], v[188:191]
ds_read_b128 v[100:103], v2 offset:1024
v_mfma_f32_16x16x32_bf16 v[204:207], v[72:75], v[40:43], v[204:207]
ds_read_b128 v[104:107], v2 offset:2048
v_mfma_f32_16x16x32_bf16 v[204:207], v[76:79], v[44:47], v[204:207]
ds_read_b128 v[108:111], v2 offset:3072
v_mfma_f32_16x16x32_bf16 v[200:203], v[68:71], v[44:47], v[200:203]
v_mfma_f32_16x16x32_bf16 v[200:203], v[64:67], v[40:43], v[200:203]
v_add_u32 v1, s30, v1
v_add_u32 v2, s30, v2
v_mfma_f32_16x16x32_bf16 v[196:199], v[56:59], v[40:43], v[196:199]
v_add_u32 v4, s30, v4
v_mfma_f32_16x16x32_bf16 v[196:199], v[60:63], v[44:47], v[196:199]
v_add_u32 v5, s30, v5
v_mfma_f32_16x16x32_bf16 v[192:195], v[52:55], v[44:47], v[192:195]
v_add_u32 v6, s30, v6
v_mfma_f32_16x16x32_bf16 v[192:195], v[48:51], v[40:43], v[192:195]
v_add_u32 v7, s30, v7
s_waitcnt lgkmcnt(15)
v_mfma_f32_16x16x32_bf16 v[144:147], v[112:115], v[80:83], v[144:147]
ds_read_b128 v[16:19], v1 offset:0
v_mfma_f32_16x16x32_bf16 v[144:147], v[116:119], v[84:87], v[144:147]
ds_read_b64_tr_b16 v[48:49], v4 offset:0
v_mfma_f32_16x16x32_bf16 v[148:151], v[124:127], v[84:87], v[148:151]
ds_read_b64_tr_b16 v[50:51], v4 offset:4096
s_waitcnt lgkmcnt(15)
v_mfma_f32_16x16x32_bf16 v[148:151], v[120:123], v[80:83], v[148:151]
ds_read_b128 v[20:23], v1 offset:1024
v_mfma_f32_16x16x32_bf16 v[152:155], v[128:131], v[80:83], v[152:155]
ds_read_b64_tr_b16 v[52:53], v4 offset:8192
s_waitcnt lgkmcnt(15)
v_mfma_f32_16x16x32_bf16 v[152:155], v[132:135], v[84:87], v[152:155]
ds_read_b64_tr_b16 v[54:55], v4 offset:12288
s_waitcnt lgkmcnt(14)
v_mfma_f32_16x16x32_bf16 v[156:159], v[140:143], v[84:87], v[156:159]
ds_read_b64_tr_b16 v[60:61], v5 offset:8192
s_waitcnt lgkmcnt(13)
v_mfma_f32_16x16x32_bf16 v[156:159], v[136:139], v[80:83], v[156:159]
ds_read_b64_tr_b16 v[62:63], v5 offset:12288
s_waitcnt lgkmcnt(13)
v_mfma_f32_16x16x32_bf16 v[172:175], v[136:139], v[88:91], v[172:175]
s_waitcnt lgkmcnt(12)
v_mfma_f32_16x16x32_bf16 v[172:175], v[140:143], v[92:95], v[172:175]
ds_read_b64_tr_b16 v[56:57], v5 offset:0
v_mfma_f32_16x16x32_bf16 v[168:171], v[132:135], v[92:95], v[168:171]
ds_read_b64_tr_b16 v[58:59], v5 offset:4096
v_mfma_f32_16x16x32_bf16 v[168:171], v[128:131], v[88:91], v[168:171]
ds_read_b64_tr_b16 v[64:65], v6 offset:0
v_mfma_f32_16x16x32_bf16 v[164:167], v[120:123], v[88:91], v[164:167]
ds_read_b64_tr_b16 v[66:67], v6 offset:4096
v_mfma_f32_16x16x32_bf16 v[164:167], v[124:127], v[92:95], v[164:167]
ds_read_b64_tr_b16 v[68:69], v6 offset:8192
v_mfma_f32_16x16x32_bf16 v[160:163], v[116:119], v[92:95], v[160:163]
ds_read_b64_tr_b16 v[70:71], v6 offset:12288
v_mfma_f32_16x16x32_bf16 v[160:163], v[112:115], v[88:91], v[160:163]
ds_read_b64_tr_b16 v[76:77], v7 offset:8192
s_waitcnt lgkmcnt(15)
v_mfma_f32_16x16x32_bf16 v[176:179], v[112:115], v[96:99], v[176:179]
ds_read_b64_tr_b16 v[78:79], v7 offset:12288
v_mfma_f32_16x16x32_bf16 v[176:179], v[116:119], v[100:103], v[176:179]
v_mfma_f32_16x16x32_bf16 v[180:183], v[124:127], v[100:103], v[180:183]
ds_read_b64_tr_b16 v[72:73], v7 offset:0
v_mfma_f32_16x16x32_bf16 v[180:183], v[120:123], v[96:99], v[180:183]
ds_read_b64_tr_b16 v[74:75], v7 offset:4096
v_mfma_f32_16x16x32_bf16 v[184:187], v[128:131], v[96:99], v[184:187]
ds_read_b128 v[24:27], v1 offset:2048
s_add_u32 s39, s29, 32768
s_cmp_eq_u32 s29, 32768
s_cmov_b32 s39, 131072
s_cmp_eq_u32 s29, 131072
s_cmov_b32 s39, 65536
s_cmp_eq_u32 s29, 98304
s_cmov_b32 s39, 0
v_mfma_f32_16x16x32_bf16 v[184:187], v[132:135], v[100:103], v[184:187]
ds_read_b128 v[28:31], v1 offset:3072
v_mfma_f32_16x16x32_bf16 v[188:191], v[140:143], v[100:103], v[188:191]
ds_read_b128 v[32:35], v2 offset:0
s_sub_u32 s30, s39, s29
s_mov_b32 s29, s39
v_mfma_f32_16x16x32_bf16 v[188:191], v[136:139], v[96:99], v[188:191]
ds_read_b128 v[36:39], v2 offset:1024
v_mfma_f32_16x16x32_bf16 v[204:207], v[136:139], v[104:107], v[204:207]
ds_read_b128 v[40:43], v2 offset:2048
v_mfma_f32_16x16x32_bf16 v[204:207], v[140:143], v[108:111], v[204:207]
ds_read_b128 v[44:47], v2 offset:3072
v_mfma_f32_16x16x32_bf16 v[200:203], v[132:135], v[108:111], v[200:203]
v_mfma_f32_16x16x32_bf16 v[200:203], v[128:131], v[104:107], v[200:203]
v_add_u32 v1, s30, v1
v_add_u32 v2, s30, v2
v_mfma_f32_16x16x32_bf16 v[196:199], v[120:123], v[104:107], v[196:199]
v_add_u32 v4, s30, v4
v_mfma_f32_16x16x32_bf16 v[196:199], v[124:127], v[108:111], v[196:199]
v_add_u32 v5, s30, v5
v_mfma_f32_16x16x32_bf16 v[192:195], v[116:119], v[108:111], v[192:195]
v_add_u32 v6, s30, v6
v_mfma_f32_16x16x32_bf16 v[192:195], v[112:115], v[104:107], v[192:195]
v_add_u32 v7, s30, v7
s_add_u32 s31, s31, 2
s_cmp_lg_u32 s31, 34
s_cbranch_scc1 L_g2l_156
s_waitcnt lgkmcnt(0)
s_barrier
v_mfma_f32_16x16x32_bf16 v[144:147], v[48:51], v[16:19], v[144:147]
ds_read_b128 v[80:83], v1 offset:0
buffer_load_dwordx4 v[208:211], v3, s[8:11], s32 offen offset:0
v_mfma_f32_16x16x32_bf16 v[144:147], v[52:55], v[20:23], v[144:147]
ds_read_b64_tr_b16 v[112:113], v4 offset:0
buffer_load_dwordx4 v[212:215], v3, s[8:11], s32 offen offset:64
v_mfma_f32_16x16x32_bf16 v[148:151], v[60:63], v[20:23], v[148:151]
ds_read_b64_tr_b16 v[114:115], v4 offset:4096
buffer_load_dwordx4 v[216:219], v3, s[8:11], s38 offen offset:0
v_mfma_f32_16x16x32_bf16 v[148:151], v[56:59], v[16:19], v[148:151]
ds_read_b128 v[84:87], v1 offset:1024
v_mov_b32 v227, s86
v_mfma_f32_16x16x32_bf16 v[152:155], v[64:67], v[16:19], v[152:155]
ds_read_b64_tr_b16 v[116:117], v4 offset:8192
buffer_load_dwordx4 v[220:223], v3, s[8:11], s38 offen offset:64
v_mfma_f32_16x16x32_bf16 v[152:155], v[68:71], v[20:23], v[152:155]
ds_read_b64_tr_b16 v[118:119], v4 offset:12288
v_mov_b32 v231, s86
v_mfma_f32_16x16x32_bf16 v[156:159], v[76:79], v[20:23], v[156:159]
ds_read_b64_tr_b16 v[124:125], v5 offset:8192
v_mov_b32 v235, s86
v_mfma_f32_16x16x32_bf16 v[156:159], v[72:75], v[16:19], v[156:159]
ds_read_b64_tr_b16 v[126:127], v5 offset:12288
v_mov_b32 v239, s86
v_mfma_f32_16x16x32_bf16 v[172:175], v[72:75], v[24:27], v[172:175]
ds_read_b64_tr_b16 v[120:121], v5 offset:0
v_mov_b32 v243, s86
v_mfma_f32_16x16x32_bf16 v[172:175], v[76:79], v[28:31], v[172:175]
ds_read_b64_tr_b16 v[122:123], v5 offset:4096
s_add_u32 s34, s36, 4096
ds_read_b64_tr_b16 v[128:129], v6 offset:0
v_mfma_f32_16x16x32_bf16 v[168:171], v[68:71], v[28:31], v[168:171]
ds_read_b64_tr_b16 v[130:131], v6 offset:4096
v_mov_b32 v247, s86
v_mfma_f32_16x16x32_bf16 v[168:171], v[64:67], v[24:27], v[168:171]
ds_read_b64_tr_b16 v[132:133], v6 offset:8192
ds_read_b64_tr_b16 v[134:135], v6 offset:12288
v_mfma_f32_16x16x32_bf16 v[164:167], v[56:59], v[24:27], v[164:167]
ds_read_b64_tr_b16 v[140:141], v7 offset:8192
ds_read_b64_tr_b16 v[142:143], v7 offset:12288
v_mfma_f32_16x16x32_bf16 v[164:167], v[60:63], v[28:31], v[164:167]
ds_read_b64_tr_b16 v[136:137], v7 offset:0
ds_read_b64_tr_b16 v[138:139], v7 offset:4096
v_mfma_f32_16x16x32_bf16 v[160:163], v[52:55], v[28:31], v[160:163]
ds_read_b128 v[88:91], v1 offset:2048
ds_read_b128 v[92:95], v1 offset:3072
v_mfma_f32_16x16x32_bf16 v[160:163], v[48:51], v[24:27], v[160:163]
ds_read_b128 v[96:99], v2 offset:0
ds_read_b128 v[100:103], v2 offset:1024
s_waitcnt lgkmcnt(15)
v_mfma_f32_16x16x32_bf16 v[144:147], v[112:115], v[80:83], v[144:147]
ds_read_b128 v[104:107], v2 offset:2048
ds_read_b128 v[108:111], v2 offset:3072
v_mfma_f32_16x16x32_bf16 v[144:147], v[116:119], v[84:87], v[144:147]
s_waitcnt lgkmcnt(15)
v_mfma_f32_16x16x32_bf16 v[148:151], v[124:127], v[84:87], v[148:151]
s_waitcnt lgkmcnt(14)
v_mfma_f32_16x16x32_bf16 v[148:151], v[120:123], v[80:83], v[148:151]
s_waitcnt lgkmcnt(12)
v_mfma_f32_16x16x32_bf16 v[152:155], v[128:131], v[80:83], v[152:155]
v_mfma_f32_16x16x32_bf16 v[176:179], v[48:51], v[32:35], v[176:179]
s_waitcnt lgkmcnt(10)
v_mfma_f32_16x16x32_bf16 v[152:155], v[132:135], v[84:87], v[152:155]
s_nop 2
v_permlane16_swap_b32 v144, v148
v_permlane16_swap_b32 v145, v149
s_waitcnt lgkmcnt(8)
v_mfma_f32_16x16x32_bf16 v[156:159], v[140:143], v[84:87], v[156:159]
v_permlane16_swap_b32 v146, v150
v_permlane16_swap_b32 v147, v151
s_waitcnt lgkmcnt(6)
v_mfma_f32_16x16x32_bf16 v[156:159], v[136:139], v[80:83], v[156:159]
v_cvt_pk_bf16_f32 v224, v144, v145
v_cvt_pk_bf16_f32 v225, v146, v147
s_waitcnt lgkmcnt(5)
v_mfma_f32_16x16x32_bf16 v[172:175], v[136:139], v[88:91], v[172:175]
v_cvt_pk_bf16_f32 v226, v148, v149
v_cvt_pk_bf16_f32 v228, v150, v151
s_waitcnt lgkmcnt(4)
v_mfma_f32_16x16x32_bf16 v[172:175], v[140:143], v[92:95], v[172:175]
buffer_store_dwordx4 v[224:227], v12, s[24:27], s36 offen offset:0 sc1
v_mfma_f32_16x16x32_bf16 v[164:167], v[120:123], v[88:91], v[164:167]
v_permlane16_swap_b32 v152, v156
v_permlane16_swap_b32 v153, v157
v_mfma_f32_16x16x32_bf16 v[168:171], v[132:135], v[92:95], v[168:171]
v_permlane16_swap_b32 v154, v158
v_permlane16_swap_b32 v155, v159
v_mfma_f32_16x16x32_bf16 v[168:171], v[128:131], v[88:91], v[168:171]
v_cvt_pk_bf16_f32 v229, v152, v153
v_cvt_pk_bf16_f32 v230, v154, v155
v_mfma_f32_16x16x32_bf16 v[164:167], v[124:127], v[92:95], v[164:167]
v_cvt_pk_bf16_f32 v232, v156, v157
v_cvt_pk_bf16_f32 v233, v158, v159
v_mfma_f32_16x16x32_bf16 v[160:163], v[116:119], v[92:95], v[160:163]
buffer_store_dwordx4 v[228:231], v12, s[24:27], s36 offen offset:1024 sc1
v_mfma_f32_16x16x32_bf16 v[160:163], v[112:115], v[88:91], v[160:163]
v_permlane16_swap_b32 v168, v172
v_permlane16_swap_b32 v169, v173
v_mfma_f32_16x16x32_bf16 v[176:179], v[52:55], v[36:39], v[176:179]
v_permlane16_swap_b32 v170, v174
v_permlane16_swap_b32 v171, v175
v_mfma_f32_16x16x32_bf16 v[180:183], v[60:63], v[36:39], v[180:183]
v_cvt_pk_bf16_f32 v240, v168, v169
v_cvt_pk_bf16_f32 v241, v170, v171
v_mfma_f32_16x16x32_bf16 v[180:183], v[56:59], v[32:35], v[180:183]
v_permlane16_swap_b32 v160, v164
v_permlane16_swap_b32 v161, v165
v_mfma_f32_16x16x32_bf16 v[184:187], v[64:67], v[32:35], v[184:187]
v_permlane16_swap_b32 v162, v166
v_permlane16_swap_b32 v163, v167
v_mfma_f32_16x16x32_bf16 v[184:187], v[68:71], v[36:39], v[184:187]
v_cvt_pk_bf16_f32 v234, v160, v161
v_cvt_pk_bf16_f32 v236, v162, v163
v_mfma_f32_16x16x32_bf16 v[188:191], v[76:79], v[36:39], v[188:191]
v_cvt_pk_bf16_f32 v237, v164, v165
v_cvt_pk_bf16_f32 v238, v166, v167
v_mfma_f32_16x16x32_bf16 v[188:191], v[72:75], v[32:35], v[188:191]
buffer_store_dwordx4 v[232:235], v12, s[24:27], s36 offen offset:2048 sc1
v_cvt_pk_bf16_f32 v242, v172, v173
v_mfma_f32_16x16x32_bf16 v[204:207], v[72:75], v[40:43], v[204:207]
buffer_store_dwordx4 v[236:239], v12, s[24:27], s36 offen offset:3072 sc1
v_cvt_pk_bf16_f32 v244, v174, v175
v_mfma_f32_16x16x32_bf16 v[204:207], v[76:79], v[44:47], v[204:207]
buffer_store_dwordx4 v[240:243], v12, s[24:27], s34 offen offset:0 sc1
buffer_store_dwordx4 v[244:247], v12, s[24:27], s34 offen offset:1024 sc1
v_mfma_f32_16x16x32_bf16 v[200:203], v[68:71], v[44:47], v[200:203]
v_mfma_f32_16x16x32_bf16 v[196:199], v[56:59], v[40:43], v[196:199]
v_mfma_f32_16x16x32_bf16 v[192:195], v[52:55], v[44:47], v[192:195]
v_mfma_f32_16x16x32_bf16 v[200:203], v[64:67], v[40:43], v[200:203]
v_mfma_f32_16x16x32_bf16 v[196:199], v[60:63], v[44:47], v[196:199]
v_mfma_f32_16x16x32_bf16 v[192:195], v[48:51], v[40:43], v[192:195]
s_waitcnt lgkmcnt(3)
v_mfma_f32_16x16x32_bf16 v[176:179], v[112:115], v[96:99], v[176:179]
s_waitcnt lgkmcnt(2)
v_mfma_f32_16x16x32_bf16 v[180:183], v[124:127], v[100:103], v[180:183]
v_mfma_f32_16x16x32_bf16 v[184:187], v[128:131], v[96:99], v[184:187]
v_mfma_f32_16x16x32_bf16 v[188:191], v[140:143], v[100:103], v[188:191]
s_waitcnt lgkmcnt(1)
v_mfma_f32_16x16x32_bf16 v[204:207], v[136:139], v[104:107], v[204:207]
s_waitcnt lgkmcnt(0)
v_mfma_f32_16x16x32_bf16 v[200:203], v[132:135], v[108:111], v[200:203]
v_mfma_f32_16x16x32_bf16 v[196:199], v[120:123], v[104:107], v[196:199]
v_mfma_f32_16x16x32_bf16 v[192:195], v[116:119], v[108:111], v[192:195]
v_mfma_f32_16x16x32_bf16 v[176:179], v[116:119], v[100:103], v[176:179]
v_mfma_f32_16x16x32_bf16 v[180:183], v[120:123], v[96:99], v[180:183]
v_mfma_f32_16x16x32_bf16 v[184:187], v[132:135], v[100:103], v[184:187]
v_mfma_f32_16x16x32_bf16 v[188:191], v[136:139], v[96:99], v[188:191]
v_mfma_f32_16x16x32_bf16 v[204:207], v[140:143], v[108:111], v[204:207]
v_mfma_f32_16x16x32_bf16 v[200:203], v[128:131], v[104:107], v[200:203]
v_mfma_f32_16x16x32_bf16 v[196:199], v[124:127], v[108:111], v[196:199]
v_mfma_f32_16x16x32_bf16 v[192:195], v[112:115], v[104:107], v[192:195]
v_mov_b32 v8, 0
s_add_u32 s35, s37, 4096
s_waitcnt vmcnt(6)
buffer_load_dwordx4 v[48:51], v12, s[24:27], s37 offen offset:0 sc1
buffer_load_dwordx4 v[52:55], v12, s[24:27], s37 offen offset:1024 sc1
buffer_load_dwordx4 v[56:59], v12, s[24:27], s37 offen offset:2048 sc1
buffer_load_dwordx4 v[60:63], v12, s[24:27], s37 offen offset:3072 sc1
buffer_load_dwordx4 v[64:67], v12, s[24:27], s35 offen offset:0 sc1
buffer_load_dwordx4 v[68:71], v12, s[24:27], s35 offen offset:1024 sc1
v_permlane16_swap_b32 v176, v180
v_permlane16_swap_b32 v177, v181
v_permlane16_swap_b32 v178, v182
v_permlane16_swap_b32 v179, v183
v_lshlrev_b32 v16, 16, v208
v_and_b32 v17, 0xffff0000, v208
v_lshlrev_b32 v18, 16, v209
v_and_b32 v19, 0xffff0000, v209
v_lshlrev_b32 v20, 16, v210
v_and_b32 v21, 0xffff0000, v210
v_lshlrev_b32 v22, 16, v211
v_and_b32 v23, 0xffff0000, v211
v_permlane16_swap_b32 v184, v188
v_permlane16_swap_b32 v185, v189
v_permlane16_swap_b32 v186, v190
v_permlane16_swap_b32 v187, v191
v_lshlrev_b32 v24, 16, v212
v_and_b32 v25, 0xffff0000, v212
v_lshlrev_b32 v26, 16, v213
v_and_b32 v27, 0xffff0000, v213
v_lshlrev_b32 v28, 16, v214
v_and_b32 v29, 0xffff0000, v214
v_lshlrev_b32 v30, 16, v215
v_and_b32 v31, 0xffff0000, v215
v_permlane16_swap_b32 v192, v196
v_permlane16_swap_b32 v193, v197
v_permlane16_swap_b32 v194, v198
v_permlane16_swap_b32 v195, v199
v_lshlrev_b32 v32, 16, v216
v_and_b32 v33, 0xffff0000, v216
v_lshlrev_b32 v34, 16, v217
v_and_b32 v35, 0xffff0000, v217
v_lshlrev_b32 v36, 16, v218
v_and_b32 v37, 0xffff0000, v218
v_lshlrev_b32 v38, 16, v219
v_and_b32 v39, 0xffff0000, v219
v_permlane16_swap_b32 v200, v204
v_permlane16_swap_b32 v201, v205
v_permlane16_swap_b32 v202, v206
v_permlane16_swap_b32 v203, v207
v_lshlrev_b32 v40, 16, v220
v_and_b32 v41, 0xffff0000, v220
v_lshlrev_b32 v42, 16, v221
v_and_b32 v43, 0xffff0000, v221
v_lshlrev_b32 v44, 16, v222
v_and_b32 v45, 0xffff0000, v222
v_lshlrev_b32 v46, 16, v223
v_and_b32 v47, 0xffff0000, v223
v_pk_add_f32 v[176:177], v[176:177], v[16:17]
v_pk_add_f32 v[178:179], v[178:179], v[18:19]
v_pk_add_f32 v[180:181], v[180:181], v[20:21]
v_pk_add_f32 v[182:183], v[182:183], v[22:23]
v_pk_add_f32 v[184:185], v[184:185], v[24:25]
v_pk_add_f32 v[186:187], v[186:187], v[26:27]
v_pk_add_f32 v[188:189], v[188:189], v[28:29]
v_pk_add_f32 v[190:191], v[190:191], v[30:31]
v_pk_add_f32 v[192:193], v[192:193], v[32:33]
v_pk_add_f32 v[194:195], v[194:195], v[34:35]
v_pk_add_f32 v[196:197], v[196:197], v[36:37]
v_pk_add_f32 v[198:199], v[198:199], v[38:39]
v_pk_add_f32 v[200:201], v[200:201], v[40:41]
v_pk_add_f32 v[202:203], v[202:203], v[42:43]
v_pk_add_f32 v[204:205], v[204:205], v[44:45]
v_pk_add_f32 v[206:207], v[206:207], v[46:47]
s_waitcnt vmcnt(0)
v_xor_b32 v8, v51, v55
v_xor_b32 v9, v59, v63
v_xor_b32 v10, v67, v71
v_xor_b32 v11, s86, v51
v_or3_b32 v8, v8, v9, v10
v_xor_b32 v9, s86, v59
v_xor_b32 v10, s86, v67
v_or3_b32 v9, v9, v10, v11
v_or_b32 v8, v8, v9
v_cmp_ne_u32 vcc, 0, v8
s_nop 0
s_cmp_lg_u64 vcc, 0
s_cbranch_scc1 L_xt_160
L_xtb_161:
v_lshlrev_b32 v16, 16, v48
v_and_b32 v17, 0xffff0000, v48
v_lshlrev_b32 v18, 16, v49
v_and_b32 v19, 0xffff0000, v49
v_lshlrev_b32 v20, 16, v50
v_and_b32 v21, 0xffff0000, v50
v_lshlrev_b32 v22, 16, v52
v_and_b32 v23, 0xffff0000, v52
v_pk_add_f32 v[16:17], v[16:17], v[176:177]
v_pk_add_f32 v[18:19], v[18:19], v[178:179]
v_pk_add_f32 v[20:21], v[20:21], v[180:181]
v_pk_add_f32 v[22:23], v[22:23], v[182:183]
v_cvt_pk_bf16_f32 v208, v16, v17
v_cvt_pk_bf16_f32 v209, v18, v19
v_cvt_pk_bf16_f32 v210, v20, v21
v_cvt_pk_bf16_f32 v211, v22, v23
buffer_store_dwordx4 v[208:211], v3, s[12:15], s32 offen offset:0
v_lshlrev_b32 v24, 16, v53
v_and_b32 v25, 0xffff0000, v53
v_lshlrev_b32 v26, 16, v54
v_and_b32 v27, 0xffff0000, v54
v_lshlrev_b32 v28, 16, v56
v_and_b32 v29, 0xffff0000, v56
v_lshlrev_b32 v30, 16, v57
v_and_b32 v31, 0xffff0000, v57
v_pk_add_f32 v[24:25], v[24:25], v[184:185]
v_pk_add_f32 v[26:27], v[26:27], v[186:187]
v_pk_add_f32 v[28:29], v[28:29], v[188:189]
v_pk_add_f32 v[30:31], v[30:31], v[190:191]
v_cvt_pk_bf16_f32 v212, v24, v25
v_cvt_pk_bf16_f32 v213, v26, v27
v_cvt_pk_bf16_f32 v214, v28, v29
v_cvt_pk_bf16_f32 v215, v30, v31
buffer_store_dwordx4 v[212:215], v3, s[12:15], s32 offen offset:64
v_lshlrev_b32 v32, 16, v58
v_and_b32 v33, 0xffff0000, v58
v_lshlrev_b32 v34, 16, v60
v_and_b32 v35, 0xffff0000, v60
v_lshlrev_b32 v36, 16, v61
v_and_b32 v37, 0xffff0000, v61
v_lshlrev_b32 v38, 16, v62
v_and_b32 v39, 0xffff0000, v62
v_pk_add_f32 v[32:33], v[32:33], v[192:193]
v_pk_add_f32 v[34:35], v[34:35], v[194:195]
v_pk_add_f32 v[36:37], v[36:37], v[196:197]
v_pk_add_f32 v[38:39], v[38:39], v[198:199]
v_cvt_pk_bf16_f32 v216, v32, v33
v_cvt_pk_bf16_f32 v217, v34, v35
v_cvt_pk_bf16_f32 v218, v36, v37
v_cvt_pk_bf16_f32 v219, v38, v39
buffer_store_dwordx4 v[216:219], v3, s[12:15], s38 offen offset:0
v_lshlrev_b32 v40, 16, v64
v_and_b32 v41, 0xffff0000, v64
v_lshlrev_b32 v42, 16, v65
v_and_b32 v43, 0xffff0000, v65
v_lshlrev_b32 v44, 16, v66
v_and_b32 v45, 0xffff0000, v66
v_lshlrev_b32 v46, 16, v68
v_and_b32 v47, 0xffff0000, v68
v_pk_add_f32 v[40:41], v[40:41], v[200:201]
v_pk_add_f32 v[42:43], v[42:43], v[202:203]
v_pk_add_f32 v[44:45], v[44:45], v[204:205]
v_pk_add_f32 v[46:47], v[46:47], v[206:207]
v_cvt_pk_bf16_f32 v220, v40, v41
v_cvt_pk_bf16_f32 v221, v42, v43
v_cvt_pk_bf16_f32 v222, v44, v45
v_cvt_pk_bf16_f32 v223, v46, v47
buffer_store_dwordx4 v[220:223], v3, s[12:15], s38 offen offset:64
s_branch L_done_155
L_ld_154:
s_waitcnt vmcnt(17)
s_barrier
s_mov_b32 s28, 65536
s_mov_b32 s28, 0
s_waitcnt vmcnt(9)
s_barrier
s_add_u32 m0, s89, s28
s_nop 0
buffer_load_dwordx4 v12, s[24:27], s87 offen sc1 lds
buffer_load_dwordx4 v12, s[24:27], s87 offen offset:1024 sc1 lds
s_add_u32 s41, s87, 147456
s_add_u32 m0, m0, 2048
s_nop 0
buffer_load_dwordx4 v12, s[24:27], s41 offen sc1 lds
buffer_load_dwordx4 v12, s[24:27], s41 offen offset:1024 sc1 lds
s_add_u32 s87, s87, 2048
s_add_u32 m0, s92, s28
s_nop 0
buffer_load_dwordx4 v8, s[16:19], s88 offen lds
s_add_u32 m0, m0, 4096
s_nop 0
buffer_load_dwordx4 v9, s[16:19], s88 offen lds
s_add_u32 m0, m0, 4096
s_nop 0
buffer_load_dwordx4 v10, s[16:19], s88 offen lds
s_add_u32 m0, m0, 4096
s_nop 0
buffer_load_dwordx4 v11, s[16:19], s88 offen lds
s_add_u32 s88, s88, 131072
s_add_u32 s41, s28, 32768
s_cmp_eq_u32 s28, 32768
s_cmov_b32 s41, 131072
s_cmp_eq_u32 s28, 131072
s_cmov_b32 s41, 65536
s_cmp_eq_u32 s28, 98304
s_cmov_b32 s41, 0
s_mov_b32 s28, s41
s_waitcnt vmcnt(8)
s_mov_b32 s31, 2
s_cmp_eq_u32 s22, 0
s_mov_b32 s30, 16
s_cmov_b32 s30, 1000
s_mov_b32 s93, 0x2f80000
L_ll_164:
s_barrier
s_cmp_lg_u32 s31, s30
s_cbranch_scc1 L_lns_165
v_cmp_ne_u32 vcc, s86, v1
s_nop 1
s_cbranch_vccz L_lnf_166
s_mov_b32 s94, 0
L_po_167:
buffer_load_dword v1, v13, s[24:27], s93 offen sc1
s_waitcnt vmcnt(0)
v_cmp_ne_u32 vcc, s86, v1
s_nop 1
s_cbranch_vccz L_pook_168
s_add_u32 s94, s94, 1
s_cmp_lt_u32 s94, 0x80000
s_cbranch_scc1 L_po_167
L_pook_168:
L_lnf_166:
s_mov_b32 s16, s84
s_mov_b32 s17, s85
s_mov_b32 s18, 2097152
s_mov_b32 s88, 0
L_lns_165:
s_add_u32 m0, s89, s28
s_nop 0
buffer_load_dwordx4 v12, s[24:27], s87 offen sc1 lds
buffer_load_dwordx4 v12, s[24:27], s87 offen offset:1024 sc1 lds
s_add_u32 s41, s87, 147456
s_add_u32 m0, m0, 2048
s_nop 0
buffer_load_dwordx4 v12, s[24:27], s41 offen sc1 lds
buffer_load_dwordx4 v12, s[24:27], s41 offen offset:1024 sc1 lds
s_add_u32 s87, s87, 2048
s_add_u32 m0, s92, s28
s_nop 0
buffer_load_dwordx4 v8, s[16:19], s88 offen lds
s_add_u32 m0, m0, 4096
s_nop 0
buffer_load_dwordx4 v9, s[16:19], s88 offen lds
s_add_u32 m0, m0, 4096
s_nop 0
buffer_load_dwordx4 v10, s[16:19], s88 offen lds
s_add_u32 m0, m0, 4096
s_nop 0
buffer_load_dwordx4 v11, s[16:19], s88 offen lds
s_add_u32 s88, s88, 131072
s_add_u32 s41, s28, 32768
s_cmp_eq_u32 s28, 32768
s_cmov_b32 s41, 131072
s_cmp_eq_u32 s28, 131072
s_cmov_b32 s41, 65536
s_cmp_eq_u32 s28, 98304
s_cmov_b32 s41, 0
s_mov_b32 s28, s41
s_cmp_lg_u32 s31, 12
s_cbranch_scc1 L_lnp_169
buffer_load_dword v1, v13, s[24:27], s93 offen sc1
L_lnp_169:
s_add_u32 m0, s89, s28
s_nop 0
buffer_load_dwordx4 v12, s[24:27], s87 offen sc1 lds
buffer_load_dwordx4 v12, s[24:27], s87 offen offset:1024 sc1 lds
s_add_u32 s41, s87, 147456
s_add_u32 m0, m0, 2048
s_nop 0
buffer_load_dwordx4 v12, s[24:27], s41 offen sc1 lds
buffer_load_dwordx4 v12, s[24:27], s41 offen offset:1024 sc1 lds
s_add_u32 s87, s87, 2048
s_add_u32 m0, s92, s28
s_nop 0
buffer_load_dwordx4 v8, s[16:19], s88 offen lds
s_add_u32 m0, m0, 4096
s_nop 0
buffer_load_dwordx4 v9, s[16:19], s88 offen lds
s_add_u32 m0, m0, 4096
s_nop 0
buffer_load_dwordx4 v10, s[16:19], s88 offen lds
s_add_u32 m0, m0, 4096
s_nop 0
buffer_load_dwordx4 v11, s[16:19], s88 offen lds
s_add_u32 s88, s88, 131072
s_add_u32 s41, s28, 32768
s_cmp_eq_u32 s28, 32768
s_cmov_b32 s41, 131072
s_cmp_eq_u32 s28, 131072
s_cmov_b32 s41, 65536
s_cmp_eq_u32 s28, 98304
s_cmov_b32 s41, 0
s_mov_b32 s28, s41
s_waitcnt vmcnt(8)
s_add_u32 s31, s31, 2
s_cmp_lg_u32 s31, 32
s_cbranch_scc1 L_ll_164
s_barrier
s_waitcnt vmcnt(0)
s_barrier
L_done_155:
s_endpgm
L_mk_134:
s_nop 7
v_mov_b32 v92, 0xf149f2ca
v_mov_b32 v93, 0xf149f2ca
v_mov_b32 v94, 0xf149f2ca
v_mov_b32 v95, 0xf149f2ca
s_cmp_eq_u32 s34, 1
s_cbranch_scc1 L_maskd_136
v_mov_b32 v96, 0xf149f2ca
v_mov_b32 v97, 0xf149f2ca
v_mov_b32 v98, 0xf149f2ca
v_mov_b32 v99, 0xf149f2ca
s_cmp_eq_u32 s34, 2
s_cbranch_scc1 L_maskd_136
v_mov_b32 v100, 0xf149f2ca
v_mov_b32 v101, 0xf149f2ca
v_mov_b32 v102, 0xf149f2ca
v_mov_b32 v103, 0xf149f2ca
s_cmp_eq_u32 s34, 3
s_cbranch_scc1 L_maskd_136
v_mov_b32 v104, 0xf149f2ca
v_mov_b32 v105, 0xf149f2ca
v_mov_b32 v106, 0xf149f2ca
v_mov_b32 v107, 0xf149f2ca
s_cmp_eq_u32 s34, 4
s_cbranch_scc1 L_maskd_136
v_mov_b32 v108, 0xf149f2ca
v_mov_b32 v109, 0xf149f2ca
v_mov_b32 v110, 0xf149f2ca
v_mov_b32 v111, 0xf149f2ca
s_cmp_eq_u32 s34, 5
s_cbranch_scc1 L_maskd_136
v_mov_b32 v112, 0xf149f2ca
v_mov_b32 v113, 0xf149f2ca
v_mov_b32 v114, 0xf149f2ca
v_mov_b32 v115, 0xf149f2ca
s_cmp_eq_u32 s34, 6
s_cbranch_scc1 L_maskd_136
v_mov_b32 v116, 0xf149f2ca
v_mov_b32 v117, 0xf149f2ca
v_mov_b32 v118, 0xf149f2ca
v_mov_b32 v119, 0xf149f2ca
s_cmp_eq_u32 s34, 7
s_cbranch_scc1 L_maskd_136
v_mov_b32 v120, 0xf149f2ca
v_mov_b32 v121, 0xf149f2ca
v_mov_b32 v122, 0xf149f2ca
v_mov_b32 v123, 0xf149f2ca
s_cmp_eq_u32 s34, 8
s_cbranch_scc1 L_maskd_136
v_mov_b32 v124, 0xf149f2ca
v_mov_b32 v125, 0xf149f2ca
v_mov_b32 v126, 0xf149f2ca
v_mov_b32 v127, 0xf149f2ca
s_cmp_eq_u32 s34, 9
s_cbranch_scc1 L_maskd_136
v_mov_b32 v128, 0xf149f2ca
v_mov_b32 v129, 0xf149f2ca
v_mov_b32 v130, 0xf149f2ca
v_mov_b32 v131, 0xf149f2ca
s_cmp_eq_u32 s34, 10
s_cbranch_scc1 L_maskd_136
v_mov_b32 v132, 0xf149f2ca
v_mov_b32 v133, 0xf149f2ca
v_mov_b32 v134, 0xf149f2ca
v_mov_b32 v135, 0xf149f2ca
s_cmp_eq_u32 s34, 11
s_cbranch_scc1 L_maskd_136
v_mov_b32 v136, 0xf149f2ca
v_mov_b32 v137, 0xf149f2ca
v_mov_b32 v138, 0xf149f2ca
v_mov_b32 v139, 0xf149f2ca
s_cmp_eq_u32 s34, 12
s_cbranch_scc1 L_maskd_136
v_mov_b32 v140, 0xf149f2ca
v_mov_b32 v141, 0xf149f2ca
v_mov_b32 v142, 0xf149f2ca
v_mov_b32 v143, 0xf149f2ca
s_cmp_eq_u32 s34, 13
s_cbranch_scc1 L_maskd_136
v_mov_b32 v144, 0xf149f2ca
v_mov_b32 v145, 0xf149f2ca
v_mov_b32 v146, 0xf149f2ca
v_mov_b32 v147, 0xf149f2ca
s_cmp_eq_u32 s34, 14
s_cbranch_scc1 L_maskd_136
v_mov_b32 v148, 0xf149f2ca
v_mov_b32 v149, 0xf149f2ca
v_mov_b32 v150, 0xf149f2ca
v_mov_b32 v151, 0xf149f2ca
s_cmp_eq_u32 s34, 15
s_cbranch_scc1 L_maskd_136
v_mov_b32 v152, 0xf149f2ca
v_mov_b32 v153, 0xf149f2ca
v_mov_b32 v154, 0xf149f2ca
v_mov_b32 v155, 0xf149f2ca
L_maskd_136:
s_sub_u32 s34, s34, 1
s_branch L_mkb_135
L_mk_138:
s_nop 7
v_mov_b32 v92, 0xf149f2ca
v_mov_b32 v93, 0xf149f2ca
v_mov_b32 v94, 0xf149f2ca
v_mov_b32 v95, 0xf149f2ca
s_cmp_eq_u32 s34, 1
s_cbranch_scc1 L_maskd_140
v_mov_b32 v96, 0xf149f2ca
v_mov_b32 v97, 0xf149f2ca
v_mov_b32 v98, 0xf149f2ca
v_mov_b32 v99, 0xf149f2ca
s_cmp_eq_u32 s34, 2
s_cbranch_scc1 L_maskd_140
v_mov_b32 v100, 0xf149f2ca
v_mov_b32 v101, 0xf149f2ca
v_mov_b32 v102, 0xf149f2ca
v_mov_b32 v103, 0xf149f2ca
s_cmp_eq_u32 s34, 3
s_cbranch_scc1 L_maskd_140
v_mov_b32 v104, 0xf149f2ca
v_mov_b32 v105, 0xf149f2ca
v_mov_b32 v106, 0xf149f2ca
v_mov_b32 v107, 0xf149f2ca
s_cmp_eq_u32 s34, 4
s_cbranch_scc1 L_maskd_140
v_mov_b32 v108, 0xf149f2ca
v_mov_b32 v109, 0xf149f2ca
v_mov_b32 v110, 0xf149f2ca
v_mov_b32 v111, 0xf149f2ca
s_cmp_eq_u32 s34, 5
s_cbranch_scc1 L_maskd_140
v_mov_b32 v112, 0xf149f2ca
v_mov_b32 v113, 0xf149f2ca
v_mov_b32 v114, 0xf149f2ca
v_mov_b32 v115, 0xf149f2ca
s_cmp_eq_u32 s34, 6
s_cbranch_scc1 L_maskd_140
v_mov_b32 v116, 0xf149f2ca
v_mov_b32 v117, 0xf149f2ca
v_mov_b32 v118, 0xf149f2ca
v_mov_b32 v119, 0xf149f2ca
s_cmp_eq_u32 s34, 7
s_cbranch_scc1 L_maskd_140
v_mov_b32 v120, 0xf149f2ca
v_mov_b32 v121, 0xf149f2ca
v_mov_b32 v122, 0xf149f2ca
v_mov_b32 v123, 0xf149f2ca
s_cmp_eq_u32 s34, 8
s_cbranch_scc1 L_maskd_140
v_mov_b32 v124, 0xf149f2ca
v_mov_b32 v125, 0xf149f2ca
v_mov_b32 v126, 0xf149f2ca
v_mov_b32 v127, 0xf149f2ca
s_cmp_eq_u32 s34, 9
s_cbranch_scc1 L_maskd_140
v_mov_b32 v128, 0xf149f2ca
v_mov_b32 v129, 0xf149f2ca
v_mov_b32 v130, 0xf149f2ca
v_mov_b32 v131, 0xf149f2ca
s_cmp_eq_u32 s34, 10
s_cbranch_scc1 L_maskd_140
v_mov_b32 v132, 0xf149f2ca
v_mov_b32 v133, 0xf149f2ca
v_mov_b32 v134, 0xf149f2ca
v_mov_b32 v135, 0xf149f2ca
s_cmp_eq_u32 s34, 11
s_cbranch_scc1 L_maskd_140
v_mov_b32 v136, 0xf149f2ca
v_mov_b32 v137, 0xf149f2ca
v_mov_b32 v138, 0xf149f2ca
v_mov_b32 v139, 0xf149f2ca
s_cmp_eq_u32 s34, 12
s_cbranch_scc1 L_maskd_140
v_mov_b32 v140, 0xf149f2ca
v_mov_b32 v141, 0xf149f2ca
v_mov_b32 v142, 0xf149f2ca
v_mov_b32 v143, 0xf149f2ca
s_cmp_eq_u32 s34, 13
s_cbranch_scc1 L_maskd_140
v_mov_b32 v144, 0xf149f2ca
v_mov_b32 v145, 0xf149f2ca
v_mov_b32 v146, 0xf149f2ca
v_mov_b32 v147, 0xf149f2ca
s_cmp_eq_u32 s34, 14
s_cbranch_scc1 L_maskd_140
v_mov_b32 v148, 0xf149f2ca
v_mov_b32 v149, 0xf149f2ca
v_mov_b32 v150, 0xf149f2ca
v_mov_b32 v151, 0xf149f2ca
s_cmp_eq_u32 s34, 15
s_cbranch_scc1 L_maskd_140
v_mov_b32 v152, 0xf149f2ca
v_mov_b32 v153, 0xf149f2ca
v_mov_b32 v154, 0xf149f2ca
v_mov_b32 v155, 0xf149f2ca
L_maskd_140:
s_sub_u32 s34, s34, 1
s_branch L_mkb_139
L_w2_141:
s_and_b32 s93, s23, 7
s_lshr_b32 s94, s23, 3
s_and_b32 s22, s93, 1
s_lshr_b32 s20, s93, 1
s_lshl_b32 s20, s20, 2
s_and_b32 s93, s94, 3
s_add_u32 s20, s20, s93
s_lshr_b32 s21, s94, 2
s_and_b32 s93, s43, 3
s_lshl_b32 s87, s20, 3
s_lshl_b32 s94, s93, 1
s_add_u32 s87, s87, s94
s_mul_i32 s87, s87, 144
s_mul_i32 s94, s22, 72
s_add_u32 s87, s87, s94
s_lshl_b32 s87, s87, 10
s_mul_i32 s88, s22, 4718592
s_lshl_b32 s89, s93, 12
s_lshl_b32 s92, s93, 10
s_add_u32 s92, s92, 16384
v_lshrrev_b32 v8, 4, v0
v_and_b32 v9, 15, v0
s_and_b32 s94, s93, 1
s_lshl_b32 s94, s94, 2
v_add_u32 v10, s94, v8
v_lshlrev_b32 v10, 1, v10
v_xor_b32 v9, v9, v10
v_lshlrev_b32 v9, 4, v9
v_lshl_add_u32 v8, v8, 11, v9
s_lshl_b32 s93, s93, 13
s_lshl_b32 s94, s21, 8
s_add_u32 s93, s93, s94
v_add_u32 v8, s93, v8
v_add_u32 v9, 32768, v8
v_add_u32 v10, 65536, v8
v_add_u32 v11, 98304, v8
v_lshlrev_b32 v12, 4, v0
s_mov_b32 s16, s52
s_mov_b32 s17, s53
s_mov_b32 s18, 0x700000
s_mov_b32 s19, 0x20000
s_add_u32 m0, s92, 0
s_nop 0
buffer_load_dwordx4 v8, s[16:19], s88 offen lds
s_add_u32 m0, m0, 4096
s_nop 0
buffer_load_dwordx4 v9, s[16:19], s88 offen lds
s_add_u32 m0, m0, 4096
s_nop 0
buffer_load_dwordx4 v10, s[16:19], s88 offen lds
s_add_u32 m0, m0, 4096
s_nop 0
buffer_load_dwordx4 v11, s[16:19], s88 offen lds
s_add_u32 s88, s88, 131072
s_add_u32 m0, s92, 32768
s_nop 0
buffer_load_dwordx4 v8, s[16:19], s88 offen lds
s_add_u32 m0, m0, 4096
s_nop 0
buffer_load_dwordx4 v9, s[16:19], s88 offen lds
s_add_u32 m0, m0, 4096
s_nop 0
buffer_load_dwordx4 v10, s[16:19], s88 offen lds
s_add_u32 m0, m0, 4096
s_nop 0
buffer_load_dwordx4 v11, s[16:19], s88 offen lds
s_add_u32 s88, s88, 131072
s_add_u32 m0, s92, 131072
s_nop 0
buffer_load_dwordx4 v8, s[16:19], s88 offen lds
s_add_u32 m0, m0, 4096
s_nop 0
buffer_load_dwordx4 v9, s[16:19], s88 offen lds
s_add_u32 m0, m0, 4096
s_nop 0
buffer_load_dwordx4 v10, s[16:19], s88 offen lds
s_add_u32 m0, m0, 4096
s_nop 0
buffer_load_dwordx4 v11, s[16:19], s88 offen lds
s_add_u32 s88, s88, 131072
s_add_u32 m0, s92, 65536
s_nop 0
buffer_load_dwordx4 v8, s[16:19], s88 offen lds
s_add_u32 m0, m0, 4096
s_nop 0
buffer_load_dwordx4 v9, s[16:19], s88 offen lds
s_add_u32 m0, m0, 4096
s_nop 0
buffer_load_dwordx4 v10, s[16:19], s88 offen lds
s_add_u32 m0, m0, 4096
s_nop 0
buffer_load_dwordx4 v11, s[16:19], s88 offen lds
s_add_u32 s88, s88, 131072
s_add_u32 m0, s92, 98304
s_nop 0
buffer_load_dwordx4 v8, s[16:19], s88 offen lds
s_add_u32 m0, m0, 4096
s_nop 0
buffer_load_dwordx4 v9, s[16:19], s88 offen lds
s_add_u32 m0, m0, 4096
s_nop 0
buffer_load_dwordx4 v10, s[16:19], s88 offen lds
s_add_u32 m0, m0, 4096
s_nop 0
buffer_load_dwordx4 v11, s[16:19], s88 offen lds
s_add_u32 s88, s88, 131072
v_and_b32 v13, 31, v0
s_lshr_b32 s93, s20, 1
s_lshl_b32 s93, s93, 5
v_add_u32 v13, s93, v13
s_lshl_b32 s93, s44, 5
s_add_u32 s93, s93, s45
v_cmp_eq_u32 vcc, s93, v13
v_lshlrev_b32 v13, 7, v13
v_add_u32 v1, 32768, v13
v_cndmask_b32 v15, v1, v13, vcc
s_branch L_w2b_142
L_hl_143:
s_mov_b32 s93, 0x2f70000
buffer_load_dword v1, v15, s[24:27], s93 offen sc1
s_branch L_hlb_144
L_hp_145:
s_waitcnt vmcnt(0)
v_cmp_ne_u32 vcc, s86, v1
s_nop 1
s_cbranch_vccnz L_hno_147
s_add_u32 m0, s89, 0
s_nop 0
buffer_load_dwordx4 v12, s[24:27], s87 offen sc1 lds
buffer_load_dwordx4 v12, s[24:27], s87 offen offset:1024 sc1 lds
s_add_u32 s41, s87, 147456
s_add_u32 m0, m0, 2048
s_nop 0
buffer_load_dwordx4 v12, s[24:27], s41 offen sc1 lds
buffer_load_dwordx4 v12, s[24:27], s41 offen offset:1024 sc1 lds
s_add_u32 s87, s87, 2048
s_add_u32 m0, s89, 32768
s_nop 0
buffer_load_dwordx4 v12, s[24:27], s87 offen sc1 lds
buffer_load_dwordx4 v12, s[24:27], s87 offen offset:1024 sc1 lds
s_add_u32 s41, s87, 147456
s_add_u32 m0, m0, 2048
s_nop 0
buffer_load_dwordx4 v12, s[24:27], s41 offen sc1 lds
buffer_load_dwordx4 v12, s[24:27], s41 offen offset:1024 sc1 lds
s_add_u32 s87, s87, 2048
s_add_u32 m0, s89, 131072
s_nop 0
buffer_load_dwordx4 v12, s[24:27], s87 offen sc1 lds
buffer_load_dwordx4 v12, s[24:27], s87 offen offset:1024 sc1 lds
s_add_u32 s41, s87, 147456
s_add_u32 m0, m0, 2048
s_nop 0
buffer_load_dwordx4 v12, s[24:27], s41 offen sc1 lds
buffer_load_dwordx4 v12, s[24:27], s41 offen offset:1024 sc1 lds
s_add_u32 s87, s87, 2048
s_add_u32 m0, s89, 65536
s_nop 0
buffer_load_dwordx4 v12, s[24:27], s87 offen sc1 lds
buffer_load_dwordx4 v12, s[24:27], s87 offen offset:1024 sc1 lds
s_add_u32 s41, s87, 147456
s_add_u32 m0, m0, 2048
s_nop 0
buffer_load_dwordx4 v12, s[24:27], s41 offen sc1 lds
buffer_load_dwordx4 v12, s[24:27], s41 offen offset:1024 sc1 lds
s_add_u32 s87, s87, 2048
s_add_u32 m0, s89, 98304
s_nop 0
buffer_load_dwordx4 v12, s[24:27], s87 offen sc1 lds
buffer_load_dwordx4 v12, s[24:27], s87 offen offset:1024 sc1 lds
s_add_u32 s41, s87, 147456
s_add_u32 m0, m0, 2048
s_nop 0
buffer_load_dwordx4 v12, s[24:27], s41 offen sc1 lds
buffer_load_dwordx4 v12, s[24:27], s41 offen offset:1024 sc1 lds
s_add_u32 s87, s87, 2048
s_mov_b32 s36, 1
s_branch L_hbk_148
L_hno_147:
s_mov_b32 s93, 0x2f70000
buffer_load_dword v1, v15, s[24:27], s93 offen sc1
L_hbk_148:
s_branch L_hpb_146
L_hg_149:
s_waitcnt vmcnt(0)
v_cmp_ne_u32 vcc, s86, v1
s_nop 1
s_cbranch_vccz L_hok_151
s_mov_b32 s94, 0
L_ph_152:
buffer_load_dword v1, v15, s[24:27], s93 offen sc1
s_waitcnt vmcnt(0)
v_cmp_ne_u32 vcc, s86, v1
s_nop 1
s_cbranch_vccz L_phok_153
s_add_u32 s94, s94, 1
s_cmp_lt_u32 s94, 0x80000
s_cbranch_scc1 L_ph_152
L_phok_153:
L_hok_151:
s_add_u32 m0, s89, 0
s_nop 0
buffer_load_dwordx4 v12, s[24:27], s87 offen sc1 lds
buffer_load_dwordx4 v12, s[24:27], s87 offen offset:1024 sc1 lds
s_add_u32 s41, s87, 147456
s_add_u32 m0, m0, 2048
s_nop 0
buffer_load_dwordx4 v12, s[24:27], s41 offen sc1 lds
buffer_load_dwordx4 v12, s[24:27], s41 offen offset:1024 sc1 lds
s_add_u32 s87, s87, 2048
s_add_u32 m0, s89, 32768
s_nop 0
buffer_load_dwordx4 v12, s[24:27], s87 offen sc1 lds
buffer_load_dwordx4 v12, s[24:27], s87 offen offset:1024 sc1 lds
s_add_u32 s41, s87, 147456
s_add_u32 m0, m0, 2048
s_nop 0
buffer_load_dwordx4 v12, s[24:27], s41 offen sc1 lds
buffer_load_dwordx4 v12, s[24:27], s41 offen offset:1024 sc1 lds
s_add_u32 s87, s87, 2048
s_add_u32 m0, s89, 131072
s_nop 0
buffer_load_dwordx4 v12, s[24:27], s87 offen sc1 lds
buffer_load_dwordx4 v12, s[24:27], s87 offen offset:1024 sc1 lds
s_add_u32 s41, s87, 147456
s_add_u32 m0, m0, 2048
s_nop 0
buffer_load_dwordx4 v12, s[24:27], s41 offen sc1 lds
buffer_load_dwordx4 v12, s[24:27], s41 offen offset:1024 sc1 lds
s_add_u32 s87, s87, 2048
s_add_u32 m0, s89, 65536
s_nop 0
buffer_load_dwordx4 v12, s[24:27], s87 offen sc1 lds
buffer_load_dwordx4 v12, s[24:27], s87 offen offset:1024 sc1 lds
s_add_u32 s41, s87, 147456
s_add_u32 m0, m0, 2048
s_nop 0
buffer_load_dwordx4 v12, s[24:27], s41 offen sc1 lds
buffer_load_dwordx4 v12, s[24:27], s41 offen offset:1024 sc1 lds
s_add_u32 s87, s87, 2048
s_add_u32 m0, s89, 98304
s_nop 0
buffer_load_dwordx4 v12, s[24:27], s87 offen sc1 lds
buffer_load_dwordx4 v12, s[24:27], s87 offen offset:1024 sc1 lds
s_add_u32 s41, s87, 147456
s_add_u32 m0, m0, 2048
s_nop 0
buffer_load_dwordx4 v12, s[24:27], s41 offen sc1 lds
buffer_load_dwordx4 v12, s[24:27], s41 offen offset:1024 sc1 lds
s_add_u32 s87, s87, 2048
s_mov_b32 s36, 1
s_branch L_hgb_150
L_fo_157:
s_cmp_lg_u32 s43, 0
s_cbranch_scc1 L_wf_159
s_lshl_b32 s93, s44, 12
s_lshl_b32 s94, s45, 7
s_add_u32 s93, s93, s94
s_add_u32 s93, s93, 0x2f80000
v_mov_b32 v8, s86
buffer_store_dword v8, off, s[24:27], s93 sc1
L_wf_159:
s_branch L_fob_158
L_xt_160:
s_mov_b32 s94, 0
L_xr_162:
buffer_load_dwordx4 v[48:51], v12, s[24:27], s37 offen offset:0 sc1
buffer_load_dwordx4 v[52:55], v12, s[24:27], s37 offen offset:1024 sc1
buffer_load_dwordx4 v[56:59], v12, s[24:27], s37 offen offset:2048 sc1
buffer_load_dwordx4 v[60:63], v12, s[24:27], s37 offen offset:3072 sc1
buffer_load_dwordx4 v[64:67], v12, s[24:27], s35 offen offset:0 sc1
buffer_load_dwordx4 v[68:71], v12, s[24:27], s35 offen offset:1024 sc1
s_waitcnt vmcnt(0)
v_xor_b32 v8, v51, v55
v_xor_b32 v9, v59, v63
v_xor_b32 v10, v67, v71
v_xor_b32 v11, s86, v51
v_or3_b32 v8, v8, v9, v10
v_xor_b32 v9, s86, v59
v_xor_b32 v10, s86, v67
v_or3_b32 v9, v9, v10, v11
v_or_b32 v8, v8, v9
v_cmp_ne_u32 vcc, 0, v8
s_nop 1
s_cbranch_vccz L_xo_163
s_add_u32 s94, s94, 1
s_cmp_lt_u32 s94, 0x40000
s_cbranch_scc1 L_xr_162
L_xo_163:
s_branch L_xtb_161
L_end:
s_endpgm
.section .rodata,"a"
.p2align 6
.amdhsa_kernel parallel_sum__sliding_block__glu_gated_geglu__prompt_kernel
  .amdhsa_next_free_vgpr 256
  .amdhsa_next_free_sgpr 102
  .amdhsa_accum_offset 256
  .amdhsa_group_segment_fixed_size 0
  .amdhsa_kernarg_size 80
  .amdhsa_user_sgpr_count 2
  .amdhsa_user_sgpr_kernarg_segment_ptr 1
  .amdhsa_system_sgpr_workgroup_id_x 1
  .amdhsa_float_denorm_mode_32 3
.end_amdhsa_kernel
```
